```python
import torch

def _softmax(x, axis=-1):
    return torch.softmax(x, dim=axis)
def _gelu(x):
    return torch.nn.functional.gelu(x, approximate="tanh")
def _silu(x):
    return torch.nn.functional.silu(x)
def _sigmoid(x):
    return torch.sigmoid(x)
def _layernorm(x, axis=-1, eps=1e-5):
    m = x.mean(dim=axis, keepdim=True)
    v = x.var(dim=axis, keepdim=True, unbiased=False)
    return (x - m) / torch.sqrt(v + eps)
def _scatter_add(tgt, idx, src, axis=0):
    return tgt.clone().index_add_(axis, idx, src)
def _segment_sum(src, seg, n):
    out = torch.zeros((n,) + src.shape[1:], dtype=src.dtype)
    return out.index_add_(0, seg, src)
def _pad(x, pw):
    flat = tuple(v for pair in reversed(pw) for v in pair)
    return torch.nn.functional.pad(x, flat)

kernel_name = 'parallel_sum__ssm_conv_s4d__glu_gated_glu__prompt'

def setup_inputs():

    _w = (lambda a: (lambda t: t.to(torch.bfloat16) if t.is_floating_point() else t)(torch.as_tensor(a)))
    def _A_setup():
        Bsz, L, D, N = 1, 2048, 640, 192
        return {
            "u": _w((lambda *s: torch.randn(*s, dtype=torch.bfloat16) * 0.05)(Bsz, L, D)),
            "log_A_real": _w((lambda *s: torch.randn(*s, dtype=torch.bfloat16) * 3.2)(D, N) * 0.5),
            "A_imag": _w((lambda *s: torch.randn(*s, dtype=torch.bfloat16) * 0.1)(D, N) * 3.14),
            "C_real": _w((lambda *s: torch.randn(*s, dtype=torch.bfloat16) * 1.6)(D, N) / N ** 0.5),
            "C_imag": _w((lambda *s: torch.randn(*s, dtype=torch.bfloat16) * 1.6)(D, N) / N ** 0.5),
            "log_dt": _w((lambda *s: torch.randn(*s, dtype=torch.bfloat16) * 0.1)(D) * 0.5 - 4.0),
            "D_skip": _w((lambda *s: torch.randn(*s, dtype=torch.bfloat16) * 0.2)(D)),
        }
    _A_in = _A_setup()

    def _B_setup():
        B, S, D, F = 1, 2048, 640, 1536
        return {
            "x": _w((lambda *s: torch.randn(*s, dtype=torch.bfloat16) * 0.05)(B, S, D)),
            "w_gate": _w((lambda *s: torch.randn(*s, dtype=torch.bfloat16) * 0.05)(D, F)),
            "w_up": _w((lambda *s: torch.randn(*s, dtype=torch.bfloat16) * 0.05)(D, F)),
            "w_down": _w((lambda *s: torch.randn(*s, dtype=torch.bfloat16) * 0.05)(F, D)),
        }
    _B_in = _B_setup()

    return {
        "A_u": _A_in["u"],
        "A_log_A_real": _A_in["log_A_real"],
        "A_A_imag": _A_in["A_imag"],
        "A_C_real": _A_in["C_real"],
        "A_C_imag": _A_in["C_imag"],
        "A_log_dt": _A_in["log_dt"],
        "A_D_skip": _A_in["D_skip"],
        "B_x": _B_in["x"],
        "B_w_gate": _B_in["w_gate"],
        "B_w_up": _B_in["w_up"],
        "B_w_down": _B_in["w_down"],
    }

def reference(A_u, A_log_A_real, A_A_imag, A_C_real, A_C_imag, A_log_dt, A_D_skip, B_x, B_w_gate, B_w_up, B_w_down):
    def _A_ref(u, log_A_real, A_imag, C_real, C_imag, log_dt, D_skip):
        L = u.shape[1]
        dt = torch.exp(log_dt)
        A = -torch.exp(log_A_real) + 1j * A_imag
        C = (C_real + 1j * C_imag) * dt[:, None]
        pos = (lambda x, dt: x.to(dt))(torch.arange(L), log_dt.dtype)
        P = torch.exp((A * dt[:, None])[:, :, None] * pos[None, None, :])
        K = 2.0 * torch.einsum("dn,dnl->dl", C, P).real
        L2 = 2 * L
        u_t = (lambda x, *d: x.permute(*d))(u, 0, 2, 1)
        Kf = (lambda x, *a, **k: torch.fft.rfft(x.float(), *a, **k))(K, L2)
        Uf = (lambda x, *a, **k: torch.fft.rfft(x.float(), *a, **k))(u_t, L2)
        y = (lambda x, *a, **k: torch.fft.irfft(x, *a, **k).to(torch.bfloat16))(Uf * Kf[None, :, :], L2)[:, :, :L]
        y = (lambda x, *d: x.permute(*d))(y, 0, 2, 1)
        return y + u * D_skip[None, None, :]

    def _B_ref(x, w_gate, w_up, w_down):
        g = torch.einsum("bsd,df->bsf", x, w_gate)
        u = torch.einsum("bsd,df->bsf", x, w_up)
        h = _sigmoid(g) * u
        return torch.einsum("bsf,fd->bsd", h, w_down)

    x = A_u
    xn = _layernorm(x, axis=-1)
    return x + _A_ref(xn, A_log_A_real, A_A_imag, A_C_real, A_C_imag, A_log_dt, A_D_skip) + _B_ref(xn, B_w_gate, B_w_up, B_w_down)
```

```asm
; @launch grid=(256,1,1) block=(1024,1,1) lds=163840
.amdgcn_target "amdgcn-amd-amdhsa--gfx950"
.text
.globl parallel_sum__ssm_conv_s4d__glu_gated_glu__prompt_kernel
.p2align 8
.type parallel_sum__ssm_conv_s4d__glu_gated_glu__prompt_kernel,@function
parallel_sum__ssm_conv_s4d__glu_gated_glu__prompt_kernel:
  s_cmp_ge_u32 s2, 256
  s_cbranch_scc1 L_k1_end
  s_load_dwordx16 s[64:79], s[0:1], 0
  s_load_dwordx8 s[80:87], s[0:1], 64
  s_load_dwordx4 s[88:91], s[0:1], 96
  v_lshrrev_b32 v1, 6, v0
  v_and_b32 v0, 63, v0
  s_and_b32 s57, s2, 7
  v_readfirstlane_b32 s3, v1
  s_lshr_b32 s56, s2, 3
  s_mul_i32 s58, s56, 52
  s_lshr_b32 s58, s58, 8
  s_mul_i32 s59, s58, 5
  s_sub_u32 s59, s56, s59
  s_and_b32 s60, s57, 1
  s_mul_i32 s60, s60, 5
  s_add_u32 s52, s60, s59
  s_lshr_b32 s60, s57, 1
  s_mul_i32 s60, s60, 6
  s_add_u32 s53, s60, s58
  s_mul_i32 s54, s52, 208
  s_min_u32 s54, s54, 1840
  s_mul_i32 s55, s57, 30
  s_add_u32 s55, s55, s56
  s_cmp_lg_u32 s3, 0
  s_cbranch_scc1 L_nopf_1
  s_cmp_ge_u32 s56, 7
  s_cbranch_scc1 L_nopf_1
  s_getpc_b64 s[96:97]
L_here_2:
  s_sub_u32 s96, s96, L_here_2-parallel_sum__ssm_conv_s4d__glu_gated_glu__prompt_kernel
  s_subb_u32 s97, s97, 0
  s_lshl_b32 s98, s56, 13
  v_lshl_add_u32 v126, v0, 7, s98
  v_min_u32 v126, L_k1_end-parallel_sum__ssm_conv_s4d__glu_gated_glu__prompt_kernel-4, v126
  global_load_dword v126, v126, s[96:97]
L_nopf_1:
  s_add_u32 s58, s3, 2
  s_sub_u32 s59, s3, 9
  s_cmp_lt_u32 s3, 9
  s_cselect_b32 s58, s58, s59
  s_cmp_lt_u32 s3, 11
  s_cselect_b32 s3, s58, s3
  s_waitcnt lgkmcnt(0)
  s_mov_b32 s4, s64
  s_mov_b32 s5, s65
  s_mov_b32 s6, 2621440
  s_mov_b32 s7, 0x00020000
  s_mov_b32 s8, s80
  s_mov_b32 s9, s81
  s_mov_b32 s10, 1966080
  s_mov_b32 s11, 0x00020000
  s_mov_b32 s12, s82
  s_mov_b32 s13, s83
  s_mov_b32 s14, 1966080
  s_mov_b32 s15, 0x00020000
  s_mov_b32 s20, s90
  s_mov_b32 s21, s91
  s_mov_b32 s22, 15895552
  s_mov_b32 s23, 0x00020000
  s_mov_b32 s24, s88
  s_mov_b32 s25, s89
  s_mov_b32 s26, 256
  s_mov_b32 s27, 0x00020000
  s_mov_b32 s16, s84
  s_mov_b32 s17, s85
  s_mov_b32 s18, 1966080
  s_mov_b32 s19, 0x00020000
  s_mov_b32 s28, s66
  s_mov_b32 s29, s67
  s_mov_b32 s30, 245760
  s_mov_b32 s31, 0x00020000
  s_mov_b32 s32, s68
  s_mov_b32 s33, s69
  s_mov_b32 s34, 245760
  s_mov_b32 s35, 0x00020000
  s_mov_b32 s36, s70
  s_mov_b32 s37, s71
  s_mov_b32 s38, 245760
  s_mov_b32 s39, 0x00020000
  s_mov_b32 s40, s72
  s_mov_b32 s41, s73
  s_mov_b32 s42, 245760
  s_mov_b32 s43, 0x00020000
  s_mov_b32 s44, s74
  s_mov_b32 s45, s75
  s_mov_b32 s46, 1280
  s_mov_b32 s47, 0x00020000
  s_mov_b32 s96, s76
  s_mov_b32 s97, s77
  s_mov_b32 s72, s86
  s_mov_b32 s73, s87
  s_mov_b32 s74, 2621440
  s_mov_b32 s75, 0x00020000
  s_mov_b32 s76, s96
  s_mov_b32 s77, s97
  s_mov_b32 s78, 1280
  s_mov_b32 s79, 0x00020000
  s_lshl_b32 s80, s57, 2
  s_and_b32 s96, s56, 3
  s_add_u32 s80, s80, s96
  s_lshr_b32 s81, s56, 2
  s_lshl_b32 s69, s57, 5
  s_add_u32 s69, s69, s56
  s_cmp_ge_u32 s3, 2
  s_cbranch_scc1 L_k1_w
  v_lshrrev_b32 v8, 3, v0
  v_and_b32 v9, 7, v0
  v_xor_b32 v10, v9, v8
  v_mul_u32_u24 v16, 1280, v8
  v_lshl_add_u32 v16, v10, 4, v16
  v_bfe_u32 v10, v8, 1, 1
  v_lshrrev_b32 v11, 1, v9
  v_xor_b32 v11, v11, v10
  v_and_b32 v12, 1, v9
  v_lshl_add_u32 v11, v11, 1, v12
  v_mul_u32_u24 v20, 3072, v8
  v_lshl_add_u32 v20, v11, 4, v20
  v_xor_b32 v13, 64, v20
  v_add_u32 v21, 23552, v13
  v_add_u32 v22, 47104, v20
  v_add_u32 v23, 70656, v13
  v_add_u32 v17, 9216, v16
  v_add_u32 v18, 18432, v16
  v_add_u32 v19, 27648, v16
  s_mul_i32 s58, s3, 104
  s_add_u32 s59, s54, s58
  s_mul_i32 s59, s59, 1280
  s_lshl_b32 s60, s53, 7
  s_cmp_eq_u32 s3, 0
  s_cselect_b32 s48, s8, s12
  s_cselect_b32 s49, s9, s13
  s_mov_b32 s50, 1966080
  s_mov_b32 s51, 0x00020000
  s_mul_i32 s92, s3, 13312
  s_mul_i32 s93, s3, 8192
  s_add_u32 s93, s93, 26624
  v_lshlrev_b32 v24, 2, v0
  v_lshlrev_b32 v25, 4, v0
  s_cmp_ge_u32 s56, 30
  s_cbranch_scc1 L_noiss_3
  s_add_u32 m0, s93, 0
  s_add_u32 s98, s60, 0
  buffer_load_dwordx4 v20, s[48:51], s98 offen offset:0 lds
  buffer_load_dwordx4 v21, s[48:51], s98 offen offset:1024 lds
  buffer_load_dwordx4 v22, s[48:51], s98 offen offset:2048 lds
  buffer_load_dwordx4 v23, s[48:51], s98 offen offset:3072 lds
  s_add_u32 m0, s92, 0
  s_add_u32 s98, s59, 0
  buffer_load_dwordx4 v16, s[4:7], s98 offen offset:0 lds
  buffer_load_dwordx4 v17, s[4:7], s98 offen offset:1024 lds
  buffer_load_dwordx4 v18, s[4:7], s98 offen offset:2048 lds
  buffer_load_dwordx4 v19, s[4:7], s98 offen offset:3072 lds
  s_add_u32 m0, s92, 4096
  s_add_u32 s98, s59, 40960
  buffer_load_dwordx4 v16, s[4:7], s98 offen offset:0 lds
  buffer_load_dwordx4 v17, s[4:7], s98 offen offset:1024 lds
  buffer_load_dwordx4 v18, s[4:7], s98 offen offset:2048 lds
  buffer_load_dwordx4 v19, s[4:7], s98 offen offset:3072 lds
  s_add_u32 m0, s92, 8192
  s_add_u32 s98, s59, 81920
  buffer_load_dwordx4 v16, s[4:7], s98 offen offset:0 lds
  buffer_load_dwordx4 v17, s[4:7], s98 offen offset:1024 lds
  buffer_load_dwordx4 v18, s[4:7], s98 offen offset:2048 lds
  buffer_load_dwordx4 v19, s[4:7], s98 offen offset:3072 lds
  s_add_u32 m0, s92, 12288
  s_add_u32 s98, s59, 122880
  buffer_load_dwordx4 v16, s[4:7], s98 offen offset:0 lds
  s_add_u32 m0, s93, 4096
  s_add_u32 s98, s60, 98304
  buffer_load_dwordx4 v20, s[48:51], s98 offen offset:0 lds
  buffer_load_dwordx4 v21, s[48:51], s98 offen offset:1024 lds
  buffer_load_dwordx4 v22, s[48:51], s98 offen offset:2048 lds
  buffer_load_dwordx4 v23, s[48:51], s98 offen offset:3072 lds
L_noiss_3:
  s_setprio 0
  s_cmp_ge_u32 s56, 30
  s_cbranch_scc1 L_noiss_4
  s_add_u32 m0, s93, 43008
  s_add_u32 s98, s60, 196608
  buffer_load_dwordx4 v20, s[48:51], s98 offen offset:0 lds
  buffer_load_dwordx4 v21, s[48:51], s98 offen offset:1024 lds
  buffer_load_dwordx4 v22, s[48:51], s98 offen offset:2048 lds
  buffer_load_dwordx4 v23, s[48:51], s98 offen offset:3072 lds
  s_add_u32 m0, s92, 43008
  s_add_u32 s98, s59, 128
  buffer_load_dwordx4 v16, s[4:7], s98 offen offset:0 lds
  buffer_load_dwordx4 v17, s[4:7], s98 offen offset:1024 lds
  buffer_load_dwordx4 v18, s[4:7], s98 offen offset:2048 lds
  buffer_load_dwordx4 v19, s[4:7], s98 offen offset:3072 lds
  s_add_u32 m0, s92, 47104
  s_add_u32 s98, s59, 41088
  buffer_load_dwordx4 v16, s[4:7], s98 offen offset:0 lds
  buffer_load_dwordx4 v17, s[4:7], s98 offen offset:1024 lds
  buffer_load_dwordx4 v18, s[4:7], s98 offen offset:2048 lds
  buffer_load_dwordx4 v19, s[4:7], s98 offen offset:3072 lds
  s_add_u32 m0, s92, 51200
  s_add_u32 s98, s59, 82048
  buffer_load_dwordx4 v16, s[4:7], s98 offen offset:0 lds
  buffer_load_dwordx4 v17, s[4:7], s98 offen offset:1024 lds
  buffer_load_dwordx4 v18, s[4:7], s98 offen offset:2048 lds
  buffer_load_dwordx4 v19, s[4:7], s98 offen offset:3072 lds
  s_add_u32 m0, s92, 55296
  s_add_u32 s98, s59, 123008
  buffer_load_dwordx4 v16, s[4:7], s98 offen offset:0 lds
  s_add_u32 m0, s93, 47104
  s_add_u32 s98, s60, 294912
  buffer_load_dwordx4 v20, s[48:51], s98 offen offset:0 lds
  buffer_load_dwordx4 v21, s[48:51], s98 offen offset:1024 lds
  buffer_load_dwordx4 v22, s[48:51], s98 offen offset:2048 lds
  buffer_load_dwordx4 v23, s[48:51], s98 offen offset:3072 lds
L_noiss_4:
  s_barrier
  s_waitcnt vmcnt(21)
  s_setprio 3
  s_barrier
  s_cmp_ge_u32 s56, 30
  s_cbranch_scc1 L_noiss_5
  s_add_u32 m0, s93, 86016
  s_add_u32 s98, s60, 393216
  buffer_load_dwordx4 v20, s[48:51], s98 offen offset:0 lds
  buffer_load_dwordx4 v21, s[48:51], s98 offen offset:1024 lds
  buffer_load_dwordx4 v22, s[48:51], s98 offen offset:2048 lds
  buffer_load_dwordx4 v23, s[48:51], s98 offen offset:3072 lds
  s_add_u32 m0, s92, 86016
  s_add_u32 s98, s59, 256
  buffer_load_dwordx4 v16, s[4:7], s98 offen offset:0 lds
  buffer_load_dwordx4 v17, s[4:7], s98 offen offset:1024 lds
  buffer_load_dwordx4 v18, s[4:7], s98 offen offset:2048 lds
  buffer_load_dwordx4 v19, s[4:7], s98 offen offset:3072 lds
  s_add_u32 m0, s92, 90112
  s_add_u32 s98, s59, 41216
  buffer_load_dwordx4 v16, s[4:7], s98 offen offset:0 lds
  buffer_load_dwordx4 v17, s[4:7], s98 offen offset:1024 lds
  buffer_load_dwordx4 v18, s[4:7], s98 offen offset:2048 lds
  buffer_load_dwordx4 v19, s[4:7], s98 offen offset:3072 lds
  s_add_u32 m0, s92, 94208
  s_add_u32 s98, s59, 82176
  buffer_load_dwordx4 v16, s[4:7], s98 offen offset:0 lds
  buffer_load_dwordx4 v17, s[4:7], s98 offen offset:1024 lds
  buffer_load_dwordx4 v18, s[4:7], s98 offen offset:2048 lds
  buffer_load_dwordx4 v19, s[4:7], s98 offen offset:3072 lds
  s_add_u32 m0, s92, 98304
  s_add_u32 s98, s59, 123136
  buffer_load_dwordx4 v16, s[4:7], s98 offen offset:0 lds
  s_add_u32 m0, s93, 90112
  s_add_u32 s98, s60, 491520
  buffer_load_dwordx4 v20, s[48:51], s98 offen offset:0 lds
  buffer_load_dwordx4 v21, s[48:51], s98 offen offset:1024 lds
  buffer_load_dwordx4 v22, s[48:51], s98 offen offset:2048 lds
  buffer_load_dwordx4 v23, s[48:51], s98 offen offset:3072 lds
L_noiss_5:
  s_waitcnt vmcnt(21)
  s_barrier
  s_cmp_ge_u32 s56, 30
  s_cbranch_scc1 L_noiss_8
  s_add_u32 m0, s93, 0
  s_add_u32 s98, s60, 589824
  buffer_load_dwordx4 v20, s[48:51], s98 offen offset:0 lds
  buffer_load_dwordx4 v21, s[48:51], s98 offen offset:1024 lds
  buffer_load_dwordx4 v22, s[48:51], s98 offen offset:2048 lds
  buffer_load_dwordx4 v23, s[48:51], s98 offen offset:3072 lds
  s_add_u32 m0, s92, 0
  s_add_u32 s98, s59, 384
  buffer_load_dwordx4 v16, s[4:7], s98 offen offset:0 lds
  buffer_load_dwordx4 v17, s[4:7], s98 offen offset:1024 lds
  buffer_load_dwordx4 v18, s[4:7], s98 offen offset:2048 lds
  buffer_load_dwordx4 v19, s[4:7], s98 offen offset:3072 lds
  s_add_u32 m0, s92, 4096
  s_add_u32 s98, s59, 41344
  buffer_load_dwordx4 v16, s[4:7], s98 offen offset:0 lds
  buffer_load_dwordx4 v17, s[4:7], s98 offen offset:1024 lds
  buffer_load_dwordx4 v18, s[4:7], s98 offen offset:2048 lds
  buffer_load_dwordx4 v19, s[4:7], s98 offen offset:3072 lds
  s_add_u32 m0, s92, 8192
  s_add_u32 s98, s59, 82304
  buffer_load_dwordx4 v16, s[4:7], s98 offen offset:0 lds
  buffer_load_dwordx4 v17, s[4:7], s98 offen offset:1024 lds
  buffer_load_dwordx4 v18, s[4:7], s98 offen offset:2048 lds
  buffer_load_dwordx4 v19, s[4:7], s98 offen offset:3072 lds
  s_add_u32 m0, s92, 12288
  s_add_u32 s98, s59, 123264
  buffer_load_dwordx4 v16, s[4:7], s98 offen offset:0 lds
  s_add_u32 m0, s93, 4096
  s_add_u32 s98, s60, 688128
  buffer_load_dwordx4 v20, s[48:51], s98 offen offset:0 lds
  buffer_load_dwordx4 v21, s[48:51], s98 offen offset:1024 lds
  buffer_load_dwordx4 v22, s[48:51], s98 offen offset:2048 lds
  buffer_load_dwordx4 v23, s[48:51], s98 offen offset:3072 lds
L_noiss_8:
  s_waitcnt vmcnt(21)
  s_barrier
  s_cmp_ge_u32 s56, 30
  s_cbranch_scc1 L_noiss_9
  s_add_u32 m0, s93, 43008
  s_add_u32 s98, s60, 786432
  buffer_load_dwordx4 v20, s[48:51], s98 offen offset:0 lds
  buffer_load_dwordx4 v21, s[48:51], s98 offen offset:1024 lds
  buffer_load_dwordx4 v22, s[48:51], s98 offen offset:2048 lds
  buffer_load_dwordx4 v23, s[48:51], s98 offen offset:3072 lds
  s_add_u32 m0, s92, 43008
  s_add_u32 s98, s59, 512
  buffer_load_dwordx4 v16, s[4:7], s98 offen offset:0 lds
  buffer_load_dwordx4 v17, s[4:7], s98 offen offset:1024 lds
  buffer_load_dwordx4 v18, s[4:7], s98 offen offset:2048 lds
  buffer_load_dwordx4 v19, s[4:7], s98 offen offset:3072 lds
  s_add_u32 m0, s92, 47104
  s_add_u32 s98, s59, 41472
  buffer_load_dwordx4 v16, s[4:7], s98 offen offset:0 lds
  buffer_load_dwordx4 v17, s[4:7], s98 offen offset:1024 lds
  buffer_load_dwordx4 v18, s[4:7], s98 offen offset:2048 lds
  buffer_load_dwordx4 v19, s[4:7], s98 offen offset:3072 lds
  s_add_u32 m0, s92, 51200
  s_add_u32 s98, s59, 82432
  buffer_load_dwordx4 v16, s[4:7], s98 offen offset:0 lds
  buffer_load_dwordx4 v17, s[4:7], s98 offen offset:1024 lds
  buffer_load_dwordx4 v18, s[4:7], s98 offen offset:2048 lds
  buffer_load_dwordx4 v19, s[4:7], s98 offen offset:3072 lds
  s_add_u32 m0, s92, 55296
  s_add_u32 s98, s59, 123392
  buffer_load_dwordx4 v16, s[4:7], s98 offen offset:0 lds
  s_add_u32 m0, s93, 47104
  s_add_u32 s98, s60, 884736
  buffer_load_dwordx4 v20, s[48:51], s98 offen offset:0 lds
  buffer_load_dwordx4 v21, s[48:51], s98 offen offset:1024 lds
  buffer_load_dwordx4 v22, s[48:51], s98 offen offset:2048 lds
  buffer_load_dwordx4 v23, s[48:51], s98 offen offset:3072 lds
L_noiss_9:
  s_waitcnt vmcnt(21)
  s_barrier
  s_cmp_ge_u32 s56, 30
  s_cbranch_scc1 L_noiss_10
  s_add_u32 m0, s93, 86016
  s_add_u32 s98, s60, 983040
  buffer_load_dwordx4 v20, s[48:51], s98 offen offset:0 lds
  buffer_load_dwordx4 v21, s[48:51], s98 offen offset:1024 lds
  buffer_load_dwordx4 v22, s[48:51], s98 offen offset:2048 lds
  buffer_load_dwordx4 v23, s[48:51], s98 offen offset:3072 lds
  s_add_u32 m0, s92, 86016
  s_add_u32 s98, s59, 640
  buffer_load_dwordx4 v16, s[4:7], s98 offen offset:0 lds
  buffer_load_dwordx4 v17, s[4:7], s98 offen offset:1024 lds
  buffer_load_dwordx4 v18, s[4:7], s98 offen offset:2048 lds
  buffer_load_dwordx4 v19, s[4:7], s98 offen offset:3072 lds
  s_add_u32 m0, s92, 90112
  s_add_u32 s98, s59, 41600
  buffer_load_dwordx4 v16, s[4:7], s98 offen offset:0 lds
  buffer_load_dwordx4 v17, s[4:7], s98 offen offset:1024 lds
  buffer_load_dwordx4 v18, s[4:7], s98 offen offset:2048 lds
  buffer_load_dwordx4 v19, s[4:7], s98 offen offset:3072 lds
  s_add_u32 m0, s92, 94208
  s_add_u32 s98, s59, 82560
  buffer_load_dwordx4 v16, s[4:7], s98 offen offset:0 lds
  buffer_load_dwordx4 v17, s[4:7], s98 offen offset:1024 lds
  buffer_load_dwordx4 v18, s[4:7], s98 offen offset:2048 lds
  buffer_load_dwordx4 v19, s[4:7], s98 offen offset:3072 lds
  s_add_u32 m0, s92, 98304
  s_add_u32 s98, s59, 123520
  buffer_load_dwordx4 v16, s[4:7], s98 offen offset:0 lds
  s_add_u32 m0, s93, 90112
  s_add_u32 s98, s60, 1081344
  buffer_load_dwordx4 v20, s[48:51], s98 offen offset:0 lds
  buffer_load_dwordx4 v21, s[48:51], s98 offen offset:1024 lds
  buffer_load_dwordx4 v22, s[48:51], s98 offen offset:2048 lds
  buffer_load_dwordx4 v23, s[48:51], s98 offen offset:3072 lds
L_noiss_10:
  s_waitcnt vmcnt(21)
  s_barrier
  s_cmp_ge_u32 s56, 30
  s_cbranch_scc1 L_noiss_11
  s_add_u32 m0, s93, 0
  s_add_u32 s98, s60, 1179648
  buffer_load_dwordx4 v20, s[48:51], s98 offen offset:0 lds
  buffer_load_dwordx4 v21, s[48:51], s98 offen offset:1024 lds
  buffer_load_dwordx4 v22, s[48:51], s98 offen offset:2048 lds
  buffer_load_dwordx4 v23, s[48:51], s98 offen offset:3072 lds
  s_add_u32 m0, s92, 0
  s_add_u32 s98, s59, 768
  buffer_load_dwordx4 v16, s[4:7], s98 offen offset:0 lds
  buffer_load_dwordx4 v17, s[4:7], s98 offen offset:1024 lds
  buffer_load_dwordx4 v18, s[4:7], s98 offen offset:2048 lds
  buffer_load_dwordx4 v19, s[4:7], s98 offen offset:3072 lds
  s_add_u32 m0, s92, 4096
  s_add_u32 s98, s59, 41728
  buffer_load_dwordx4 v16, s[4:7], s98 offen offset:0 lds
  buffer_load_dwordx4 v17, s[4:7], s98 offen offset:1024 lds
  buffer_load_dwordx4 v18, s[4:7], s98 offen offset:2048 lds
  buffer_load_dwordx4 v19, s[4:7], s98 offen offset:3072 lds
  s_add_u32 m0, s92, 8192
  s_add_u32 s98, s59, 82688
  buffer_load_dwordx4 v16, s[4:7], s98 offen offset:0 lds
  buffer_load_dwordx4 v17, s[4:7], s98 offen offset:1024 lds
  buffer_load_dwordx4 v18, s[4:7], s98 offen offset:2048 lds
  buffer_load_dwordx4 v19, s[4:7], s98 offen offset:3072 lds
  s_add_u32 m0, s92, 12288
  s_add_u32 s98, s59, 123648
  buffer_load_dwordx4 v16, s[4:7], s98 offen offset:0 lds
  s_add_u32 m0, s93, 4096
  s_add_u32 s98, s60, 1277952
  buffer_load_dwordx4 v20, s[48:51], s98 offen offset:0 lds
  buffer_load_dwordx4 v21, s[48:51], s98 offen offset:1024 lds
  buffer_load_dwordx4 v22, s[48:51], s98 offen offset:2048 lds
  buffer_load_dwordx4 v23, s[48:51], s98 offen offset:3072 lds
L_noiss_11:
  s_waitcnt vmcnt(21)
  s_barrier
  s_cmp_ge_u32 s56, 30
  s_cbranch_scc1 L_noiss_12
  s_add_u32 m0, s93, 43008
  s_add_u32 s98, s60, 1376256
  buffer_load_dwordx4 v20, s[48:51], s98 offen offset:0 lds
  buffer_load_dwordx4 v21, s[48:51], s98 offen offset:1024 lds
  buffer_load_dwordx4 v22, s[48:51], s98 offen offset:2048 lds
  buffer_load_dwordx4 v23, s[48:51], s98 offen offset:3072 lds
  s_add_u32 m0, s92, 43008
  s_add_u32 s98, s59, 896
  buffer_load_dwordx4 v16, s[4:7], s98 offen offset:0 lds
  buffer_load_dwordx4 v17, s[4:7], s98 offen offset:1024 lds
  buffer_load_dwordx4 v18, s[4:7], s98 offen offset:2048 lds
  buffer_load_dwordx4 v19, s[4:7], s98 offen offset:3072 lds
  s_add_u32 m0, s92, 47104
  s_add_u32 s98, s59, 41856
  buffer_load_dwordx4 v16, s[4:7], s98 offen offset:0 lds
  buffer_load_dwordx4 v17, s[4:7], s98 offen offset:1024 lds
  buffer_load_dwordx4 v18, s[4:7], s98 offen offset:2048 lds
  buffer_load_dwordx4 v19, s[4:7], s98 offen offset:3072 lds
  s_add_u32 m0, s92, 51200
  s_add_u32 s98, s59, 82816
  buffer_load_dwordx4 v16, s[4:7], s98 offen offset:0 lds
  buffer_load_dwordx4 v17, s[4:7], s98 offen offset:1024 lds
  buffer_load_dwordx4 v18, s[4:7], s98 offen offset:2048 lds
  buffer_load_dwordx4 v19, s[4:7], s98 offen offset:3072 lds
  s_add_u32 m0, s92, 55296
  s_add_u32 s98, s59, 123776
  buffer_load_dwordx4 v16, s[4:7], s98 offen offset:0 lds
  s_add_u32 m0, s93, 47104
  s_add_u32 s98, s60, 1474560
  buffer_load_dwordx4 v20, s[48:51], s98 offen offset:0 lds
  buffer_load_dwordx4 v21, s[48:51], s98 offen offset:1024 lds
  buffer_load_dwordx4 v22, s[48:51], s98 offen offset:2048 lds
  buffer_load_dwordx4 v23, s[48:51], s98 offen offset:3072 lds
L_noiss_12:
  s_cmp_eq_u32 s3, 1
  s_cbranch_scc1 L_ldr1_6
  s_waitcnt vmcnt(21)
  s_barrier
  s_cmp_ge_u32 s56, 30
  s_cbranch_scc1 L_noiss_13
  s_add_u32 m0, s93, 86016
  s_add_u32 s98, s60, 1572864
  buffer_load_dwordx4 v20, s[48:51], s98 offen offset:0 lds
  buffer_load_dwordx4 v21, s[48:51], s98 offen offset:1024 lds
  buffer_load_dwordx4 v22, s[48:51], s98 offen offset:2048 lds
  buffer_load_dwordx4 v23, s[48:51], s98 offen offset:3072 lds
  s_add_u32 m0, s92, 86016
  s_add_u32 s98, s59, 1024
  buffer_load_dwordx4 v16, s[4:7], s98 offen offset:0 lds
  buffer_load_dwordx4 v17, s[4:7], s98 offen offset:1024 lds
  buffer_load_dwordx4 v18, s[4:7], s98 offen offset:2048 lds
  buffer_load_dwordx4 v19, s[4:7], s98 offen offset:3072 lds
  s_add_u32 m0, s92, 90112
  s_add_u32 s98, s59, 41984
  buffer_load_dwordx4 v16, s[4:7], s98 offen offset:0 lds
  buffer_load_dwordx4 v17, s[4:7], s98 offen offset:1024 lds
  buffer_load_dwordx4 v18, s[4:7], s98 offen offset:2048 lds
  buffer_load_dwordx4 v19, s[4:7], s98 offen offset:3072 lds
  s_add_u32 m0, s92, 94208
  s_add_u32 s98, s59, 82944
  buffer_load_dwordx4 v16, s[4:7], s98 offen offset:0 lds
  buffer_load_dwordx4 v17, s[4:7], s98 offen offset:1024 lds
  buffer_load_dwordx4 v18, s[4:7], s98 offen offset:2048 lds
  buffer_load_dwordx4 v19, s[4:7], s98 offen offset:3072 lds
  s_add_u32 m0, s92, 98304
  s_add_u32 s98, s59, 123904
  buffer_load_dwordx4 v16, s[4:7], s98 offen offset:0 lds
  s_add_u32 m0, s93, 90112
  s_add_u32 s98, s60, 1671168
  buffer_load_dwordx4 v20, s[48:51], s98 offen offset:0 lds
  buffer_load_dwordx4 v21, s[48:51], s98 offen offset:1024 lds
  buffer_load_dwordx4 v22, s[48:51], s98 offen offset:2048 lds
  buffer_load_dwordx4 v23, s[48:51], s98 offen offset:3072 lds
L_noiss_13:
  s_waitcnt vmcnt(21)
  s_branch L_b4_7
L_ldr1_6:
  s_cmp_lt_u32 s56, 30
  s_cbranch_scc1 L_bk_14
  s_sleep 100
L_bk_14:
  s_waitcnt vmcnt(21)
  s_barrier
  s_mov_b64 exec, 0xffff
  buffer_load_dwordx4 v[44:47], v25, s[24:27], 0 offen sc1
  s_mov_b64 exec, -1
  s_cmp_ge_u32 s56, 30
  s_cbranch_scc1 L_noiss_15
  s_add_u32 m0, s93, 86016
  s_add_u32 s98, s60, 1572864
  buffer_load_dwordx4 v20, s[48:51], s98 offen offset:0 lds
  buffer_load_dwordx4 v21, s[48:51], s98 offen offset:1024 lds
  buffer_load_dwordx4 v22, s[48:51], s98 offen offset:2048 lds
  buffer_load_dwordx4 v23, s[48:51], s98 offen offset:3072 lds
  s_add_u32 m0, s92, 86016
  s_add_u32 s98, s59, 1024
  buffer_load_dwordx4 v16, s[4:7], s98 offen offset:0 lds
  buffer_load_dwordx4 v17, s[4:7], s98 offen offset:1024 lds
  buffer_load_dwordx4 v18, s[4:7], s98 offen offset:2048 lds
  buffer_load_dwordx4 v19, s[4:7], s98 offen offset:3072 lds
  s_add_u32 m0, s92, 90112
  s_add_u32 s98, s59, 41984
  buffer_load_dwordx4 v16, s[4:7], s98 offen offset:0 lds
  buffer_load_dwordx4 v17, s[4:7], s98 offen offset:1024 lds
  buffer_load_dwordx4 v18, s[4:7], s98 offen offset:2048 lds
  buffer_load_dwordx4 v19, s[4:7], s98 offen offset:3072 lds
  s_add_u32 m0, s92, 94208
  s_add_u32 s98, s59, 82944
  buffer_load_dwordx4 v16, s[4:7], s98 offen offset:0 lds
  buffer_load_dwordx4 v17, s[4:7], s98 offen offset:1024 lds
  buffer_load_dwordx4 v18, s[4:7], s98 offen offset:2048 lds
  buffer_load_dwordx4 v19, s[4:7], s98 offen offset:3072 lds
  s_add_u32 m0, s92, 98304
  s_add_u32 s98, s59, 123904
  buffer_load_dwordx4 v16, s[4:7], s98 offen offset:0 lds
  s_add_u32 m0, s93, 90112
  s_add_u32 s98, s60, 1671168
  buffer_load_dwordx4 v20, s[48:51], s98 offen offset:0 lds
  buffer_load_dwordx4 v21, s[48:51], s98 offen offset:1024 lds
  buffer_load_dwordx4 v22, s[48:51], s98 offen offset:2048 lds
  buffer_load_dwordx4 v23, s[48:51], s98 offen offset:3072 lds
L_noiss_15:
  s_waitcnt vmcnt(21)
  s_cmp_lt_u32 s56, 30
  s_cbranch_scc1 L_v_16
  s_waitcnt vmcnt(0)
L_v_16:
  s_mov_b32 s62, 0
L_chk_18:
  v_min_u32 v44, v44, v45
  v_min3_u32 v44, v44, v46, v47
  v_cmp_le_u32 vcc, 4, v44
  s_and_b32 s58, vcc_lo, 0xffff
  s_cmp_eq_u32 s58, 0xffff
  s_cbranch_scc0 L_spin_17
  s_branch L_b4_7
L_spin_17:
  s_sleep 24
  s_mov_b64 exec, 0xffff
  buffer_load_dwordx4 v[44:47], v25, s[24:27], 0 offen sc1
  s_mov_b64 exec, -1
  s_add_u32 s62, s62, 1
  s_waitcnt vmcnt(0)
  s_cmp_lt_u32 s62, 200000
  s_cbranch_scc1 L_chk_18
L_b4_7:
  s_barrier
  s_cmp_eq_u32 s3, 0
  s_cbranch_scc1 L_nocs_19
  s_cmp_ge_u32 s56, 30
  s_cbranch_scc1 L_noiss_21
  s_add_u32 m0, s93, 0
  s_add_u32 s98, s60, 1769472
  buffer_load_dwordx4 v20, s[48:51], s98 offen offset:0 lds
  buffer_load_dwordx4 v21, s[48:51], s98 offen offset:1024 lds
  buffer_load_dwordx4 v22, s[48:51], s98 offen offset:2048 lds
  buffer_load_dwordx4 v23, s[48:51], s98 offen offset:3072 lds
  s_add_u32 m0, s92, 0
  s_add_u32 s98, s59, 1152
  buffer_load_dwordx4 v16, s[4:7], s98 offen offset:0 lds
  buffer_load_dwordx4 v17, s[4:7], s98 offen offset:1024 lds
  buffer_load_dwordx4 v18, s[4:7], s98 offen offset:2048 lds
  buffer_load_dwordx4 v19, s[4:7], s98 offen offset:3072 lds
  s_add_u32 m0, s92, 4096
  s_add_u32 s98, s59, 42112
  buffer_load_dwordx4 v16, s[4:7], s98 offen offset:0 lds
  buffer_load_dwordx4 v17, s[4:7], s98 offen offset:1024 lds
  buffer_load_dwordx4 v18, s[4:7], s98 offen offset:2048 lds
  buffer_load_dwordx4 v19, s[4:7], s98 offen offset:3072 lds
  s_add_u32 m0, s92, 8192
  s_add_u32 s98, s59, 83072
  buffer_load_dwordx4 v16, s[4:7], s98 offen offset:0 lds
  buffer_load_dwordx4 v17, s[4:7], s98 offen offset:1024 lds
  buffer_load_dwordx4 v18, s[4:7], s98 offen offset:2048 lds
  buffer_load_dwordx4 v19, s[4:7], s98 offen offset:3072 lds
  s_add_u32 m0, s92, 12288
  s_add_u32 s98, s59, 124032
  buffer_load_dwordx4 v16, s[4:7], s98 offen offset:0 lds
  s_add_u32 m0, s93, 4096
  s_add_u32 s98, s60, 1867776
  buffer_load_dwordx4 v20, s[48:51], s98 offen offset:0 lds
  buffer_load_dwordx4 v21, s[48:51], s98 offen offset:1024 lds
  buffer_load_dwordx4 v22, s[48:51], s98 offen offset:2048 lds
  buffer_load_dwordx4 v23, s[48:51], s98 offen offset:3072 lds
L_noiss_21:
  s_lshl_b32 s98, s54, 3
  s_mov_b32 m0, 129024
  s_add_u32 s98, s98, 15810560
  buffer_load_dwordx4 v25, s[20:23], s98 offen sc1 lds
  buffer_load_dwordx4 v25, s[20:23], s98 offen offset:1024 sc1 lds
  s_lshl_b32 s97, s53, 8
  s_add_u32 s97, s97, 15826944
  s_add_u32 s98, s97, 0
  buffer_load_dword v32, v24, s[20:23], s98 offen sc1
  s_add_u32 s98, s97, 6144
  buffer_load_dword v37, v24, s[20:23], s98 offen sc1
  s_add_u32 s98, s97, 12288
  buffer_load_dword v33, v24, s[20:23], s98 offen sc1
  s_add_u32 s98, s97, 18432
  buffer_load_dword v38, v24, s[20:23], s98 offen sc1
  s_add_u32 s98, s97, 24576
  buffer_load_dword v34, v24, s[20:23], s98 offen sc1
  s_add_u32 s98, s97, 30720
  buffer_load_dword v39, v24, s[20:23], s98 offen sc1
  s_add_u32 s98, s97, 36864
  buffer_load_dword v35, v24, s[20:23], s98 offen sc1
  s_add_u32 s98, s97, 43008
  buffer_load_dword v40, v24, s[20:23], s98 offen sc1
  s_add_u32 s98, s97, 49152
  buffer_load_dword v36, v24, s[20:23], s98 offen sc1
  s_add_u32 s98, s97, 55296
  buffer_load_dword v41, v24, s[20:23], s98 offen sc1
  s_waitcnt vmcnt(33)
  s_barrier
  s_waitcnt vmcnt(0)
  v_add_f32 v32, v32, v33
  v_add_f32 v37, v37, v38
  v_add_f32 v32, v32, v34
  v_add_f32 v37, v37, v39
  v_add_f32 v32, v32, v35
  v_add_f32 v37, v37, v40
  v_add_f32 v32, v32, v36
  v_add_f32 v37, v37, v41
  v_add_u32 v26, 131072, v24
  ds_write_b32 v26, v32
  ds_write_b32 v26, v37 offset:256
  s_waitcnt lgkmcnt(0)
  s_branch L_nocs_20
L_nocs_19:
  s_cmp_ge_u32 s56, 30
  s_cbranch_scc1 L_noiss_22
  s_add_u32 m0, s93, 0
  s_add_u32 s98, s60, 1769472
  buffer_load_dwordx4 v20, s[48:51], s98 offen offset:0 lds
  buffer_load_dwordx4 v21, s[48:51], s98 offen offset:1024 lds
  buffer_load_dwordx4 v22, s[48:51], s98 offen offset:2048 lds
  buffer_load_dwordx4 v23, s[48:51], s98 offen offset:3072 lds
  s_add_u32 m0, s92, 0
  s_add_u32 s98, s59, 1152
  buffer_load_dwordx4 v16, s[4:7], s98 offen offset:0 lds
  buffer_load_dwordx4 v17, s[4:7], s98 offen offset:1024 lds
  buffer_load_dwordx4 v18, s[4:7], s98 offen offset:2048 lds
  buffer_load_dwordx4 v19, s[4:7], s98 offen offset:3072 lds
  s_add_u32 m0, s92, 4096
  s_add_u32 s98, s59, 42112
  buffer_load_dwordx4 v16, s[4:7], s98 offen offset:0 lds
  buffer_load_dwordx4 v17, s[4:7], s98 offen offset:1024 lds
  buffer_load_dwordx4 v18, s[4:7], s98 offen offset:2048 lds
  buffer_load_dwordx4 v19, s[4:7], s98 offen offset:3072 lds
  s_add_u32 m0, s92, 8192
  s_add_u32 s98, s59, 83072
  buffer_load_dwordx4 v16, s[4:7], s98 offen offset:0 lds
  buffer_load_dwordx4 v17, s[4:7], s98 offen offset:1024 lds
  buffer_load_dwordx4 v18, s[4:7], s98 offen offset:2048 lds
  buffer_load_dwordx4 v19, s[4:7], s98 offen offset:3072 lds
  s_add_u32 m0, s92, 12288
  s_add_u32 s98, s59, 124032
  buffer_load_dwordx4 v16, s[4:7], s98 offen offset:0 lds
  s_add_u32 m0, s93, 4096
  s_add_u32 s98, s60, 1867776
  buffer_load_dwordx4 v20, s[48:51], s98 offen offset:0 lds
  buffer_load_dwordx4 v21, s[48:51], s98 offen offset:1024 lds
  buffer_load_dwordx4 v22, s[48:51], s98 offen offset:2048 lds
  buffer_load_dwordx4 v23, s[48:51], s98 offen offset:3072 lds
L_noiss_22:
  s_mov_b32 m0, 141568
  s_mov_b32 s97, 15794176
  buffer_load_dwordx4 v25, s[20:23], s97 offen offset:0 sc1 lds
  buffer_load_dwordx4 v25, s[20:23], s97 offen offset:1024 sc1 lds
  buffer_load_dwordx4 v25, s[20:23], s97 offen offset:2048 sc1 lds
  buffer_load_dwordx4 v25, s[20:23], s97 offen offset:3072 sc1 lds
  s_mov_b32 m0, 145664
  s_mov_b32 s97, 15798272
  buffer_load_dwordx4 v25, s[20:23], s97 offen offset:0 sc1 lds
  buffer_load_dwordx4 v25, s[20:23], s97 offen offset:1024 sc1 lds
  buffer_load_dwordx4 v25, s[20:23], s97 offen offset:2048 sc1 lds
  buffer_load_dwordx4 v25, s[20:23], s97 offen offset:3072 sc1 lds
  s_mov_b32 m0, 149760
  s_mov_b32 s97, 15802368
  buffer_load_dwordx4 v25, s[20:23], s97 offen offset:0 sc1 lds
  buffer_load_dwordx4 v25, s[20:23], s97 offen offset:1024 sc1 lds
  buffer_load_dwordx4 v25, s[20:23], s97 offen offset:2048 sc1 lds
  buffer_load_dwordx4 v25, s[20:23], s97 offen offset:3072 sc1 lds
  s_mov_b32 m0, 153856
  s_mov_b32 s97, 15806464
  buffer_load_dwordx4 v25, s[20:23], s97 offen offset:0 sc1 lds
  buffer_load_dwordx4 v25, s[20:23], s97 offen offset:1024 sc1 lds
  buffer_load_dwordx4 v25, s[20:23], s97 offen offset:2048 sc1 lds
  buffer_load_dwordx4 v25, s[20:23], s97 offen offset:3072 sc1 lds
  s_waitcnt vmcnt(37)
  s_barrier
  s_waitcnt vmcnt(16)
  s_barrier
  s_waitcnt vmcnt(0)
  v_mov_b32 v5, 163776
  v_mov_b32 v6, 1
  ds_write_b32 v5, v6 offset:12
  s_branch L_q_23
L_nocs_20:
  s_barrier
L_q_23:
  v_lshlrev_b32 v2, 4, v0
  s_mul_i32 s58, s81, 245760
  s_add_u32 s58, s58, 6291456
  v_mov_b32 v5, 163776
  v_mov_b32 v6, 1
  s_and_b32 s65, s56, 7
  s_mul_i32 s65, s65, 3
  s_lshr_b32 s96, s56, 3
  s_mul_i32 s96, s96, 7
  s_add_u32 s65, s65, s96
  s_cmp_ge_u32 s65, 24
  s_cselect_b32 s96, 24, 0
  s_sub_u32 s65, s65, s96
  s_mov_b32 s65, 0
  s_mov_b32 s66, s65
  s_cmp_ge_u32 s56, 30
  s_cselect_b32 s98, 0, 8
  s_cmp_eq_u32 s3, 1
  s_cbranch_scc1 L_p2l1_24
L_pq_25:
  ds_read_b32 v12, v5 offset:16
  s_sleep 1
  s_waitcnt lgkmcnt(0)
  v_readfirstlane_b32 s97, v12
  s_cmp_ge_u32 s97, s98
  s_cbranch_scc0 L_pq_25
  s_mul_i32 s67, s65, 10240
  s_add_u32 s67, s67, s58
  s_add_u32 s65, s65, 1
  s_cmp_eq_u32 s65, 24
  s_cselect_b32 s65, 0, s65
  s_mov_b32 m0, 0
  s_add_u32 s97, s67, 0
  buffer_load_dwordx4 v2, s[20:23], s97 offen offset:0 sc1 lds
  buffer_load_dwordx4 v2, s[20:23], s97 offen offset:1024 sc1 lds
  buffer_load_dwordx4 v2, s[20:23], s97 offen offset:2048 sc1 lds
  buffer_load_dwordx4 v2, s[20:23], s97 offen offset:3072 sc1 lds
  s_mov_b32 m0, 4096
  s_add_u32 s97, s67, 4096
  buffer_load_dwordx4 v2, s[20:23], s97 offen offset:0 sc1 lds
  buffer_load_dwordx4 v2, s[20:23], s97 offen offset:1024 sc1 lds
  buffer_load_dwordx4 v2, s[20:23], s97 offen offset:2048 sc1 lds
  buffer_load_dwordx4 v2, s[20:23], s97 offen offset:3072 sc1 lds
  s_mov_b32 m0, 8192
  s_add_u32 s97, s67, 8192
  buffer_load_dwordx4 v2, s[20:23], s97 offen offset:0 sc1 lds
  s_mul_i32 s67, s65, 10240
  s_add_u32 s67, s67, s58
  s_add_u32 s65, s65, 1
  s_cmp_eq_u32 s65, 24
  s_cselect_b32 s65, 0, s65
  s_mov_b32 m0, 10240
  s_add_u32 s97, s67, 0
  buffer_load_dwordx4 v2, s[20:23], s97 offen offset:0 sc1 lds
  buffer_load_dwordx4 v2, s[20:23], s97 offen offset:1024 sc1 lds
  buffer_load_dwordx4 v2, s[20:23], s97 offen offset:2048 sc1 lds
  buffer_load_dwordx4 v2, s[20:23], s97 offen offset:3072 sc1 lds
  s_mov_b32 m0, 14336
  s_add_u32 s97, s67, 4096
  buffer_load_dwordx4 v2, s[20:23], s97 offen offset:0 sc1 lds
  buffer_load_dwordx4 v2, s[20:23], s97 offen offset:1024 sc1 lds
  buffer_load_dwordx4 v2, s[20:23], s97 offen offset:2048 sc1 lds
  buffer_load_dwordx4 v2, s[20:23], s97 offen offset:3072 sc1 lds
  s_mov_b32 m0, 18432
  s_add_u32 s97, s67, 8192
  buffer_load_dwordx4 v2, s[20:23], s97 offen offset:0 sc1 lds
  s_mul_i32 s67, s65, 10240
  s_add_u32 s67, s67, s58
  s_add_u32 s65, s65, 1
  s_cmp_eq_u32 s65, 24
  s_cselect_b32 s65, 0, s65
  s_mov_b32 m0, 20480
  s_add_u32 s97, s67, 0
  buffer_load_dwordx4 v2, s[20:23], s97 offen offset:0 sc1 lds
  buffer_load_dwordx4 v2, s[20:23], s97 offen offset:1024 sc1 lds
  buffer_load_dwordx4 v2, s[20:23], s97 offen offset:2048 sc1 lds
  buffer_load_dwordx4 v2, s[20:23], s97 offen offset:3072 sc1 lds
  s_mov_b32 m0, 24576
  s_add_u32 s97, s67, 4096
  buffer_load_dwordx4 v2, s[20:23], s97 offen offset:0 sc1 lds
  buffer_load_dwordx4 v2, s[20:23], s97 offen offset:1024 sc1 lds
  buffer_load_dwordx4 v2, s[20:23], s97 offen offset:2048 sc1 lds
  buffer_load_dwordx4 v2, s[20:23], s97 offen offset:3072 sc1 lds
  s_mov_b32 m0, 28672
  s_add_u32 s97, s67, 8192
  buffer_load_dwordx4 v2, s[20:23], s97 offen offset:0 sc1 lds
  s_mul_i32 s67, s65, 10240
  s_add_u32 s67, s67, s58
  s_add_u32 s65, s65, 1
  s_cmp_eq_u32 s65, 24
  s_cselect_b32 s65, 0, s65
  s_mov_b32 m0, 30720
  s_add_u32 s97, s67, 0
  buffer_load_dwordx4 v2, s[20:23], s97 offen offset:0 sc1 lds
  buffer_load_dwordx4 v2, s[20:23], s97 offen offset:1024 sc1 lds
  buffer_load_dwordx4 v2, s[20:23], s97 offen offset:2048 sc1 lds
  buffer_load_dwordx4 v2, s[20:23], s97 offen offset:3072 sc1 lds
  s_mov_b32 m0, 34816
  s_add_u32 s97, s67, 4096
  buffer_load_dwordx4 v2, s[20:23], s97 offen offset:0 sc1 lds
  buffer_load_dwordx4 v2, s[20:23], s97 offen offset:1024 sc1 lds
  buffer_load_dwordx4 v2, s[20:23], s97 offen offset:2048 sc1 lds
  buffer_load_dwordx4 v2, s[20:23], s97 offen offset:3072 sc1 lds
  s_mov_b32 m0, 38912
  s_add_u32 s97, s67, 8192
  buffer_load_dwordx4 v2, s[20:23], s97 offen offset:0 sc1 lds
  s_mul_i32 s67, s65, 10240
  s_add_u32 s67, s67, s58
  s_add_u32 s65, s65, 1
  s_cmp_eq_u32 s65, 24
  s_cselect_b32 s65, 0, s65
  s_mov_b32 m0, 40960
  s_add_u32 s97, s67, 0
  buffer_load_dwordx4 v2, s[20:23], s97 offen offset:0 sc1 lds
  buffer_load_dwordx4 v2, s[20:23], s97 offen offset:1024 sc1 lds
  buffer_load_dwordx4 v2, s[20:23], s97 offen offset:2048 sc1 lds
  buffer_load_dwordx4 v2, s[20:23], s97 offen offset:3072 sc1 lds
  s_mov_b32 m0, 45056
  s_add_u32 s97, s67, 4096
  buffer_load_dwordx4 v2, s[20:23], s97 offen offset:0 sc1 lds
  buffer_load_dwordx4 v2, s[20:23], s97 offen offset:1024 sc1 lds
  buffer_load_dwordx4 v2, s[20:23], s97 offen offset:2048 sc1 lds
  buffer_load_dwordx4 v2, s[20:23], s97 offen offset:3072 sc1 lds
  s_mov_b32 m0, 49152
  s_add_u32 s97, s67, 8192
  buffer_load_dwordx4 v2, s[20:23], s97 offen offset:0 sc1 lds
  s_mul_i32 s67, s65, 10240
  s_add_u32 s67, s67, s58
  s_add_u32 s65, s65, 1
  s_cmp_eq_u32 s65, 24
  s_cselect_b32 s65, 0, s65
  s_mov_b32 m0, 51200
  s_add_u32 s97, s67, 0
  buffer_load_dwordx4 v2, s[20:23], s97 offen offset:0 sc1 lds
  buffer_load_dwordx4 v2, s[20:23], s97 offen offset:1024 sc1 lds
  buffer_load_dwordx4 v2, s[20:23], s97 offen offset:2048 sc1 lds
  buffer_load_dwordx4 v2, s[20:23], s97 offen offset:3072 sc1 lds
  s_mov_b32 m0, 55296
  s_add_u32 s97, s67, 4096
  buffer_load_dwordx4 v2, s[20:23], s97 offen offset:0 sc1 lds
  buffer_load_dwordx4 v2, s[20:23], s97 offen offset:1024 sc1 lds
  buffer_load_dwordx4 v2, s[20:23], s97 offen offset:2048 sc1 lds
  buffer_load_dwordx4 v2, s[20:23], s97 offen offset:3072 sc1 lds
  s_mov_b32 m0, 59392
  s_add_u32 s97, s67, 8192
  buffer_load_dwordx4 v2, s[20:23], s97 offen offset:0 sc1 lds
  s_waitcnt vmcnt(0)
  s_barrier
  s_mul_i32 s67, s65, 10240
  s_add_u32 s67, s67, s58
  s_add_u32 s65, s65, 1
  s_cmp_eq_u32 s65, 24
  s_cselect_b32 s65, 0, s65
  s_mov_b32 m0, 61440
  s_add_u32 s97, s67, 0
  buffer_load_dwordx4 v2, s[20:23], s97 offen offset:0 sc1 lds
  buffer_load_dwordx4 v2, s[20:23], s97 offen offset:1024 sc1 lds
  buffer_load_dwordx4 v2, s[20:23], s97 offen offset:2048 sc1 lds
  buffer_load_dwordx4 v2, s[20:23], s97 offen offset:3072 sc1 lds
  s_mov_b32 m0, 65536
  s_add_u32 s97, s67, 4096
  buffer_load_dwordx4 v2, s[20:23], s97 offen offset:0 sc1 lds
  buffer_load_dwordx4 v2, s[20:23], s97 offen offset:1024 sc1 lds
  buffer_load_dwordx4 v2, s[20:23], s97 offen offset:2048 sc1 lds
  buffer_load_dwordx4 v2, s[20:23], s97 offen offset:3072 sc1 lds
  s_mov_b32 m0, 69632
  s_add_u32 s97, s67, 8192
  buffer_load_dwordx4 v2, s[20:23], s97 offen offset:0 sc1 lds
  s_mul_i32 s67, s65, 10240
  s_add_u32 s67, s67, s58
  s_add_u32 s65, s65, 1
  s_cmp_eq_u32 s65, 24
  s_cselect_b32 s65, 0, s65
  s_mov_b32 m0, 71680
  s_add_u32 s97, s67, 0
  buffer_load_dwordx4 v2, s[20:23], s97 offen offset:0 sc1 lds
  buffer_load_dwordx4 v2, s[20:23], s97 offen offset:1024 sc1 lds
  buffer_load_dwordx4 v2, s[20:23], s97 offen offset:2048 sc1 lds
  buffer_load_dwordx4 v2, s[20:23], s97 offen offset:3072 sc1 lds
  s_mov_b32 m0, 75776
  s_add_u32 s97, s67, 4096
  buffer_load_dwordx4 v2, s[20:23], s97 offen offset:0 sc1 lds
  buffer_load_dwordx4 v2, s[20:23], s97 offen offset:1024 sc1 lds
  buffer_load_dwordx4 v2, s[20:23], s97 offen offset:2048 sc1 lds
  buffer_load_dwordx4 v2, s[20:23], s97 offen offset:3072 sc1 lds
  s_mov_b32 m0, 79872
  s_add_u32 s97, s67, 8192
  buffer_load_dwordx4 v2, s[20:23], s97 offen offset:0 sc1 lds
  s_barrier
  s_waitcnt vmcnt(54)
  s_barrier
  s_mul_i32 s67, s65, 10240
  s_add_u32 s67, s67, s58
  s_add_u32 s65, s65, 1
  s_cmp_eq_u32 s65, 24
  s_cselect_b32 s65, 0, s65
  s_mov_b32 m0, 0
  s_add_u32 s97, s67, 0
  buffer_load_dwordx4 v2, s[20:23], s97 offen offset:0 sc1 lds
  buffer_load_dwordx4 v2, s[20:23], s97 offen offset:1024 sc1 lds
  buffer_load_dwordx4 v2, s[20:23], s97 offen offset:2048 sc1 lds
  buffer_load_dwordx4 v2, s[20:23], s97 offen offset:3072 sc1 lds
  s_mov_b32 m0, 4096
  s_add_u32 s97, s67, 4096
  buffer_load_dwordx4 v2, s[20:23], s97 offen offset:0 sc1 lds
  buffer_load_dwordx4 v2, s[20:23], s97 offen offset:1024 sc1 lds
  buffer_load_dwordx4 v2, s[20:23], s97 offen offset:2048 sc1 lds
  buffer_load_dwordx4 v2, s[20:23], s97 offen offset:3072 sc1 lds
  s_mov_b32 m0, 8192
  s_add_u32 s97, s67, 8192
  buffer_load_dwordx4 v2, s[20:23], s97 offen offset:0 sc1 lds
  s_waitcnt vmcnt(54)
  s_barrier
  s_mul_i32 s67, s65, 10240
  s_add_u32 s67, s67, s58
  s_add_u32 s65, s65, 1
  s_cmp_eq_u32 s65, 24
  s_cselect_b32 s65, 0, s65
  s_mov_b32 m0, 10240
  s_add_u32 s97, s67, 0
  buffer_load_dwordx4 v2, s[20:23], s97 offen offset:0 sc1 lds
  buffer_load_dwordx4 v2, s[20:23], s97 offen offset:1024 sc1 lds
  buffer_load_dwordx4 v2, s[20:23], s97 offen offset:2048 sc1 lds
  buffer_load_dwordx4 v2, s[20:23], s97 offen offset:3072 sc1 lds
  s_mov_b32 m0, 14336
  s_add_u32 s97, s67, 4096
  buffer_load_dwordx4 v2, s[20:23], s97 offen offset:0 sc1 lds
  buffer_load_dwordx4 v2, s[20:23], s97 offen offset:1024 sc1 lds
  buffer_load_dwordx4 v2, s[20:23], s97 offen offset:2048 sc1 lds
  buffer_load_dwordx4 v2, s[20:23], s97 offen offset:3072 sc1 lds
  s_mov_b32 m0, 18432
  s_add_u32 s97, s67, 8192
  buffer_load_dwordx4 v2, s[20:23], s97 offen offset:0 sc1 lds
  s_waitcnt vmcnt(54)
  s_barrier
  s_mul_i32 s67, s65, 10240
  s_add_u32 s67, s67, s58
  s_add_u32 s65, s65, 1
  s_cmp_eq_u32 s65, 24
  s_cselect_b32 s65, 0, s65
  s_mov_b32 m0, 20480
  s_add_u32 s97, s67, 0
  buffer_load_dwordx4 v2, s[20:23], s97 offen offset:0 sc1 lds
  buffer_load_dwordx4 v2, s[20:23], s97 offen offset:1024 sc1 lds
  buffer_load_dwordx4 v2, s[20:23], s97 offen offset:2048 sc1 lds
  buffer_load_dwordx4 v2, s[20:23], s97 offen offset:3072 sc1 lds
  s_mov_b32 m0, 24576
  s_add_u32 s97, s67, 4096
  buffer_load_dwordx4 v2, s[20:23], s97 offen offset:0 sc1 lds
  buffer_load_dwordx4 v2, s[20:23], s97 offen offset:1024 sc1 lds
  buffer_load_dwordx4 v2, s[20:23], s97 offen offset:2048 sc1 lds
  buffer_load_dwordx4 v2, s[20:23], s97 offen offset:3072 sc1 lds
  s_mov_b32 m0, 28672
  s_add_u32 s97, s67, 8192
  buffer_load_dwordx4 v2, s[20:23], s97 offen offset:0 sc1 lds
  s_waitcnt vmcnt(54)
  s_barrier
  s_mul_i32 s67, s65, 10240
  s_add_u32 s67, s67, s58
  s_add_u32 s65, s65, 1
  s_cmp_eq_u32 s65, 24
  s_cselect_b32 s65, 0, s65
  s_mov_b32 m0, 30720
  s_add_u32 s97, s67, 0
  buffer_load_dwordx4 v2, s[20:23], s97 offen offset:0 sc1 lds
  buffer_load_dwordx4 v2, s[20:23], s97 offen offset:1024 sc1 lds
  buffer_load_dwordx4 v2, s[20:23], s97 offen offset:2048 sc1 lds
  buffer_load_dwordx4 v2, s[20:23], s97 offen offset:3072 sc1 lds
  s_mov_b32 m0, 34816
  s_add_u32 s97, s67, 4096
  buffer_load_dwordx4 v2, s[20:23], s97 offen offset:0 sc1 lds
  buffer_load_dwordx4 v2, s[20:23], s97 offen offset:1024 sc1 lds
  buffer_load_dwordx4 v2, s[20:23], s97 offen offset:2048 sc1 lds
  buffer_load_dwordx4 v2, s[20:23], s97 offen offset:3072 sc1 lds
  s_mov_b32 m0, 38912
  s_add_u32 s97, s67, 8192
  buffer_load_dwordx4 v2, s[20:23], s97 offen offset:0 sc1 lds
  s_waitcnt vmcnt(54)
  s_barrier
  s_mul_i32 s67, s65, 10240
  s_add_u32 s67, s67, s58
  s_add_u32 s65, s65, 1
  s_cmp_eq_u32 s65, 24
  s_cselect_b32 s65, 0, s65
  s_mov_b32 m0, 40960
  s_add_u32 s97, s67, 0
  buffer_load_dwordx4 v2, s[20:23], s97 offen offset:0 sc1 lds
  buffer_load_dwordx4 v2, s[20:23], s97 offen offset:1024 sc1 lds
  buffer_load_dwordx4 v2, s[20:23], s97 offen offset:2048 sc1 lds
  buffer_load_dwordx4 v2, s[20:23], s97 offen offset:3072 sc1 lds
  s_mov_b32 m0, 45056
  s_add_u32 s97, s67, 4096
  buffer_load_dwordx4 v2, s[20:23], s97 offen offset:0 sc1 lds
  buffer_load_dwordx4 v2, s[20:23], s97 offen offset:1024 sc1 lds
  buffer_load_dwordx4 v2, s[20:23], s97 offen offset:2048 sc1 lds
  buffer_load_dwordx4 v2, s[20:23], s97 offen offset:3072 sc1 lds
  s_mov_b32 m0, 49152
  s_add_u32 s97, s67, 8192
  buffer_load_dwordx4 v2, s[20:23], s97 offen offset:0 sc1 lds
  s_waitcnt vmcnt(54)
  s_barrier
  s_mul_i32 s67, s65, 10240
  s_add_u32 s67, s67, s58
  s_add_u32 s65, s65, 1
  s_cmp_eq_u32 s65, 24
  s_cselect_b32 s65, 0, s65
  s_mov_b32 m0, 51200
  s_add_u32 s97, s67, 0
  buffer_load_dwordx4 v2, s[20:23], s97 offen offset:0 sc1 lds
  buffer_load_dwordx4 v2, s[20:23], s97 offen offset:1024 sc1 lds
  buffer_load_dwordx4 v2, s[20:23], s97 offen offset:2048 sc1 lds
  buffer_load_dwordx4 v2, s[20:23], s97 offen offset:3072 sc1 lds
  s_mov_b32 m0, 55296
  s_add_u32 s97, s67, 4096
  buffer_load_dwordx4 v2, s[20:23], s97 offen offset:0 sc1 lds
  buffer_load_dwordx4 v2, s[20:23], s97 offen offset:1024 sc1 lds
  buffer_load_dwordx4 v2, s[20:23], s97 offen offset:2048 sc1 lds
  buffer_load_dwordx4 v2, s[20:23], s97 offen offset:3072 sc1 lds
  s_mov_b32 m0, 59392
  s_add_u32 s97, s67, 8192
  buffer_load_dwordx4 v2, s[20:23], s97 offen offset:0 sc1 lds
  s_waitcnt vmcnt(54)
  s_barrier
  s_mul_i32 s67, s65, 10240
  s_add_u32 s67, s67, s58
  s_add_u32 s65, s65, 1
  s_cmp_eq_u32 s65, 24
  s_cselect_b32 s65, 0, s65
  s_mov_b32 m0, 61440
  s_add_u32 s97, s67, 0
  buffer_load_dwordx4 v2, s[20:23], s97 offen offset:0 sc1 lds
  buffer_load_dwordx4 v2, s[20:23], s97 offen offset:1024 sc1 lds
  buffer_load_dwordx4 v2, s[20:23], s97 offen offset:2048 sc1 lds
  buffer_load_dwordx4 v2, s[20:23], s97 offen offset:3072 sc1 lds
  s_mov_b32 m0, 65536
  s_add_u32 s97, s67, 4096
  buffer_load_dwordx4 v2, s[20:23], s97 offen offset:0 sc1 lds
  buffer_load_dwordx4 v2, s[20:23], s97 offen offset:1024 sc1 lds
  buffer_load_dwordx4 v2, s[20:23], s97 offen offset:2048 sc1 lds
  buffer_load_dwordx4 v2, s[20:23], s97 offen offset:3072 sc1 lds
  s_mov_b32 m0, 69632
  s_add_u32 s97, s67, 8192
  buffer_load_dwordx4 v2, s[20:23], s97 offen offset:0 sc1 lds
  s_waitcnt vmcnt(54)
  s_barrier
  s_mul_i32 s67, s65, 10240
  s_add_u32 s67, s67, s58
  s_add_u32 s65, s65, 1
  s_cmp_eq_u32 s65, 24
  s_cselect_b32 s65, 0, s65
  s_mov_b32 m0, 71680
  s_add_u32 s97, s67, 0
  buffer_load_dwordx4 v2, s[20:23], s97 offen offset:0 sc1 lds
  buffer_load_dwordx4 v2, s[20:23], s97 offen offset:1024 sc1 lds
  buffer_load_dwordx4 v2, s[20:23], s97 offen offset:2048 sc1 lds
  buffer_load_dwordx4 v2, s[20:23], s97 offen offset:3072 sc1 lds
  s_mov_b32 m0, 75776
  s_add_u32 s97, s67, 4096
  buffer_load_dwordx4 v2, s[20:23], s97 offen offset:0 sc1 lds
  buffer_load_dwordx4 v2, s[20:23], s97 offen offset:1024 sc1 lds
  buffer_load_dwordx4 v2, s[20:23], s97 offen offset:2048 sc1 lds
  buffer_load_dwordx4 v2, s[20:23], s97 offen offset:3072 sc1 lds
  s_mov_b32 m0, 79872
  s_add_u32 s97, s67, 8192
  buffer_load_dwordx4 v2, s[20:23], s97 offen offset:0 sc1 lds
  s_waitcnt vmcnt(54)
  s_barrier
  s_mul_i32 s67, s65, 10240
  s_add_u32 s67, s67, s58
  s_add_u32 s65, s65, 1
  s_cmp_eq_u32 s65, 24
  s_cselect_b32 s65, 0, s65
  s_mov_b32 m0, 0
  s_add_u32 s97, s67, 0
  buffer_load_dwordx4 v2, s[20:23], s97 offen offset:0 sc1 lds
  buffer_load_dwordx4 v2, s[20:23], s97 offen offset:1024 sc1 lds
  buffer_load_dwordx4 v2, s[20:23], s97 offen offset:2048 sc1 lds
  buffer_load_dwordx4 v2, s[20:23], s97 offen offset:3072 sc1 lds
  s_mov_b32 m0, 4096
  s_add_u32 s97, s67, 4096
  buffer_load_dwordx4 v2, s[20:23], s97 offen offset:0 sc1 lds
  buffer_load_dwordx4 v2, s[20:23], s97 offen offset:1024 sc1 lds
  buffer_load_dwordx4 v2, s[20:23], s97 offen offset:2048 sc1 lds
  buffer_load_dwordx4 v2, s[20:23], s97 offen offset:3072 sc1 lds
  s_mov_b32 m0, 8192
  s_add_u32 s97, s67, 8192
  buffer_load_dwordx4 v2, s[20:23], s97 offen offset:0 sc1 lds
  s_waitcnt vmcnt(54)
  s_barrier
  s_mul_i32 s67, s65, 10240
  s_add_u32 s67, s67, s58
  s_add_u32 s65, s65, 1
  s_cmp_eq_u32 s65, 24
  s_cselect_b32 s65, 0, s65
  s_mov_b32 m0, 10240
  s_add_u32 s97, s67, 0
  buffer_load_dwordx4 v2, s[20:23], s97 offen offset:0 sc1 lds
  buffer_load_dwordx4 v2, s[20:23], s97 offen offset:1024 sc1 lds
  buffer_load_dwordx4 v2, s[20:23], s97 offen offset:2048 sc1 lds
  buffer_load_dwordx4 v2, s[20:23], s97 offen offset:3072 sc1 lds
  s_mov_b32 m0, 14336
  s_add_u32 s97, s67, 4096
  buffer_load_dwordx4 v2, s[20:23], s97 offen offset:0 sc1 lds
  buffer_load_dwordx4 v2, s[20:23], s97 offen offset:1024 sc1 lds
  buffer_load_dwordx4 v2, s[20:23], s97 offen offset:2048 sc1 lds
  buffer_load_dwordx4 v2, s[20:23], s97 offen offset:3072 sc1 lds
  s_mov_b32 m0, 18432
  s_add_u32 s97, s67, 8192
  buffer_load_dwordx4 v2, s[20:23], s97 offen offset:0 sc1 lds
  s_waitcnt vmcnt(54)
  s_barrier
  s_mul_i32 s67, s65, 10240
  s_add_u32 s67, s67, s58
  s_add_u32 s65, s65, 1
  s_cmp_eq_u32 s65, 24
  s_cselect_b32 s65, 0, s65
  s_mov_b32 m0, 20480
  s_add_u32 s97, s67, 0
  buffer_load_dwordx4 v2, s[20:23], s97 offen offset:0 sc1 lds
  buffer_load_dwordx4 v2, s[20:23], s97 offen offset:1024 sc1 lds
  buffer_load_dwordx4 v2, s[20:23], s97 offen offset:2048 sc1 lds
  buffer_load_dwordx4 v2, s[20:23], s97 offen offset:3072 sc1 lds
  s_mov_b32 m0, 24576
  s_add_u32 s97, s67, 4096
  buffer_load_dwordx4 v2, s[20:23], s97 offen offset:0 sc1 lds
  buffer_load_dwordx4 v2, s[20:23], s97 offen offset:1024 sc1 lds
  buffer_load_dwordx4 v2, s[20:23], s97 offen offset:2048 sc1 lds
  buffer_load_dwordx4 v2, s[20:23], s97 offen offset:3072 sc1 lds
  s_mov_b32 m0, 28672
  s_add_u32 s97, s67, 8192
  buffer_load_dwordx4 v2, s[20:23], s97 offen offset:0 sc1 lds
  s_waitcnt vmcnt(54)
  s_barrier
  s_mul_i32 s67, s65, 10240
  s_add_u32 s67, s67, s58
  s_add_u32 s65, s65, 1
  s_cmp_eq_u32 s65, 24
  s_cselect_b32 s65, 0, s65
  s_mov_b32 m0, 30720
  s_add_u32 s97, s67, 0
  buffer_load_dwordx4 v2, s[20:23], s97 offen offset:0 sc1 lds
  buffer_load_dwordx4 v2, s[20:23], s97 offen offset:1024 sc1 lds
  buffer_load_dwordx4 v2, s[20:23], s97 offen offset:2048 sc1 lds
  buffer_load_dwordx4 v2, s[20:23], s97 offen offset:3072 sc1 lds
  s_mov_b32 m0, 34816
  s_add_u32 s97, s67, 4096
  buffer_load_dwordx4 v2, s[20:23], s97 offen offset:0 sc1 lds
  buffer_load_dwordx4 v2, s[20:23], s97 offen offset:1024 sc1 lds
  buffer_load_dwordx4 v2, s[20:23], s97 offen offset:2048 sc1 lds
  buffer_load_dwordx4 v2, s[20:23], s97 offen offset:3072 sc1 lds
  s_mov_b32 m0, 38912
  s_add_u32 s97, s67, 8192
  buffer_load_dwordx4 v2, s[20:23], s97 offen offset:0 sc1 lds
  s_waitcnt vmcnt(54)
  s_barrier
  s_mul_i32 s67, s65, 10240
  s_add_u32 s67, s67, s58
  s_add_u32 s65, s65, 1
  s_cmp_eq_u32 s65, 24
  s_cselect_b32 s65, 0, s65
  s_mov_b32 m0, 40960
  s_add_u32 s97, s67, 0
  buffer_load_dwordx4 v2, s[20:23], s97 offen offset:0 sc1 lds
  buffer_load_dwordx4 v2, s[20:23], s97 offen offset:1024 sc1 lds
  buffer_load_dwordx4 v2, s[20:23], s97 offen offset:2048 sc1 lds
  buffer_load_dwordx4 v2, s[20:23], s97 offen offset:3072 sc1 lds
  s_mov_b32 m0, 45056
  s_add_u32 s97, s67, 4096
  buffer_load_dwordx4 v2, s[20:23], s97 offen offset:0 sc1 lds
  buffer_load_dwordx4 v2, s[20:23], s97 offen offset:1024 sc1 lds
  buffer_load_dwordx4 v2, s[20:23], s97 offen offset:2048 sc1 lds
  buffer_load_dwordx4 v2, s[20:23], s97 offen offset:3072 sc1 lds
  s_mov_b32 m0, 49152
  s_add_u32 s97, s67, 8192
  buffer_load_dwordx4 v2, s[20:23], s97 offen offset:0 sc1 lds
  s_waitcnt vmcnt(54)
  s_barrier
  s_mul_i32 s67, s65, 10240
  s_add_u32 s67, s67, s58
  s_add_u32 s65, s65, 1
  s_cmp_eq_u32 s65, 24
  s_cselect_b32 s65, 0, s65
  s_mov_b32 m0, 51200
  s_add_u32 s97, s67, 0
  buffer_load_dwordx4 v2, s[20:23], s97 offen offset:0 sc1 lds
  buffer_load_dwordx4 v2, s[20:23], s97 offen offset:1024 sc1 lds
  buffer_load_dwordx4 v2, s[20:23], s97 offen offset:2048 sc1 lds
  buffer_load_dwordx4 v2, s[20:23], s97 offen offset:3072 sc1 lds
  s_mov_b32 m0, 55296
  s_add_u32 s97, s67, 4096
  buffer_load_dwordx4 v2, s[20:23], s97 offen offset:0 sc1 lds
  buffer_load_dwordx4 v2, s[20:23], s97 offen offset:1024 sc1 lds
  buffer_load_dwordx4 v2, s[20:23], s97 offen offset:2048 sc1 lds
  buffer_load_dwordx4 v2, s[20:23], s97 offen offset:3072 sc1 lds
  s_mov_b32 m0, 59392
  s_add_u32 s97, s67, 8192
  buffer_load_dwordx4 v2, s[20:23], s97 offen offset:0 sc1 lds
  s_waitcnt vmcnt(54)
  s_barrier
  s_mul_i32 s67, s65, 10240
  s_add_u32 s67, s67, s58
  s_add_u32 s65, s65, 1
  s_cmp_eq_u32 s65, 24
  s_cselect_b32 s65, 0, s65
  s_mov_b32 m0, 61440
  s_add_u32 s97, s67, 0
  buffer_load_dwordx4 v2, s[20:23], s97 offen offset:0 sc1 lds
  buffer_load_dwordx4 v2, s[20:23], s97 offen offset:1024 sc1 lds
  buffer_load_dwordx4 v2, s[20:23], s97 offen offset:2048 sc1 lds
  buffer_load_dwordx4 v2, s[20:23], s97 offen offset:3072 sc1 lds
  s_mov_b32 m0, 65536
  s_add_u32 s97, s67, 4096
  buffer_load_dwordx4 v2, s[20:23], s97 offen offset:0 sc1 lds
  buffer_load_dwordx4 v2, s[20:23], s97 offen offset:1024 sc1 lds
  buffer_load_dwordx4 v2, s[20:23], s97 offen offset:2048 sc1 lds
  buffer_load_dwordx4 v2, s[20:23], s97 offen offset:3072 sc1 lds
  s_mov_b32 m0, 69632
  s_add_u32 s97, s67, 8192
  buffer_load_dwordx4 v2, s[20:23], s97 offen offset:0 sc1 lds
  s_waitcnt vmcnt(54)
  s_barrier
  s_mul_i32 s67, s65, 10240
  s_add_u32 s67, s67, s58
  s_add_u32 s65, s65, 1
  s_cmp_eq_u32 s65, 24
  s_cselect_b32 s65, 0, s65
  s_mov_b32 m0, 71680
  s_add_u32 s97, s67, 0
  buffer_load_dwordx4 v2, s[20:23], s97 offen offset:0 sc1 lds
  buffer_load_dwordx4 v2, s[20:23], s97 offen offset:1024 sc1 lds
  buffer_load_dwordx4 v2, s[20:23], s97 offen offset:2048 sc1 lds
  buffer_load_dwordx4 v2, s[20:23], s97 offen offset:3072 sc1 lds
  s_mov_b32 m0, 75776
  s_add_u32 s97, s67, 4096
  buffer_load_dwordx4 v2, s[20:23], s97 offen offset:0 sc1 lds
  buffer_load_dwordx4 v2, s[20:23], s97 offen offset:1024 sc1 lds
  buffer_load_dwordx4 v2, s[20:23], s97 offen offset:2048 sc1 lds
  buffer_load_dwordx4 v2, s[20:23], s97 offen offset:3072 sc1 lds
  s_mov_b32 m0, 79872
  s_add_u32 s97, s67, 8192
  buffer_load_dwordx4 v2, s[20:23], s97 offen offset:0 sc1 lds
  s_waitcnt vmcnt(54)
  s_barrier
  s_waitcnt vmcnt(45)
  s_barrier
  s_waitcnt vmcnt(36)
  s_barrier
  s_waitcnt vmcnt(27)
  s_barrier
  s_waitcnt vmcnt(18)
  s_barrier
  s_waitcnt vmcnt(9)
  s_barrier
  s_waitcnt vmcnt(0)
  s_barrier
  s_endpgm
L_p2l1_24:
  v_lshrrev_b32 v3, 3, v0
  v_and_b32 v4, 7, v0
  v_lshlrev_b32 v3, 12, v3
  v_lshl_add_u32 v3, v4, 4, v3
  s_mul_i32 s60, s81, 327680
  s_lshl_b32 s96, s80, 7
  s_add_u32 s60, s60, s96
  s_mul_i32 s59, s80, 196608
  s_add_u32 s59, s59, 0
  s_add_u32 s68, s58, 9216
L_pq_26:
  ds_read_b128 v[8:11], v5
  s_sleep 1
  s_waitcnt lgkmcnt(0)
  v_and_b32 v8, v8, v9
  v_and_b32 v8, v8, v10
  s_nop 0
  v_readfirstlane_b32 s96, v8
  s_cmp_eq_u32 s96, 1
  s_cbranch_scc0 L_pq_26
  s_add_u32 s96, s60, 8257536
  s_mov_b32 m0, 149504
  s_add_u32 s97, s96, 0
  buffer_load_dwordx4 v3, s[20:23], s97 offen sc1 lds
  s_mov_b32 m0, 150528
  s_add_u32 s97, s96, 32768
  buffer_load_dwordx4 v3, s[20:23], s97 offen sc1 lds
  s_mov_b32 m0, 151552
  s_add_u32 s97, s96, 65536
  buffer_load_dwordx4 v3, s[20:23], s97 offen sc1 lds
  s_mov_b32 m0, 152576
  s_add_u32 s97, s96, 98304
  buffer_load_dwordx4 v3, s[20:23], s97 offen sc1 lds
  s_mov_b32 m0, 153600
  s_add_u32 s97, s96, 131072
  buffer_load_dwordx4 v3, s[20:23], s97 offen sc1 lds
  s_mov_b32 m0, 154624
  s_add_u32 s97, s96, 163840
  buffer_load_dwordx4 v3, s[20:23], s97 offen sc1 lds
  s_mov_b32 m0, 155648
  s_add_u32 s97, s96, 196608
  buffer_load_dwordx4 v3, s[20:23], s97 offen sc1 lds
  s_mov_b32 m0, 156672
  s_add_u32 s97, s96, 229376
  buffer_load_dwordx4 v3, s[20:23], s97 offen sc1 lds
  s_mov_b32 m0, 157696
  s_add_u32 s97, s96, 262144
  buffer_load_dwordx4 v3, s[20:23], s97 offen sc1 lds
  s_mov_b32 m0, 158720
  s_add_u32 s97, s96, 294912
  buffer_load_dwordx4 v3, s[20:23], s97 offen sc1 lds
  s_mul_i32 s97, s65, 10240
  s_mov_b32 m0, 9216
  s_add_u32 s97, s97, s68
  buffer_load_dwordx4 v2, s[20:23], s97 offen sc1 lds
  s_add_u32 s65, s65, 1
  s_cmp_eq_u32 s65, 24
  s_cselect_b32 s65, 0, s65
  s_mul_i32 s97, s65, 10240
  s_mov_b32 m0, 19456
  s_add_u32 s97, s97, s68
  buffer_load_dwordx4 v2, s[20:23], s97 offen sc1 lds
  s_add_u32 s65, s65, 1
  s_cmp_eq_u32 s65, 24
  s_cselect_b32 s65, 0, s65
  s_mul_i32 s97, s65, 10240
  s_mov_b32 m0, 29696
  s_add_u32 s97, s97, s68
  buffer_load_dwordx4 v2, s[20:23], s97 offen sc1 lds
  s_add_u32 s65, s65, 1
  s_cmp_eq_u32 s65, 24
  s_cselect_b32 s65, 0, s65
  s_mul_i32 s97, s65, 10240
  s_mov_b32 m0, 39936
  s_add_u32 s97, s97, s68
  buffer_load_dwordx4 v2, s[20:23], s97 offen sc1 lds
  s_add_u32 s65, s65, 1
  s_cmp_eq_u32 s65, 24
  s_cselect_b32 s65, 0, s65
  s_mul_i32 s97, s65, 10240
  s_mov_b32 m0, 50176
  s_add_u32 s97, s97, s68
  buffer_load_dwordx4 v2, s[20:23], s97 offen sc1 lds
  s_add_u32 s65, s65, 1
  s_cmp_eq_u32 s65, 24
  s_cselect_b32 s65, 0, s65
  s_mul_i32 s97, s65, 10240
  s_mov_b32 m0, 60416
  s_add_u32 s97, s97, s68
  buffer_load_dwordx4 v2, s[20:23], s97 offen sc1 lds
  s_add_u32 s65, s65, 1
  s_cmp_eq_u32 s65, 24
  s_cselect_b32 s65, 0, s65
  s_lshl_b32 s96, s80, 6
  s_mul_i32 s97, s96, 5042
  s_lshr_b32 s97, s97, 20
  s_add_u32 s96, s96, 63
  s_mul_i32 s96, s96, 5042
  s_lshr_b32 s96, s96, 20
  s_lshl_b32 s97, s97, 7
  s_lshl_b32 s96, s96, 7
  s_sub_u32 s96, s96, 96
  v_mov_b32 v7, s97
  v_mov_b32 v8, s96
  v_cmp_gt_u32 vcc, 6, v0
  v_lshlrev_b32 v9, 4, v0
  s_nop 0
  v_cndmask_b32 v7, v8, v7, vcc
  v_add_u32 v7, v7, v9
  s_mov_b32 s61, 15888384
  s_mov_b32 s62, 0
  s_mov_b32 s98, 2
  v_add_u32 v10, 32, v5
  s_waitcnt vmcnt(0)
  ds_write_b32 v5, v6 offset:24
L_own_27:
  ds_read_b32 v11, v10
  s_sleep 2
  s_waitcnt lgkmcnt(0)
  v_readfirstlane_b32 s96, v11
  s_cmp_ge_u32 s96, s98
  s_cbranch_scc0 L_own_27
L_hp_28:
  s_mov_b64 exec, 0xfff
  buffer_load_dwordx4 v[12:15], v7, s[20:23], s61 offen sc1
  s_mov_b64 exec, -1
  s_add_u32 s62, s62, 1
  s_waitcnt vmcnt(0)
  v_and_b32 v12, v12, v13
  v_and_b32 v14, v14, v15
  v_and_b32 v12, v12, v14
  v_cmp_eq_u32 vcc, 1, v12
  s_and_b32 s96, vcc_lo, 0xfff
  s_cmp_eq_u32 s96, 0xfff
  s_cbranch_scc1 L_hgo_29
  s_sleep 8
  s_cmp_lt_u32 s62, 200000
  s_cbranch_scc1 L_hp_28
L_hgo_29:
  s_barrier
  s_lshl_b32 s67, s66, 11
  s_add_u32 s67, s67, s59
  s_add_u32 s66, s66, 1
  s_cmp_eq_u32 s66, 24
  s_cselect_b32 s66, 0, s66
  s_mov_b32 m0, 81920
  s_add_u32 s97, s67, 0
  buffer_load_dwordx4 v2, s[20:23], s97 offen offset:0 sc1 lds
  buffer_load_dwordx4 v2, s[20:23], s97 offen offset:1024 sc1 lds
  s_mov_b32 m0, 83968
  s_add_u32 s97, s67, 49152
  buffer_load_dwordx4 v2, s[20:23], s97 offen offset:0 sc1 lds
  buffer_load_dwordx4 v2, s[20:23], s97 offen offset:1024 sc1 lds
  s_mov_b32 m0, 86016
  s_add_u32 s97, s67, 98304
  buffer_load_dwordx4 v2, s[20:23], s97 offen offset:0 sc1 lds
  buffer_load_dwordx4 v2, s[20:23], s97 offen offset:1024 sc1 lds
  s_mov_b32 m0, 88064
  s_add_u32 s97, s67, 147456
  buffer_load_dwordx4 v2, s[20:23], s97 offen offset:0 sc1 lds
  buffer_load_dwordx4 v2, s[20:23], s97 offen offset:1024 sc1 lds
  s_lshl_b32 s67, s66, 11
  s_add_u32 s67, s67, s59
  s_add_u32 s66, s66, 1
  s_cmp_eq_u32 s66, 24
  s_cselect_b32 s66, 0, s66
  s_mov_b32 m0, 90112
  s_add_u32 s97, s67, 0
  buffer_load_dwordx4 v2, s[20:23], s97 offen offset:0 sc1 lds
  buffer_load_dwordx4 v2, s[20:23], s97 offen offset:1024 sc1 lds
  s_mov_b32 m0, 92160
  s_add_u32 s97, s67, 49152
  buffer_load_dwordx4 v2, s[20:23], s97 offen offset:0 sc1 lds
  buffer_load_dwordx4 v2, s[20:23], s97 offen offset:1024 sc1 lds
  s_mov_b32 m0, 94208
  s_add_u32 s97, s67, 98304
  buffer_load_dwordx4 v2, s[20:23], s97 offen offset:0 sc1 lds
  buffer_load_dwordx4 v2, s[20:23], s97 offen offset:1024 sc1 lds
  s_mov_b32 m0, 96256
  s_add_u32 s97, s67, 147456
  buffer_load_dwordx4 v2, s[20:23], s97 offen offset:0 sc1 lds
  buffer_load_dwordx4 v2, s[20:23], s97 offen offset:1024 sc1 lds
  s_lshl_b32 s67, s66, 11
  s_add_u32 s67, s67, s59
  s_add_u32 s66, s66, 1
  s_cmp_eq_u32 s66, 24
  s_cselect_b32 s66, 0, s66
  s_mov_b32 m0, 98304
  s_add_u32 s97, s67, 0
  buffer_load_dwordx4 v2, s[20:23], s97 offen offset:0 sc1 lds
  buffer_load_dwordx4 v2, s[20:23], s97 offen offset:1024 sc1 lds
  s_mov_b32 m0, 100352
  s_add_u32 s97, s67, 49152
  buffer_load_dwordx4 v2, s[20:23], s97 offen offset:0 sc1 lds
  buffer_load_dwordx4 v2, s[20:23], s97 offen offset:1024 sc1 lds
  s_mov_b32 m0, 102400
  s_add_u32 s97, s67, 98304
  buffer_load_dwordx4 v2, s[20:23], s97 offen offset:0 sc1 lds
  buffer_load_dwordx4 v2, s[20:23], s97 offen offset:1024 sc1 lds
  s_mov_b32 m0, 104448
  s_add_u32 s97, s67, 147456
  buffer_load_dwordx4 v2, s[20:23], s97 offen offset:0 sc1 lds
  buffer_load_dwordx4 v2, s[20:23], s97 offen offset:1024 sc1 lds
  s_lshl_b32 s67, s66, 11
  s_add_u32 s67, s67, s59
  s_add_u32 s66, s66, 1
  s_cmp_eq_u32 s66, 24
  s_cselect_b32 s66, 0, s66
  s_mov_b32 m0, 106496
  s_add_u32 s97, s67, 0
  buffer_load_dwordx4 v2, s[20:23], s97 offen offset:0 sc1 lds
  buffer_load_dwordx4 v2, s[20:23], s97 offen offset:1024 sc1 lds
  s_mov_b32 m0, 108544
  s_add_u32 s97, s67, 49152
  buffer_load_dwordx4 v2, s[20:23], s97 offen offset:0 sc1 lds
  buffer_load_dwordx4 v2, s[20:23], s97 offen offset:1024 sc1 lds
  s_mov_b32 m0, 110592
  s_add_u32 s97, s67, 98304
  buffer_load_dwordx4 v2, s[20:23], s97 offen offset:0 sc1 lds
  buffer_load_dwordx4 v2, s[20:23], s97 offen offset:1024 sc1 lds
  s_mov_b32 m0, 112640
  s_add_u32 s97, s67, 147456
  buffer_load_dwordx4 v2, s[20:23], s97 offen offset:0 sc1 lds
  buffer_load_dwordx4 v2, s[20:23], s97 offen offset:1024 sc1 lds
  s_lshl_b32 s67, s66, 11
  s_add_u32 s67, s67, s59
  s_add_u32 s66, s66, 1
  s_cmp_eq_u32 s66, 24
  s_cselect_b32 s66, 0, s66
  s_mov_b32 m0, 114688
  s_add_u32 s97, s67, 0
  buffer_load_dwordx4 v2, s[20:23], s97 offen offset:0 sc1 lds
  buffer_load_dwordx4 v2, s[20:23], s97 offen offset:1024 sc1 lds
  s_mov_b32 m0, 116736
  s_add_u32 s97, s67, 49152
  buffer_load_dwordx4 v2, s[20:23], s97 offen offset:0 sc1 lds
  buffer_load_dwordx4 v2, s[20:23], s97 offen offset:1024 sc1 lds
  s_mov_b32 m0, 118784
  s_add_u32 s97, s67, 98304
  buffer_load_dwordx4 v2, s[20:23], s97 offen offset:0 sc1 lds
  buffer_load_dwordx4 v2, s[20:23], s97 offen offset:1024 sc1 lds
  s_mov_b32 m0, 120832
  s_add_u32 s97, s67, 147456
  buffer_load_dwordx4 v2, s[20:23], s97 offen offset:0 sc1 lds
  buffer_load_dwordx4 v2, s[20:23], s97 offen offset:1024 sc1 lds
  s_lshl_b32 s67, s66, 11
  s_add_u32 s67, s67, s59
  s_add_u32 s66, s66, 1
  s_cmp_eq_u32 s66, 24
  s_cselect_b32 s66, 0, s66
  s_mov_b32 m0, 122880
  s_add_u32 s97, s67, 0
  buffer_load_dwordx4 v2, s[20:23], s97 offen offset:0 sc1 lds
  buffer_load_dwordx4 v2, s[20:23], s97 offen offset:1024 sc1 lds
  s_mov_b32 m0, 124928
  s_add_u32 s97, s67, 49152
  buffer_load_dwordx4 v2, s[20:23], s97 offen offset:0 sc1 lds
  buffer_load_dwordx4 v2, s[20:23], s97 offen offset:1024 sc1 lds
  s_mov_b32 m0, 126976
  s_add_u32 s97, s67, 98304
  buffer_load_dwordx4 v2, s[20:23], s97 offen offset:0 sc1 lds
  buffer_load_dwordx4 v2, s[20:23], s97 offen offset:1024 sc1 lds
  s_mov_b32 m0, 129024
  s_add_u32 s97, s67, 147456
  buffer_load_dwordx4 v2, s[20:23], s97 offen offset:0 sc1 lds
  buffer_load_dwordx4 v2, s[20:23], s97 offen offset:1024 sc1 lds
  s_lshl_b32 s67, s66, 11
  s_add_u32 s67, s67, s59
  s_add_u32 s66, s66, 1
  s_cmp_eq_u32 s66, 24
  s_cselect_b32 s66, 0, s66
  s_mov_b32 m0, 131072
  s_add_u32 s97, s67, 0
  buffer_load_dwordx4 v2, s[20:23], s97 offen offset:0 sc1 lds
  buffer_load_dwordx4 v2, s[20:23], s97 offen offset:1024 sc1 lds
  s_mov_b32 m0, 133120
  s_add_u32 s97, s67, 49152
  buffer_load_dwordx4 v2, s[20:23], s97 offen offset:0 sc1 lds
  buffer_load_dwordx4 v2, s[20:23], s97 offen offset:1024 sc1 lds
  s_mov_b32 m0, 135168
  s_add_u32 s97, s67, 98304
  buffer_load_dwordx4 v2, s[20:23], s97 offen offset:0 sc1 lds
  buffer_load_dwordx4 v2, s[20:23], s97 offen offset:1024 sc1 lds
  s_mov_b32 m0, 137216
  s_add_u32 s97, s67, 147456
  buffer_load_dwordx4 v2, s[20:23], s97 offen offset:0 sc1 lds
  buffer_load_dwordx4 v2, s[20:23], s97 offen offset:1024 sc1 lds
  s_mul_i32 s97, s65, 10240
  s_mov_b32 m0, 70656
  s_add_u32 s97, s97, s68
  buffer_load_dwordx4 v2, s[20:23], s97 offen sc1 lds
  s_add_u32 s65, s65, 1
  s_cmp_eq_u32 s65, 24
  s_cselect_b32 s65, 0, s65
  s_waitcnt vmcnt(49)
  s_barrier
  s_lshl_b32 s67, s66, 11
  s_add_u32 s67, s67, s59
  s_add_u32 s66, s66, 1
  s_cmp_eq_u32 s66, 24
  s_cselect_b32 s66, 0, s66
  s_mov_b32 m0, 139264
  s_add_u32 s97, s67, 0
  buffer_load_dwordx4 v2, s[20:23], s97 offen offset:0 sc1 lds
  buffer_load_dwordx4 v2, s[20:23], s97 offen offset:1024 sc1 lds
  s_mov_b32 m0, 141312
  s_add_u32 s97, s67, 49152
  buffer_load_dwordx4 v2, s[20:23], s97 offen offset:0 sc1 lds
  buffer_load_dwordx4 v2, s[20:23], s97 offen offset:1024 sc1 lds
  s_mov_b32 m0, 143360
  s_add_u32 s97, s67, 98304
  buffer_load_dwordx4 v2, s[20:23], s97 offen offset:0 sc1 lds
  buffer_load_dwordx4 v2, s[20:23], s97 offen offset:1024 sc1 lds
  s_mov_b32 m0, 145408
  s_add_u32 s97, s67, 147456
  buffer_load_dwordx4 v2, s[20:23], s97 offen offset:0 sc1 lds
  buffer_load_dwordx4 v2, s[20:23], s97 offen offset:1024 sc1 lds
  s_mul_i32 s97, s65, 10240
  s_mov_b32 m0, 80896
  s_add_u32 s97, s97, s68
  buffer_load_dwordx4 v2, s[20:23], s97 offen sc1 lds
  s_add_u32 s65, s65, 1
  s_cmp_eq_u32 s65, 24
  s_cselect_b32 s65, 0, s65
  s_waitcnt vmcnt(50)
  s_barrier
  s_lshl_b32 s67, s66, 11
  s_add_u32 s67, s67, s59
  s_add_u32 s66, s66, 1
  s_cmp_eq_u32 s66, 24
  s_cselect_b32 s66, 0, s66
  s_mov_b32 m0, 81920
  s_add_u32 s97, s67, 0
  buffer_load_dwordx4 v2, s[20:23], s97 offen offset:0 sc1 lds
  buffer_load_dwordx4 v2, s[20:23], s97 offen offset:1024 sc1 lds
  s_mov_b32 m0, 83968
  s_add_u32 s97, s67, 49152
  buffer_load_dwordx4 v2, s[20:23], s97 offen offset:0 sc1 lds
  buffer_load_dwordx4 v2, s[20:23], s97 offen offset:1024 sc1 lds
  s_mov_b32 m0, 86016
  s_add_u32 s97, s67, 98304
  buffer_load_dwordx4 v2, s[20:23], s97 offen offset:0 sc1 lds
  buffer_load_dwordx4 v2, s[20:23], s97 offen offset:1024 sc1 lds
  s_mov_b32 m0, 88064
  s_add_u32 s97, s67, 147456
  buffer_load_dwordx4 v2, s[20:23], s97 offen offset:0 sc1 lds
  buffer_load_dwordx4 v2, s[20:23], s97 offen offset:1024 sc1 lds
  s_mul_i32 s97, s65, 10240
  s_mov_b32 m0, 9216
  s_add_u32 s97, s97, s68
  buffer_load_dwordx4 v2, s[20:23], s97 offen sc1 lds
  s_add_u32 s65, s65, 1
  s_cmp_eq_u32 s65, 24
  s_cselect_b32 s65, 0, s65
  s_waitcnt vmcnt(51)
  s_barrier
  s_lshl_b32 s67, s66, 11
  s_add_u32 s67, s67, s59
  s_add_u32 s66, s66, 1
  s_cmp_eq_u32 s66, 24
  s_cselect_b32 s66, 0, s66
  s_mov_b32 m0, 90112
  s_add_u32 s97, s67, 0
  buffer_load_dwordx4 v2, s[20:23], s97 offen offset:0 sc1 lds
  buffer_load_dwordx4 v2, s[20:23], s97 offen offset:1024 sc1 lds
  s_mov_b32 m0, 92160
  s_add_u32 s97, s67, 49152
  buffer_load_dwordx4 v2, s[20:23], s97 offen offset:0 sc1 lds
  buffer_load_dwordx4 v2, s[20:23], s97 offen offset:1024 sc1 lds
  s_mov_b32 m0, 94208
  s_add_u32 s97, s67, 98304
  buffer_load_dwordx4 v2, s[20:23], s97 offen offset:0 sc1 lds
  buffer_load_dwordx4 v2, s[20:23], s97 offen offset:1024 sc1 lds
  s_mov_b32 m0, 96256
  s_add_u32 s97, s67, 147456
  buffer_load_dwordx4 v2, s[20:23], s97 offen offset:0 sc1 lds
  buffer_load_dwordx4 v2, s[20:23], s97 offen offset:1024 sc1 lds
  s_mul_i32 s97, s65, 10240
  s_mov_b32 m0, 19456
  s_add_u32 s97, s97, s68
  buffer_load_dwordx4 v2, s[20:23], s97 offen sc1 lds
  s_add_u32 s65, s65, 1
  s_cmp_eq_u32 s65, 24
  s_cselect_b32 s65, 0, s65
  s_waitcnt vmcnt(52)
  s_barrier
  s_lshl_b32 s67, s66, 11
  s_add_u32 s67, s67, s59
  s_add_u32 s66, s66, 1
  s_cmp_eq_u32 s66, 24
  s_cselect_b32 s66, 0, s66
  s_mov_b32 m0, 98304
  s_add_u32 s97, s67, 0
  buffer_load_dwordx4 v2, s[20:23], s97 offen offset:0 sc1 lds
  buffer_load_dwordx4 v2, s[20:23], s97 offen offset:1024 sc1 lds
  s_mov_b32 m0, 100352
  s_add_u32 s97, s67, 49152
  buffer_load_dwordx4 v2, s[20:23], s97 offen offset:0 sc1 lds
  buffer_load_dwordx4 v2, s[20:23], s97 offen offset:1024 sc1 lds
  s_mov_b32 m0, 102400
  s_add_u32 s97, s67, 98304
  buffer_load_dwordx4 v2, s[20:23], s97 offen offset:0 sc1 lds
  buffer_load_dwordx4 v2, s[20:23], s97 offen offset:1024 sc1 lds
  s_mov_b32 m0, 104448
  s_add_u32 s97, s67, 147456
  buffer_load_dwordx4 v2, s[20:23], s97 offen offset:0 sc1 lds
  buffer_load_dwordx4 v2, s[20:23], s97 offen offset:1024 sc1 lds
  s_mul_i32 s97, s65, 10240
  s_mov_b32 m0, 29696
  s_add_u32 s97, s97, s68
  buffer_load_dwordx4 v2, s[20:23], s97 offen sc1 lds
  s_add_u32 s65, s65, 1
  s_cmp_eq_u32 s65, 24
  s_cselect_b32 s65, 0, s65
  s_waitcnt vmcnt(53)
  s_barrier
  s_lshl_b32 s67, s66, 11
  s_add_u32 s67, s67, s59
  s_add_u32 s66, s66, 1
  s_cmp_eq_u32 s66, 24
  s_cselect_b32 s66, 0, s66
  s_mov_b32 m0, 106496
  s_add_u32 s97, s67, 0
  buffer_load_dwordx4 v2, s[20:23], s97 offen offset:0 sc1 lds
  buffer_load_dwordx4 v2, s[20:23], s97 offen offset:1024 sc1 lds
  s_mov_b32 m0, 108544
  s_add_u32 s97, s67, 49152
  buffer_load_dwordx4 v2, s[20:23], s97 offen offset:0 sc1 lds
  buffer_load_dwordx4 v2, s[20:23], s97 offen offset:1024 sc1 lds
  s_mov_b32 m0, 110592
  s_add_u32 s97, s67, 98304
  buffer_load_dwordx4 v2, s[20:23], s97 offen offset:0 sc1 lds
  buffer_load_dwordx4 v2, s[20:23], s97 offen offset:1024 sc1 lds
  s_mov_b32 m0, 112640
  s_add_u32 s97, s67, 147456
  buffer_load_dwordx4 v2, s[20:23], s97 offen offset:0 sc1 lds
  buffer_load_dwordx4 v2, s[20:23], s97 offen offset:1024 sc1 lds
  s_mul_i32 s97, s65, 10240
  s_mov_b32 m0, 39936
  s_add_u32 s97, s97, s68
  buffer_load_dwordx4 v2, s[20:23], s97 offen sc1 lds
  s_add_u32 s65, s65, 1
  s_cmp_eq_u32 s65, 24
  s_cselect_b32 s65, 0, s65
  s_waitcnt vmcnt(54)
  s_barrier
  s_lshl_b32 s67, s66, 11
  s_add_u32 s67, s67, s59
  s_add_u32 s66, s66, 1
  s_cmp_eq_u32 s66, 24
  s_cselect_b32 s66, 0, s66
  s_mov_b32 m0, 114688
  s_add_u32 s97, s67, 0
  buffer_load_dwordx4 v2, s[20:23], s97 offen offset:0 sc1 lds
  buffer_load_dwordx4 v2, s[20:23], s97 offen offset:1024 sc1 lds
  s_mov_b32 m0, 116736
  s_add_u32 s97, s67, 49152
  buffer_load_dwordx4 v2, s[20:23], s97 offen offset:0 sc1 lds
  buffer_load_dwordx4 v2, s[20:23], s97 offen offset:1024 sc1 lds
  s_mov_b32 m0, 118784
  s_add_u32 s97, s67, 98304
  buffer_load_dwordx4 v2, s[20:23], s97 offen offset:0 sc1 lds
  buffer_load_dwordx4 v2, s[20:23], s97 offen offset:1024 sc1 lds
  s_mov_b32 m0, 120832
  s_add_u32 s97, s67, 147456
  buffer_load_dwordx4 v2, s[20:23], s97 offen offset:0 sc1 lds
  buffer_load_dwordx4 v2, s[20:23], s97 offen offset:1024 sc1 lds
  s_mul_i32 s97, s65, 10240
  s_mov_b32 m0, 50176
  s_add_u32 s97, s97, s68
  buffer_load_dwordx4 v2, s[20:23], s97 offen sc1 lds
  s_add_u32 s65, s65, 1
  s_cmp_eq_u32 s65, 24
  s_cselect_b32 s65, 0, s65
  s_waitcnt vmcnt(54)
  s_barrier
  s_lshl_b32 s67, s66, 11
  s_add_u32 s67, s67, s59
  s_add_u32 s66, s66, 1
  s_cmp_eq_u32 s66, 24
  s_cselect_b32 s66, 0, s66
  s_mov_b32 m0, 122880
  s_add_u32 s97, s67, 0
  buffer_load_dwordx4 v2, s[20:23], s97 offen offset:0 sc1 lds
  buffer_load_dwordx4 v2, s[20:23], s97 offen offset:1024 sc1 lds
  s_mov_b32 m0, 124928
  s_add_u32 s97, s67, 49152
  buffer_load_dwordx4 v2, s[20:23], s97 offen offset:0 sc1 lds
  buffer_load_dwordx4 v2, s[20:23], s97 offen offset:1024 sc1 lds
  s_mov_b32 m0, 126976
  s_add_u32 s97, s67, 98304
  buffer_load_dwordx4 v2, s[20:23], s97 offen offset:0 sc1 lds
  buffer_load_dwordx4 v2, s[20:23], s97 offen offset:1024 sc1 lds
  s_mov_b32 m0, 129024
  s_add_u32 s97, s67, 147456
  buffer_load_dwordx4 v2, s[20:23], s97 offen offset:0 sc1 lds
  buffer_load_dwordx4 v2, s[20:23], s97 offen offset:1024 sc1 lds
  s_mul_i32 s97, s65, 10240
  s_mov_b32 m0, 60416
  s_add_u32 s97, s97, s68
  buffer_load_dwordx4 v2, s[20:23], s97 offen sc1 lds
  s_add_u32 s65, s65, 1
  s_cmp_eq_u32 s65, 24
  s_cselect_b32 s65, 0, s65
  s_waitcnt vmcnt(54)
  s_barrier
  s_lshl_b32 s67, s66, 11
  s_add_u32 s67, s67, s59
  s_add_u32 s66, s66, 1
  s_cmp_eq_u32 s66, 24
  s_cselect_b32 s66, 0, s66
  s_mov_b32 m0, 131072
  s_add_u32 s97, s67, 0
  buffer_load_dwordx4 v2, s[20:23], s97 offen offset:0 sc1 lds
  buffer_load_dwordx4 v2, s[20:23], s97 offen offset:1024 sc1 lds
  s_mov_b32 m0, 133120
  s_add_u32 s97, s67, 49152
  buffer_load_dwordx4 v2, s[20:23], s97 offen offset:0 sc1 lds
  buffer_load_dwordx4 v2, s[20:23], s97 offen offset:1024 sc1 lds
  s_mov_b32 m0, 135168
  s_add_u32 s97, s67, 98304
  buffer_load_dwordx4 v2, s[20:23], s97 offen offset:0 sc1 lds
  buffer_load_dwordx4 v2, s[20:23], s97 offen offset:1024 sc1 lds
  s_mov_b32 m0, 137216
  s_add_u32 s97, s67, 147456
  buffer_load_dwordx4 v2, s[20:23], s97 offen offset:0 sc1 lds
  buffer_load_dwordx4 v2, s[20:23], s97 offen offset:1024 sc1 lds
  s_mul_i32 s97, s65, 10240
  s_mov_b32 m0, 70656
  s_add_u32 s97, s97, s68
  buffer_load_dwordx4 v2, s[20:23], s97 offen sc1 lds
  s_add_u32 s65, s65, 1
  s_cmp_eq_u32 s65, 24
  s_cselect_b32 s65, 0, s65
  s_waitcnt vmcnt(54)
  s_barrier
  s_lshl_b32 s67, s66, 11
  s_add_u32 s67, s67, s59
  s_add_u32 s66, s66, 1
  s_cmp_eq_u32 s66, 24
  s_cselect_b32 s66, 0, s66
  s_mov_b32 m0, 139264
  s_add_u32 s97, s67, 0
  buffer_load_dwordx4 v2, s[20:23], s97 offen offset:0 sc1 lds
  buffer_load_dwordx4 v2, s[20:23], s97 offen offset:1024 sc1 lds
  s_mov_b32 m0, 141312
  s_add_u32 s97, s67, 49152
  buffer_load_dwordx4 v2, s[20:23], s97 offen offset:0 sc1 lds
  buffer_load_dwordx4 v2, s[20:23], s97 offen offset:1024 sc1 lds
  s_mov_b32 m0, 143360
  s_add_u32 s97, s67, 98304
  buffer_load_dwordx4 v2, s[20:23], s97 offen offset:0 sc1 lds
  buffer_load_dwordx4 v2, s[20:23], s97 offen offset:1024 sc1 lds
  s_mov_b32 m0, 145408
  s_add_u32 s97, s67, 147456
  buffer_load_dwordx4 v2, s[20:23], s97 offen offset:0 sc1 lds
  buffer_load_dwordx4 v2, s[20:23], s97 offen offset:1024 sc1 lds
  s_mul_i32 s97, s65, 10240
  s_mov_b32 m0, 80896
  s_add_u32 s97, s97, s68
  buffer_load_dwordx4 v2, s[20:23], s97 offen sc1 lds
  s_add_u32 s65, s65, 1
  s_cmp_eq_u32 s65, 24
  s_cselect_b32 s65, 0, s65
  s_waitcnt vmcnt(54)
  s_barrier
  s_lshl_b32 s67, s66, 11
  s_add_u32 s67, s67, s59
  s_add_u32 s66, s66, 1
  s_cmp_eq_u32 s66, 24
  s_cselect_b32 s66, 0, s66
  s_mov_b32 m0, 81920
  s_add_u32 s97, s67, 0
  buffer_load_dwordx4 v2, s[20:23], s97 offen offset:0 sc1 lds
  buffer_load_dwordx4 v2, s[20:23], s97 offen offset:1024 sc1 lds
  s_mov_b32 m0, 83968
  s_add_u32 s97, s67, 49152
  buffer_load_dwordx4 v2, s[20:23], s97 offen offset:0 sc1 lds
  buffer_load_dwordx4 v2, s[20:23], s97 offen offset:1024 sc1 lds
  s_mov_b32 m0, 86016
  s_add_u32 s97, s67, 98304
  buffer_load_dwordx4 v2, s[20:23], s97 offen offset:0 sc1 lds
  buffer_load_dwordx4 v2, s[20:23], s97 offen offset:1024 sc1 lds
  s_mov_b32 m0, 88064
  s_add_u32 s97, s67, 147456
  buffer_load_dwordx4 v2, s[20:23], s97 offen offset:0 sc1 lds
  buffer_load_dwordx4 v2, s[20:23], s97 offen offset:1024 sc1 lds
  s_mul_i32 s97, s65, 10240
  s_mov_b32 m0, 9216
  s_add_u32 s97, s97, s68
  buffer_load_dwordx4 v2, s[20:23], s97 offen sc1 lds
  s_add_u32 s65, s65, 1
  s_cmp_eq_u32 s65, 24
  s_cselect_b32 s65, 0, s65
  s_waitcnt vmcnt(54)
  s_barrier
  s_lshl_b32 s67, s66, 11
  s_add_u32 s67, s67, s59
  s_add_u32 s66, s66, 1
  s_cmp_eq_u32 s66, 24
  s_cselect_b32 s66, 0, s66
  s_mov_b32 m0, 90112
  s_add_u32 s97, s67, 0
  buffer_load_dwordx4 v2, s[20:23], s97 offen offset:0 sc1 lds
  buffer_load_dwordx4 v2, s[20:23], s97 offen offset:1024 sc1 lds
  s_mov_b32 m0, 92160
  s_add_u32 s97, s67, 49152
  buffer_load_dwordx4 v2, s[20:23], s97 offen offset:0 sc1 lds
  buffer_load_dwordx4 v2, s[20:23], s97 offen offset:1024 sc1 lds
  s_mov_b32 m0, 94208
  s_add_u32 s97, s67, 98304
  buffer_load_dwordx4 v2, s[20:23], s97 offen offset:0 sc1 lds
  buffer_load_dwordx4 v2, s[20:23], s97 offen offset:1024 sc1 lds
  s_mov_b32 m0, 96256
  s_add_u32 s97, s67, 147456
  buffer_load_dwordx4 v2, s[20:23], s97 offen offset:0 sc1 lds
  buffer_load_dwordx4 v2, s[20:23], s97 offen offset:1024 sc1 lds
  s_mul_i32 s97, s65, 10240
  s_mov_b32 m0, 19456
  s_add_u32 s97, s97, s68
  buffer_load_dwordx4 v2, s[20:23], s97 offen sc1 lds
  s_add_u32 s65, s65, 1
  s_cmp_eq_u32 s65, 24
  s_cselect_b32 s65, 0, s65
  s_waitcnt vmcnt(54)
  s_barrier
  s_lshl_b32 s67, s66, 11
  s_add_u32 s67, s67, s59
  s_add_u32 s66, s66, 1
  s_cmp_eq_u32 s66, 24
  s_cselect_b32 s66, 0, s66
  s_mov_b32 m0, 98304
  s_add_u32 s97, s67, 0
  buffer_load_dwordx4 v2, s[20:23], s97 offen offset:0 sc1 lds
  buffer_load_dwordx4 v2, s[20:23], s97 offen offset:1024 sc1 lds
  s_mov_b32 m0, 100352
  s_add_u32 s97, s67, 49152
  buffer_load_dwordx4 v2, s[20:23], s97 offen offset:0 sc1 lds
  buffer_load_dwordx4 v2, s[20:23], s97 offen offset:1024 sc1 lds
  s_mov_b32 m0, 102400
  s_add_u32 s97, s67, 98304
  buffer_load_dwordx4 v2, s[20:23], s97 offen offset:0 sc1 lds
  buffer_load_dwordx4 v2, s[20:23], s97 offen offset:1024 sc1 lds
  s_mov_b32 m0, 104448
  s_add_u32 s97, s67, 147456
  buffer_load_dwordx4 v2, s[20:23], s97 offen offset:0 sc1 lds
  buffer_load_dwordx4 v2, s[20:23], s97 offen offset:1024 sc1 lds
  s_mul_i32 s97, s65, 10240
  s_mov_b32 m0, 29696
  s_add_u32 s97, s97, s68
  buffer_load_dwordx4 v2, s[20:23], s97 offen sc1 lds
  s_add_u32 s65, s65, 1
  s_cmp_eq_u32 s65, 24
  s_cselect_b32 s65, 0, s65
  s_waitcnt vmcnt(54)
  s_barrier
  s_lshl_b32 s67, s66, 11
  s_add_u32 s67, s67, s59
  s_add_u32 s66, s66, 1
  s_cmp_eq_u32 s66, 24
  s_cselect_b32 s66, 0, s66
  s_mov_b32 m0, 106496
  s_add_u32 s97, s67, 0
  buffer_load_dwordx4 v2, s[20:23], s97 offen offset:0 sc1 lds
  buffer_load_dwordx4 v2, s[20:23], s97 offen offset:1024 sc1 lds
  s_mov_b32 m0, 108544
  s_add_u32 s97, s67, 49152
  buffer_load_dwordx4 v2, s[20:23], s97 offen offset:0 sc1 lds
  buffer_load_dwordx4 v2, s[20:23], s97 offen offset:1024 sc1 lds
  s_mov_b32 m0, 110592
  s_add_u32 s97, s67, 98304
  buffer_load_dwordx4 v2, s[20:23], s97 offen offset:0 sc1 lds
  buffer_load_dwordx4 v2, s[20:23], s97 offen offset:1024 sc1 lds
  s_mov_b32 m0, 112640
  s_add_u32 s97, s67, 147456
  buffer_load_dwordx4 v2, s[20:23], s97 offen offset:0 sc1 lds
  buffer_load_dwordx4 v2, s[20:23], s97 offen offset:1024 sc1 lds
  s_mul_i32 s97, s65, 10240
  s_mov_b32 m0, 39936
  s_add_u32 s97, s97, s68
  buffer_load_dwordx4 v2, s[20:23], s97 offen sc1 lds
  s_add_u32 s65, s65, 1
  s_cmp_eq_u32 s65, 24
  s_cselect_b32 s65, 0, s65
  s_waitcnt vmcnt(54)
  s_barrier
  s_lshl_b32 s67, s66, 11
  s_add_u32 s67, s67, s59
  s_add_u32 s66, s66, 1
  s_cmp_eq_u32 s66, 24
  s_cselect_b32 s66, 0, s66
  s_mov_b32 m0, 114688
  s_add_u32 s97, s67, 0
  buffer_load_dwordx4 v2, s[20:23], s97 offen offset:0 sc1 lds
  buffer_load_dwordx4 v2, s[20:23], s97 offen offset:1024 sc1 lds
  s_mov_b32 m0, 116736
  s_add_u32 s97, s67, 49152
  buffer_load_dwordx4 v2, s[20:23], s97 offen offset:0 sc1 lds
  buffer_load_dwordx4 v2, s[20:23], s97 offen offset:1024 sc1 lds
  s_mov_b32 m0, 118784
  s_add_u32 s97, s67, 98304
  buffer_load_dwordx4 v2, s[20:23], s97 offen offset:0 sc1 lds
  buffer_load_dwordx4 v2, s[20:23], s97 offen offset:1024 sc1 lds
  s_mov_b32 m0, 120832
  s_add_u32 s97, s67, 147456
  buffer_load_dwordx4 v2, s[20:23], s97 offen offset:0 sc1 lds
  buffer_load_dwordx4 v2, s[20:23], s97 offen offset:1024 sc1 lds
  s_mul_i32 s97, s65, 10240
  s_mov_b32 m0, 50176
  s_add_u32 s97, s97, s68
  buffer_load_dwordx4 v2, s[20:23], s97 offen sc1 lds
  s_add_u32 s65, s65, 1
  s_cmp_eq_u32 s65, 24
  s_cselect_b32 s65, 0, s65
  s_waitcnt vmcnt(54)
  s_barrier
  s_lshl_b32 s67, s66, 11
  s_add_u32 s67, s67, s59
  s_add_u32 s66, s66, 1
  s_cmp_eq_u32 s66, 24
  s_cselect_b32 s66, 0, s66
  s_mov_b32 m0, 122880
  s_add_u32 s97, s67, 0
  buffer_load_dwordx4 v2, s[20:23], s97 offen offset:0 sc1 lds
  buffer_load_dwordx4 v2, s[20:23], s97 offen offset:1024 sc1 lds
  s_mov_b32 m0, 124928
  s_add_u32 s97, s67, 49152
  buffer_load_dwordx4 v2, s[20:23], s97 offen offset:0 sc1 lds
  buffer_load_dwordx4 v2, s[20:23], s97 offen offset:1024 sc1 lds
  s_mov_b32 m0, 126976
  s_add_u32 s97, s67, 98304
  buffer_load_dwordx4 v2, s[20:23], s97 offen offset:0 sc1 lds
  buffer_load_dwordx4 v2, s[20:23], s97 offen offset:1024 sc1 lds
  s_mov_b32 m0, 129024
  s_add_u32 s97, s67, 147456
  buffer_load_dwordx4 v2, s[20:23], s97 offen offset:0 sc1 lds
  buffer_load_dwordx4 v2, s[20:23], s97 offen offset:1024 sc1 lds
  s_mul_i32 s97, s65, 10240
  s_mov_b32 m0, 60416
  s_add_u32 s97, s97, s68
  buffer_load_dwordx4 v2, s[20:23], s97 offen sc1 lds
  s_add_u32 s65, s65, 1
  s_cmp_eq_u32 s65, 24
  s_cselect_b32 s65, 0, s65
  s_waitcnt vmcnt(54)
  s_barrier
  s_lshl_b32 s67, s66, 11
  s_add_u32 s67, s67, s59
  s_add_u32 s66, s66, 1
  s_cmp_eq_u32 s66, 24
  s_cselect_b32 s66, 0, s66
  s_mov_b32 m0, 131072
  s_add_u32 s97, s67, 0
  buffer_load_dwordx4 v2, s[20:23], s97 offen offset:0 sc1 lds
  buffer_load_dwordx4 v2, s[20:23], s97 offen offset:1024 sc1 lds
  s_mov_b32 m0, 133120
  s_add_u32 s97, s67, 49152
  buffer_load_dwordx4 v2, s[20:23], s97 offen offset:0 sc1 lds
  buffer_load_dwordx4 v2, s[20:23], s97 offen offset:1024 sc1 lds
  s_mov_b32 m0, 135168
  s_add_u32 s97, s67, 98304
  buffer_load_dwordx4 v2, s[20:23], s97 offen offset:0 sc1 lds
  buffer_load_dwordx4 v2, s[20:23], s97 offen offset:1024 sc1 lds
  s_mov_b32 m0, 137216
  s_add_u32 s97, s67, 147456
  buffer_load_dwordx4 v2, s[20:23], s97 offen offset:0 sc1 lds
  buffer_load_dwordx4 v2, s[20:23], s97 offen offset:1024 sc1 lds
  s_mul_i32 s97, s65, 10240
  s_mov_b32 m0, 70656
  s_add_u32 s97, s97, s68
  buffer_load_dwordx4 v2, s[20:23], s97 offen sc1 lds
  s_add_u32 s65, s65, 1
  s_cmp_eq_u32 s65, 24
  s_cselect_b32 s65, 0, s65
  s_waitcnt vmcnt(54)
  s_barrier
  s_lshl_b32 s67, s66, 11
  s_add_u32 s67, s67, s59
  s_add_u32 s66, s66, 1
  s_cmp_eq_u32 s66, 24
  s_cselect_b32 s66, 0, s66
  s_mov_b32 m0, 139264
  s_add_u32 s97, s67, 0
  buffer_load_dwordx4 v2, s[20:23], s97 offen offset:0 sc1 lds
  buffer_load_dwordx4 v2, s[20:23], s97 offen offset:1024 sc1 lds
  s_mov_b32 m0, 141312
  s_add_u32 s97, s67, 49152
  buffer_load_dwordx4 v2, s[20:23], s97 offen offset:0 sc1 lds
  buffer_load_dwordx4 v2, s[20:23], s97 offen offset:1024 sc1 lds
  s_mov_b32 m0, 143360
  s_add_u32 s97, s67, 98304
  buffer_load_dwordx4 v2, s[20:23], s97 offen offset:0 sc1 lds
  buffer_load_dwordx4 v2, s[20:23], s97 offen offset:1024 sc1 lds
  s_mov_b32 m0, 145408
  s_add_u32 s97, s67, 147456
  buffer_load_dwordx4 v2, s[20:23], s97 offen offset:0 sc1 lds
  buffer_load_dwordx4 v2, s[20:23], s97 offen offset:1024 sc1 lds
  s_mul_i32 s97, s65, 10240
  s_mov_b32 m0, 80896
  s_add_u32 s97, s97, s68
  buffer_load_dwordx4 v2, s[20:23], s97 offen sc1 lds
  s_add_u32 s65, s65, 1
  s_cmp_eq_u32 s65, 24
  s_cselect_b32 s65, 0, s65
  s_waitcnt vmcnt(54)
  s_barrier
  s_waitcnt vmcnt(45)
  s_barrier
  s_waitcnt vmcnt(36)
  s_barrier
  s_waitcnt vmcnt(27)
  s_barrier
  s_waitcnt vmcnt(18)
  s_barrier
  s_waitcnt vmcnt(9)
  s_barrier
  s_waitcnt vmcnt(0)
  s_barrier
  s_endpgm
L_k1_w:
  s_setprio 2
  s_cmp_ge_u32 s3, 11
  s_cbranch_scc1 L_k1_side
  s_sub_u32 s66, s3, 2
  s_mul_i32 s68, s66, 86
  s_lshr_b32 s68, s68, 8
  s_mul_i32 s96, s68, 3
  s_sub_u32 s66, s66, s96
  s_and_b32 s96, s69, 1
  s_lshl_b32 s96, s96, 1
  s_and_b32 s96, s96, s68
  s_cmp_lg_u32 s96, 0
  s_cbranch_scc1 L_k1_idle
  s_sub_u32 s67, s3, 2
  s_lshl_b32 s67, s67, 12
  s_add_u32 s67, s67, 86016
  s_add_u32 s70, s67, 4096
  s_mul_i32 s71, s68, 3328
  s_add_u32 s71, s71, 131584
  s_lshl_b32 s65, s69, 1
  s_add_u32 s65, s65, s68
  s_lshr_b32 s96, s69, 1
  s_add_u32 s96, s96, 512
  s_cmp_eq_u32 s68, 2
  s_cselect_b32 s65, s96, s65
  s_lshl_b32 s96, s66, 7
  v_lshl_add_u32 v2, v0, 1, s96
  s_mul_i32 s96, s65, 384
  s_lshl_b32 s97, s65, 1
  v_mov_b32 v3, 0
  buffer_load_ushort v12, v3, s[44:47], s97 offen
  buffer_load_ushort v8, v2, s[28:31], s96 offen
  buffer_load_ushort v9, v2, s[32:35], s96 offen
  buffer_load_ushort v10, v2, s[36:39], s96 offen
  buffer_load_ushort v11, v2, s[40:43], s96 offen
  v_bfe_u32 v16, v0, 1, 2
  v_lshlrev_b32 v17, 6, v0
  v_add_u32 v17, s67, v17
  v_lshl_add_u32 v2, v16, 4, v17
  v_xor_b32 v3, 16, v2
  v_xor_b32 v4, 32, v2
  v_xor_b32 v5, 48, v2
  v_lshrrev_b32 v16, 4, v0
  v_bfe_u32 v17, v0, 2, 2
  v_and_b32 v18, 3, v0
  v_lshrrev_b32 v19, 1, v17
  v_lshl_add_u32 v19, v16, 1, v19
  v_lshlrev_b32 v6, 6, v19
  v_and_b32 v17, 1, v17
  v_lshrrev_b32 v19, 1, v18
  v_lshl_add_u32 v17, v17, 1, v19
  v_xor_b32 v17, v17, v16
  v_lshl_add_u32 v6, v17, 4, v6
  v_and_b32 v18, 1, v18
  v_lshl_add_u32 v6, v18, 3, v6
  v_add_u32 v6, s67, v6
  s_setprio 0
  s_waitcnt vmcnt(0)
  s_mov_b32 s88, 0x3fb8aa3b
  s_mov_b32 s89, 0x32a57060
  s_mov_b32 s90, 0x3f317218
  v_lshlrev_b32 v8, 16, v8
  v_lshlrev_b32 v9, 16, v9
  v_lshlrev_b32 v10, 16, v10
  v_lshlrev_b32 v11, 16, v11
  v_lshlrev_b32 v12, 16, v12
  v_and_b32 v18, 0x7fffffff, v10
  v_and_b32 v19, 0x7fffffff, v11
  v_max_u32 v18, v18, v19
  v_mul_f32 v16, s88, v12
  v_fma_f32 v17, v12, s88, -v16
  v_exp_f32 v16, v16
  v_fma_f32 v17, v12, s89, v17
  v_mul_f32 v17, s90, v17
  v_fma_f32 v16, v16, v17, v16
  v_cvt_pk_bf16_f32 v12, v16, v16
  v_lshlrev_b32 v12, 16, v12
  v_mul_f32 v16, s88, v8
  v_fma_f32 v17, v8, s88, -v16
  v_exp_f32 v16, v16
  v_fma_f32 v17, v8, s89, v17
  v_mul_f32 v17, s90, v17
  v_fma_f32 v16, v16, v17, v16
  v_cvt_pk_bf16_f32 v8, v16, v16
  v_lshlrev_b32 v8, 16, v8
  v_mul_f32 v13, v8, v12
  v_mul_f32 v14, v9, v12
  v_mul_f32_e64 v13, -v13, s88
  v_mul_f32 v14, 0.15915494, v14
  s_nop 1
  v_max_u32_dpp v18, v18, v18 row_ror:8 row_mask:0xf bank_mask:0xf
  s_nop 1
  v_max_u32_dpp v18, v18, v18 row_ror:4 row_mask:0xf bank_mask:0xf
  s_nop 1
  v_max_u32_dpp v18, v18, v18 row_ror:2 row_mask:0xf bank_mask:0xf
  s_nop 1
  v_max_u32_dpp v18, v18, v18 row_ror:1 row_mask:0xf bank_mask:0xf
  s_nop 0
  v_readlane_b32 s92, v18, 0
  v_readlane_b32 s93, v18, 16
  s_max_u32 s92, s92, s93
  v_readlane_b32 s93, v18, 32
  s_max_u32 s92, s92, s93
  v_readlane_b32 s93, v18, 48
  s_max_u32 s92, s92, s93
  s_lshr_b32 s92, s92, 23
  s_max_u32 s92, s92, 1
  s_min_u32 s92, s92, 252
  s_sub_u32 s93, 253, s92
  s_lshl_b32 s93, s93, 23
  s_add_u32 s92, s92, 2
  s_lshl_b32 s92, s92, 23
  v_mul_f32 v10, s93, v10
  v_mul_f32 v11, s93, v11
  v_mul_f32 v12, s92, v12
  v_mul_f32 v24, 0x41000000, v13
  v_mul_f32 v25, 0x41000000, v14
  v_mul_f32 v26, 0x42000000, v13
  v_mul_f32 v27, 0x42000000, v14
  v_exp_f32 v24, v24
  v_fract_f32 v25, v25
  v_exp_f32 v26, v26
  v_fract_f32 v27, v27
  v_cos_f32 v16, v25
  v_sin_f32 v17, v25
  v_cos_f32 v18, v27
  v_sin_f32 v19, v27
  v_mul_f32_e64 v25, -v24, v17
  v_mul_f32 v24, v24, v16
  v_mul_f32_e64 v27, -v26, v19
  v_mul_f32 v26, v26, v18
  s_nop 0
  v_mul_f32 v16, v25, v25
  v_mul_f32 v17, v24, v25
  v_fma_f32 v28, v24, v24, -v16
  v_fma_f32 v29, v25, v24, v17
  v_mul_f32 v18, v27, v27
  v_mul_f32 v19, v26, v27
  v_fma_f32 v30, v26, v26, -v18
  v_fma_f32 v31, v27, v26, v19
  v_mul_f32 v16, v29, v25
  v_mul_f32 v17, v28, v25
  v_fma_f32 v32, v28, v24, -v16
  v_fma_f32 v33, v29, v24, v17
  v_mul_f32 v18, v31, v27
  v_mul_f32 v19, v30, v27
  v_fma_f32 v34, v30, v26, -v18
  v_fma_f32 v35, v31, v26, v19
  v_cvt_pk_f16_f32 v60, 1.0, v24
  v_cvt_pk_f16_f32 v68, 0, v25
  v_cvt_pk_f16_f32 v61, v28, v32
  v_cvt_pk_f16_f32 v69, v29, v33
  v_cvt_pk_f16_f32 v36, v26, v27
  v_cvt_pk_f16_f32 v37, v30, v31
  v_cvt_pk_f16_f32 v38, v34, v35
  v_pk_mul_f16 v62, v60, v36 op_sel:[0,0] op_sel_hi:[1,0]
  v_pk_mul_f16 v70, v60, v36 op_sel:[0,1] op_sel_hi:[1,1]
  v_pk_fma_f16 v62, v68, v36, v62 op_sel:[0,1,0] op_sel_hi:[1,1,1] neg_lo:[0,1,0] neg_hi:[0,1,0]
  v_pk_fma_f16 v70, v68, v36, v70 op_sel:[0,0,0] op_sel_hi:[1,0,1]
  v_pk_mul_f16 v63, v61, v36 op_sel:[0,0] op_sel_hi:[1,0]
  v_pk_mul_f16 v71, v61, v36 op_sel:[0,1] op_sel_hi:[1,1]
  v_pk_fma_f16 v63, v69, v36, v63 op_sel:[0,1,0] op_sel_hi:[1,1,1] neg_lo:[0,1,0] neg_hi:[0,1,0]
  v_pk_fma_f16 v71, v69, v36, v71 op_sel:[0,0,0] op_sel_hi:[1,0,1]
  v_pk_mul_f16 v64, v60, v37 op_sel:[0,0] op_sel_hi:[1,0]
  v_pk_mul_f16 v72, v60, v37 op_sel:[0,1] op_sel_hi:[1,1]
  v_pk_fma_f16 v64, v68, v37, v64 op_sel:[0,1,0] op_sel_hi:[1,1,1] neg_lo:[0,1,0] neg_hi:[0,1,0]
  v_pk_fma_f16 v72, v68, v37, v72 op_sel:[0,0,0] op_sel_hi:[1,0,1]
  v_pk_mul_f16 v65, v61, v37 op_sel:[0,0] op_sel_hi:[1,0]
  v_pk_mul_f16 v73, v61, v37 op_sel:[0,1] op_sel_hi:[1,1]
  v_pk_fma_f16 v65, v69, v37, v65 op_sel:[0,1,0] op_sel_hi:[1,1,1] neg_lo:[0,1,0] neg_hi:[0,1,0]
  v_pk_fma_f16 v73, v69, v37, v73 op_sel:[0,0,0] op_sel_hi:[1,0,1]
  v_pk_mul_f16 v66, v60, v38 op_sel:[0,0] op_sel_hi:[1,0]
  v_pk_mul_f16 v74, v60, v38 op_sel:[0,1] op_sel_hi:[1,1]
  v_pk_fma_f16 v66, v68, v38, v66 op_sel:[0,1,0] op_sel_hi:[1,1,1] neg_lo:[0,1,0] neg_hi:[0,1,0]
  v_pk_fma_f16 v74, v68, v38, v74 op_sel:[0,0,0] op_sel_hi:[1,0,1]
  v_pk_mul_f16 v67, v61, v38 op_sel:[0,0] op_sel_hi:[1,0]
  v_pk_mul_f16 v75, v61, v38 op_sel:[0,1] op_sel_hi:[1,1]
  v_pk_fma_f16 v67, v69, v38, v67 op_sel:[0,1,0] op_sel_hi:[1,1,1] neg_lo:[0,1,0] neg_hi:[0,1,0]
  v_pk_fma_f16 v75, v69, v38, v75 op_sel:[0,0,0] op_sel_hi:[1,0,1]
  ds_write_b128 v2, v[60:63]
  ds_write_b128 v3, v[64:67]
  ds_write_b128 v4, v[68:71]
  ds_write_b128 v5, v[72:75]
  ds_read_b64_tr_b16 v[60:61], v6 offset:0
  ds_read_b64_tr_b16 v[62:63], v6 offset:512
  ds_read_b64_tr_b16 v[64:65], v6 offset:1024
  ds_read_b64_tr_b16 v[66:67], v6 offset:1536
  ds_read_b64_tr_b16 v[68:69], v6 offset:2048
  ds_read_b64_tr_b16 v[70:71], v6 offset:2560
  ds_read_b64_tr_b16 v[72:73], v6 offset:3072
  ds_read_b64_tr_b16 v[74:75], v6 offset:3584
  v_mul_f32 v24, 0x3f800000, v13
  v_mul_f32 v25, 0x3f800000, v14
  v_mul_f32 v26, 0x43000000, v13
  v_mul_f32 v27, 0x43000000, v14
  v_mul_f32 v28, 0x44800000, v13
  v_mul_f32 v29, 0x44800000, v14
  v_exp_f32 v24, v24
  v_fract_f32 v25, v25
  v_exp_f32 v26, v26
  v_fract_f32 v27, v27
  v_exp_f32 v28, v28
  v_fract_f32 v29, v29
  v_cos_f32 v16, v25
  v_sin_f32 v17, v25
  v_cos_f32 v18, v27
  v_sin_f32 v19, v27
  v_cos_f32 v20, v29
  v_sin_f32 v21, v29
  v_mul_f32_e64 v25, v24, v17
  v_mul_f32 v24, v24, v16
  v_mul_f32_e64 v27, v26, v19
  v_mul_f32 v26, v26, v18
  v_mul_f32_e64 v29, v28, v21
  v_mul_f32 v28, v28, v20
  v_mul_f32 v16, v11, v25
  v_mul_f32 v17, v10, v25
  v_fma_f32 v30, v10, v24, -v16
  v_fma_f32 v31, v11, v24, v17
  v_mul_f32 v18, v31, v25
  v_mul_f32 v19, v30, v25
  v_fma_f32 v32, v30, v24, -v18
  v_fma_f32 v33, v31, v24, v19
  v_mul_f32 v16, v33, v25
  v_mul_f32 v17, v32, v25
  v_fma_f32 v34, v32, v24, -v16
  v_fma_f32 v35, v33, v24, v17
  v_mul_f32 v18, v35, v25
  v_mul_f32 v19, v34, v25
  v_fma_f32 v36, v34, v24, -v18
  v_fma_f32 v37, v35, v24, v19
  v_mul_f32 v16, v37, v25
  v_mul_f32 v17, v36, v25
  v_fma_f32 v38, v36, v24, -v16
  v_fma_f32 v39, v37, v24, v17
  v_mul_f32 v18, v39, v25
  v_mul_f32 v19, v38, v25
  v_fma_f32 v40, v38, v24, -v18
  v_fma_f32 v41, v39, v24, v19
  v_mul_f32 v16, v41, v25
  v_mul_f32 v17, v40, v25
  v_fma_f32 v42, v40, v24, -v16
  v_fma_f32 v43, v41, v24, v17
  v_cvt_pk_f16_f32 v44, v26, v27
  v_cvt_pk_f16_f32 v76, v10, v30
  v_cvt_pk_f16_f32 v84, v11, v31
  v_cvt_pk_f16_f32 v77, v32, v34
  v_cvt_pk_f16_f32 v85, v33, v35
  v_cvt_pk_f16_f32 v78, v36, v38
  v_cvt_pk_f16_f32 v86, v37, v39
  v_cvt_pk_f16_f32 v79, v40, v42
  v_cvt_pk_f16_f32 v87, v41, v43
  v_pk_mul_f16 v80, v76, v44 op_sel:[0,0] op_sel_hi:[1,0]
  v_pk_mul_f16 v88, v76, v44 op_sel:[0,1] op_sel_hi:[1,1]
  v_pk_fma_f16 v80, v84, v44, v80 op_sel:[0,1,0] op_sel_hi:[1,1,1] neg_lo:[0,1,0] neg_hi:[0,1,0]
  v_pk_fma_f16 v88, v84, v44, v88 op_sel:[0,0,0] op_sel_hi:[1,0,1]
  v_pk_mul_f16 v81, v77, v44 op_sel:[0,0] op_sel_hi:[1,0]
  v_pk_mul_f16 v89, v77, v44 op_sel:[0,1] op_sel_hi:[1,1]
  v_pk_fma_f16 v81, v85, v44, v81 op_sel:[0,1,0] op_sel_hi:[1,1,1] neg_lo:[0,1,0] neg_hi:[0,1,0]
  v_pk_fma_f16 v89, v85, v44, v89 op_sel:[0,0,0] op_sel_hi:[1,0,1]
  v_pk_mul_f16 v82, v78, v44 op_sel:[0,0] op_sel_hi:[1,0]
  v_pk_mul_f16 v90, v78, v44 op_sel:[0,1] op_sel_hi:[1,1]
  v_pk_fma_f16 v82, v86, v44, v82 op_sel:[0,1,0] op_sel_hi:[1,1,1] neg_lo:[0,1,0] neg_hi:[0,1,0]
  v_pk_fma_f16 v90, v86, v44, v90 op_sel:[0,0,0] op_sel_hi:[1,0,1]
  v_pk_mul_f16 v83, v79, v44 op_sel:[0,0] op_sel_hi:[1,0]
  v_pk_mul_f16 v91, v79, v44 op_sel:[0,1] op_sel_hi:[1,1]
  v_pk_fma_f16 v83, v87, v44, v83 op_sel:[0,1,0] op_sel_hi:[1,1,1] neg_lo:[0,1,0] neg_hi:[0,1,0]
  v_pk_fma_f16 v91, v87, v44, v91 op_sel:[0,0,0] op_sel_hi:[1,0,1]
  ds_write_b128 v2, v[76:79]
  ds_write_b128 v3, v[80:83]
  ds_write_b128 v4, v[84:87]
  ds_write_b128 v5, v[88:91]
  ds_read_b64_tr_b16 v[76:77], v6 offset:0
  ds_read_b64_tr_b16 v[78:79], v6 offset:512
  ds_read_b64_tr_b16 v[80:81], v6 offset:1024
  ds_read_b64_tr_b16 v[82:83], v6 offset:1536
  ds_read_b64_tr_b16 v[84:85], v6 offset:2048
  ds_read_b64_tr_b16 v[86:87], v6 offset:2560
  ds_read_b64_tr_b16 v[88:89], v6 offset:3072
  ds_read_b64_tr_b16 v[90:91], v6 offset:3584
  v_cvt_pk_f16_f32 v45, v10, v32
  v_cvt_pk_f16_f32 v46, v11, v33
  v_cvt_pk_f16_f32 v47, v36, v40
  v_cvt_pk_f16_f32 v48, v37, v41
  v_cvt_pk_f16_f32 v49, v10, v36
  v_cvt_pk_f16_f32 v50, v11, v37
  v_mul_f32 v18, v27, v27
  v_mul_f32 v19, v26, v27
  v_fma_f32 v30, v26, v26, -v18
  v_fma_f32 v31, v27, v26, v19
  v_mul_f32 v16, v11, v29
  v_mul_f32 v17, v10, v29
  v_fma_f32 v42, v10, v28, -v16
  v_fma_f32 v43, v11, v28, v17
  v_mul_f32 v18, v31, v27
  v_mul_f32 v19, v30, v27
  v_fma_f32 v32, v30, v26, -v18
  v_fma_f32 v33, v31, v26, v19
  v_mul_f32 v16, v31, v31
  v_mul_f32 v17, v30, v31
  v_fma_f32 v34, v30, v30, -v16
  v_fma_f32 v35, v31, v30, v17
  v_mul_f32 v18, v43, v27
  v_mul_f32 v19, v42, v27
  v_fma_f32 v24, v42, v26, -v18
  v_fma_f32 v25, v43, v26, v19
  v_mul_f32 v16, v35, v27
  v_mul_f32 v17, v34, v27
  v_fma_f32 v36, v34, v26, -v16
  v_fma_f32 v37, v35, v26, v17
  v_mul_f32 v18, v33, v33
  v_mul_f32 v19, v32, v33
  v_fma_f32 v38, v32, v32, -v18
  v_fma_f32 v39, v33, v32, v19
  v_mul_f32 v16, v39, v27
  v_mul_f32 v17, v38, v27
  v_fma_f32 v40, v38, v26, -v16
  v_fma_f32 v41, v39, v26, v17
  v_cvt_pk_f16_f32 v51, v30, v31
  v_cvt_pk_f16_f32 v52, v32, v33
  v_cvt_pk_f16_f32 v53, v34, v35
  v_cvt_pk_f16_f32 v54, v36, v37
  v_cvt_pk_f16_f32 v55, v38, v39
  v_cvt_pk_f16_f32 v56, v40, v41
  v_mul_f32 v18, v43, v29
  v_mul_f32 v19, v42, v29
  v_fma_f32 v30, v42, v28, -v18
  v_fma_f32 v31, v43, v28, v19
  v_pk_mul_f16 v92, v45, v51 op_sel:[0,0] op_sel_hi:[1,0]
  v_pk_mul_f16 v100, v45, v51 op_sel:[0,1] op_sel_hi:[1,1]
  v_pk_fma_f16 v92, v46, v51, v92 op_sel:[0,1,0] op_sel_hi:[1,1,1] neg_lo:[0,1,0] neg_hi:[0,1,0]
  v_pk_fma_f16 v100, v46, v51, v100 op_sel:[0,0,0] op_sel_hi:[1,0,1]
  v_pk_mul_f16 v93, v47, v51 op_sel:[0,0] op_sel_hi:[1,0]
  v_pk_mul_f16 v101, v47, v51 op_sel:[0,1] op_sel_hi:[1,1]
  v_pk_fma_f16 v93, v48, v51, v93 op_sel:[0,1,0] op_sel_hi:[1,1,1] neg_lo:[0,1,0] neg_hi:[0,1,0]
  v_pk_fma_f16 v101, v48, v51, v101 op_sel:[0,0,0] op_sel_hi:[1,0,1]
  v_pk_mul_f16 v94, v45, v52 op_sel:[0,0] op_sel_hi:[1,0]
  v_pk_mul_f16 v102, v45, v52 op_sel:[0,1] op_sel_hi:[1,1]
  v_pk_fma_f16 v94, v46, v52, v94 op_sel:[0,1,0] op_sel_hi:[1,1,1] neg_lo:[0,1,0] neg_hi:[0,1,0]
  v_pk_fma_f16 v102, v46, v52, v102 op_sel:[0,0,0] op_sel_hi:[1,0,1]
  v_pk_mul_f16 v95, v47, v52 op_sel:[0,0] op_sel_hi:[1,0]
  v_pk_mul_f16 v103, v47, v52 op_sel:[0,1] op_sel_hi:[1,1]
  v_pk_fma_f16 v95, v48, v52, v95 op_sel:[0,1,0] op_sel_hi:[1,1,1] neg_lo:[0,1,0] neg_hi:[0,1,0]
  v_pk_fma_f16 v103, v48, v52, v103 op_sel:[0,0,0] op_sel_hi:[1,0,1]
  v_pk_mul_f16 v96, v49, v53 op_sel:[0,0] op_sel_hi:[1,0]
  v_pk_mul_f16 v104, v49, v53 op_sel:[0,1] op_sel_hi:[1,1]
  v_pk_fma_f16 v96, v50, v53, v96 op_sel:[0,1,0] op_sel_hi:[1,1,1] neg_lo:[0,1,0] neg_hi:[0,1,0]
  v_pk_fma_f16 v104, v50, v53, v104 op_sel:[0,0,0] op_sel_hi:[1,0,1]
  v_pk_mul_f16 v97, v49, v54 op_sel:[0,0] op_sel_hi:[1,0]
  v_pk_mul_f16 v105, v49, v54 op_sel:[0,1] op_sel_hi:[1,1]
  v_pk_fma_f16 v97, v50, v54, v97 op_sel:[0,1,0] op_sel_hi:[1,1,1] neg_lo:[0,1,0] neg_hi:[0,1,0]
  v_pk_fma_f16 v105, v50, v54, v105 op_sel:[0,0,0] op_sel_hi:[1,0,1]
  v_pk_mul_f16 v98, v49, v55 op_sel:[0,0] op_sel_hi:[1,0]
  v_pk_mul_f16 v106, v49, v55 op_sel:[0,1] op_sel_hi:[1,1]
  v_pk_fma_f16 v98, v50, v55, v98 op_sel:[0,1,0] op_sel_hi:[1,1,1] neg_lo:[0,1,0] neg_hi:[0,1,0]
  v_pk_fma_f16 v106, v50, v55, v106 op_sel:[0,0,0] op_sel_hi:[1,0,1]
  v_pk_mul_f16 v99, v49, v56 op_sel:[0,0] op_sel_hi:[1,0]
  v_pk_mul_f16 v107, v49, v56 op_sel:[0,1] op_sel_hi:[1,1]
  v_pk_fma_f16 v99, v50, v56, v99 op_sel:[0,1,0] op_sel_hi:[1,1,1] neg_lo:[0,1,0] neg_hi:[0,1,0]
  v_pk_fma_f16 v107, v50, v56, v107 op_sel:[0,0,0] op_sel_hi:[1,0,1]
  ds_write_b128 v2, v[92:95]
  ds_write_b128 v3, v[96:99]
  ds_write_b128 v4, v[100:103]
  ds_write_b128 v5, v[104:107]
  ds_read_b64_tr_b16 v[92:93], v6 offset:0
  ds_read_b64_tr_b16 v[94:95], v6 offset:512
  ds_read_b64_tr_b16 v[96:97], v6 offset:1024
  ds_read_b64_tr_b16 v[98:99], v6 offset:1536
  ds_read_b64_tr_b16 v[100:101], v6 offset:2048
  ds_read_b64_tr_b16 v[102:103], v6 offset:2560
  ds_read_b64_tr_b16 v[104:105], v6 offset:3072
  ds_read_b64_tr_b16 v[106:107], v6 offset:3584
  v_cvt_pk_f16_f32 v108, v42, v24
  v_cvt_pk_f16_f32 v116, v43, v25
  v_pk_mul_f16 v109, v108, v51 op_sel:[0,0] op_sel_hi:[1,0]
  v_pk_mul_f16 v117, v108, v51 op_sel:[0,1] op_sel_hi:[1,1]
  v_pk_fma_f16 v109, v116, v51, v109 op_sel:[0,1,0] op_sel_hi:[1,1,1] neg_lo:[0,1,0] neg_hi:[0,1,0]
  v_pk_fma_f16 v117, v116, v51, v117 op_sel:[0,0,0] op_sel_hi:[1,0,1]
  v_pk_mul_f16 v110, v108, v53 op_sel:[0,0] op_sel_hi:[1,0]
  v_pk_mul_f16 v118, v108, v53 op_sel:[0,1] op_sel_hi:[1,1]
  v_pk_fma_f16 v110, v116, v53, v110 op_sel:[0,1,0] op_sel_hi:[1,1,1] neg_lo:[0,1,0] neg_hi:[0,1,0]
  v_pk_fma_f16 v118, v116, v53, v118 op_sel:[0,0,0] op_sel_hi:[1,0,1]
  v_pk_mul_f16 v111, v108, v55 op_sel:[0,0] op_sel_hi:[1,0]
  v_pk_mul_f16 v119, v108, v55 op_sel:[0,1] op_sel_hi:[1,1]
  v_pk_fma_f16 v111, v116, v55, v111 op_sel:[0,1,0] op_sel_hi:[1,1,1] neg_lo:[0,1,0] neg_hi:[0,1,0]
  v_pk_fma_f16 v119, v116, v55, v119 op_sel:[0,0,0] op_sel_hi:[1,0,1]
  v_cvt_pk_f16_f32 v112, v30, 0
  v_cvt_pk_f16_f32 v120, v31, 0
  v_mov_b32 v113, 0
  v_mov_b32 v121, 0
  v_mov_b64 v[114:115], 0
  v_mov_b64 v[122:123], 0
  ds_write_b128 v2, v[108:111]
  ds_write_b128 v3, v[112:115]
  ds_write_b128 v4, v[116:119]
  ds_write_b128 v5, v[120:123]
  ds_read_b64_tr_b16 v[108:109], v6 offset:0
  ds_read_b64_tr_b16 v[110:111], v6 offset:512
  ds_read_b64_tr_b16 v[112:113], v6 offset:1024
  ds_read_b64_tr_b16 v[114:115], v6 offset:1536
  ds_read_b64_tr_b16 v[116:117], v6 offset:2048
  ds_read_b64_tr_b16 v[118:119], v6 offset:2560
  ds_read_b64_tr_b16 v[120:121], v6 offset:3072
  ds_read_b64_tr_b16 v[122:123], v6 offset:3584
  s_waitcnt lgkmcnt(15)
  v_mfma_f32_16x16x32_f16 v[16:19], v[76:79], v[60:63], 0
  v_mfma_f32_16x16x32_f16 v[16:19], v[80:83], v[64:67], v[16:19]
  v_mfma_f32_16x16x32_f16 v[16:19], v[84:87], v[68:71], v[16:19]
  v_mfma_f32_16x16x32_f16 v[16:19], v[88:91], v[72:75], v[16:19]
  v_mfma_f32_16x16x32_f16 v[20:23], v[92:95], v[60:63], 0
  v_mfma_f32_16x16x32_f16 v[20:23], v[96:99], v[64:67], v[20:23]
  s_waitcnt lgkmcnt(14)
  v_mfma_f32_16x16x32_f16 v[20:23], v[100:103], v[68:71], v[20:23]
  s_waitcnt lgkmcnt(12)
  v_mfma_f32_16x16x32_f16 v[20:23], v[104:107], v[72:75], v[20:23]
  s_waitcnt lgkmcnt(6)
  v_mfma_f32_16x16x32_f16 v[24:27], v[108:111], v[60:63], 0
  s_waitcnt lgkmcnt(4)
  v_mfma_f32_16x16x32_f16 v[24:27], v[112:115], v[64:67], v[24:27]
  s_waitcnt lgkmcnt(2)
  v_mfma_f32_16x16x32_f16 v[24:27], v[116:119], v[68:71], v[24:27]
  s_waitcnt lgkmcnt(0)
  v_mfma_f32_16x16x32_f16 v[24:27], v[120:123], v[72:75], v[24:27]
  s_nop 7
  v_mul_f32 v16, v16, v12
  v_mul_f32 v17, v17, v12
  v_mul_f32 v18, v18, v12
  v_mul_f32 v19, v19, v12
  v_mul_f32 v20, v20, v12
  v_mul_f32 v21, v21, v12
  v_mul_f32 v22, v22, v12
  v_mul_f32 v23, v23, v12
  v_mul_f32 v24, v24, v12
  v_mul_f32 v25, v25, v12
  v_mul_f32 v26, v26, v12
  v_mul_f32 v27, v27, v12
  s_cmp_eq_u32 s66, 0
  s_cbranch_scc1 L_kfin_30
  v_lshlrev_b32 v5, 4, v0
  v_add_u32 v5, s67, v5
  ds_write_b128 v5, v[16:19] offset:0
  ds_write_b128 v5, v[20:23] offset:1024
  ds_write_b128 v5, v[24:27] offset:2048
  s_waitcnt lgkmcnt(0)
L_k1_idle:
  s_mov_b32 s70, 1
  s_branch L_k1_pdone
L_kfin_30:
  v_lshlrev_b32 v80, 4, v0
  v_add_u32 v81, s71, v80
  v_add_u32 v82, s70, v80
  v_mov_b32 v112, v82
  v_mov_b32 v48, 0
  v_mov_b32 v49, 0
  v_mov_b32 v50, 0
  v_mov_b32 v51, 0
  ds_write_b128 v81, v[48:51] offset:0
  ds_write_b128 v81, v[48:51] offset:1024
  ds_write_b128 v81, v[48:51] offset:2048
  s_mov_b64 exec, 0xffff
  ds_write_b128 v81, v[48:51] offset:3072
  s_mov_b64 exec, -1
  v_and_b32 v82, 15, v0
  v_lshrrev_b32 v83, 4, v0
  v_lshrrev_b32 v84, 1, v83
  v_and_b32 v85, 1, v83
  v_lshlrev_b32 v86, 7, v84
  v_lshl_add_u32 v86, v85, 2, v86
  v_lshl_add_u32 v86, v82, 3, v86
  v_sub_u32 v86, 285, v86
  v_lshl_add_u32 v52, v86, 1, s71
  v_lshlrev_b32 v86, 6, v85
  v_add_u32 v86, s71, v86
  v_lshl_add_u32 v87, v82, 2, v86
  v_lshl_add_u32 v86, v82, 1, v86
  v_cmp_gt_u32 vcc, 2, v83
  v_add_u32 v60, 1398, v87
  v_add_u32 v61, 2106, v86
  v_cndmask_b32 v54, v61, v60, vcc
  v_add_u32 v60, 1782, v87
  v_add_u32 v61, 2364, v86
  v_cndmask_b32 v55, v61, v60, vcc
  v_add_u32 v60, 1400, v87
  v_add_u32 v61, 2138, v86
  v_cndmask_b32 v56, v61, v60, vcc
  v_add_u32 v60, 1784, v87
  v_add_u32 v61, 2396, v86
  v_cndmask_b32 v57, v61, v60, vcc
  s_add_u32 s96, s71, 64
  v_writelane_b32 v54, s96, 0
  s_add_u32 s96, s71, 60
  v_writelane_b32 v55, s96, 0
  s_add_u32 s96, s71, 1526
  v_writelane_b32 v54, s96, 32
  v_and_b32 v60, 1, v82
  v_mul_u32_u24 v60, 322, v60
  v_lshrrev_b32 v61, 1, v82
  v_lshl_add_u32 v61, v83, 5, v61
  v_lshl_add_u32 v53, v61, 1, v60
  s_add_u32 s96, s71, 2588
  v_add_u32 v53, s96, v53
  v_mov_b32 v62, s71
  s_barrier
  s_setprio 3
  ds_read_b128 v[88:91], v112 offset:0
  ds_read_b128 v[92:95], v112 offset:1024
  ds_read_b128 v[96:99], v112 offset:2048
  ds_read_b128 v[100:103], v112 offset:4096
  ds_read_b128 v[104:107], v112 offset:5120
  ds_read_b128 v[108:111], v112 offset:6144
  s_waitcnt lgkmcnt(0)
  v_add_f32 v16, v16, v88
  v_add_f32 v17, v17, v89
  v_add_f32 v18, v18, v90
  v_add_f32 v19, v19, v91
  v_add_f32 v20, v20, v92
  v_add_f32 v21, v21, v93
  v_add_f32 v22, v22, v94
  v_add_f32 v23, v23, v95
  v_add_f32 v24, v24, v96
  v_add_f32 v25, v25, v97
  v_add_f32 v26, v26, v98
  v_add_f32 v27, v27, v99
  v_add_f32 v16, v16, v100
  v_add_f32 v17, v17, v101
  v_add_f32 v18, v18, v102
  v_add_f32 v19, v19, v103
  v_add_f32 v20, v20, v104
  v_add_f32 v21, v21, v105
  v_add_f32 v22, v22, v106
  v_add_f32 v23, v23, v107
  v_add_f32 v24, v24, v108
  v_add_f32 v25, v25, v109
  v_add_f32 v26, v26, v110
  v_add_f32 v27, v27, v111
  v_max3_f32 v63, abs(v16), abs(v17), abs(v18)
  v_max3_f32 v63, v63, abs(v19), abs(v20)
  v_max3_f32 v63, v63, abs(v21), abs(v22)
  v_max3_f32 v63, v63, abs(v23), abs(v24)
  v_max3_f32 v63, v63, abs(v25), abs(v26)
  v_max_f32_e64 v63, v63, abs(v27)
  s_nop 1
  v_max_u32_dpp v63, v63, v63 row_ror:8 row_mask:0xf bank_mask:0xf
  s_nop 1
  v_max_u32_dpp v63, v63, v63 row_ror:4 row_mask:0xf bank_mask:0xf
  s_nop 1
  v_max_u32_dpp v63, v63, v63 row_ror:2 row_mask:0xf bank_mask:0xf
  s_nop 1
  v_max_u32_dpp v63, v63, v63 row_ror:1 row_mask:0xf bank_mask:0xf
  s_nop 0
  v_readlane_b32 s92, v63, 0
  v_readlane_b32 s93, v63, 16
  s_max_u32 s92, s92, s93
  v_readlane_b32 s93, v63, 32
  s_max_u32 s92, s92, s93
  v_readlane_b32 s93, v63, 48
  s_max_u32 s92, s92, s93
  s_lshr_b32 s92, s92, 23
  s_max_u32 s92, s92, 1
  s_min_u32 s92, s92, 252
  s_sub_u32 s93, 253, s92
  s_lshl_b32 s93, s93, 23
  s_add_u32 s92, s92, 1
  s_lshl_b32 s92, s92, 23
  v_mul_f32 v16, s93, v16
  v_mul_f32 v17, s93, v17
  v_mul_f32 v18, s93, v18
  v_mul_f32 v19, s93, v19
  v_mul_f32 v20, s93, v20
  v_mul_f32 v21, s93, v21
  v_mul_f32 v22, s93, v22
  v_mul_f32 v23, s93, v23
  v_mul_f32 v24, s93, v24
  v_mul_f32 v25, s93, v25
  v_mul_f32 v26, s93, v26
  v_mul_f32 v27, s93, v27
  v_cvt_pk_f16_f32 v64, v16, v17
  v_cvt_pk_f16_f32 v65, v18, v19
  v_cvt_pk_f16_f32 v66, v20, v21
  v_cvt_pk_f16_f32 v67, v22, v23
  v_cvt_pk_f16_f32 v68, v24, v25
  v_cvt_pk_f16_f32 v69, v26, v27
  ds_write_b16 v52, v64 offset:6
  ds_write_b16 v52, v64 offset:644
  ds_write_b16 v54, v66 offset:0
  ds_write_b16_d16_hi v52, v64 offset:4
  ds_write_b16_d16_hi v52, v64 offset:642
  ds_write_b16_d16_hi v55, v66 offset:0
  ds_write_b16 v52, v65 offset:2
  ds_write_b16 v52, v65 offset:640
  ds_write_b16 v56, v67 offset:0
  ds_write_b16_d16_hi v52, v65 offset:0
  ds_write_b16_d16_hi v52, v65 offset:638
  ds_write_b16_d16_hi v57, v67 offset:0
  s_mov_b32 exec_hi, 0
  ds_write_b16_d16_hi v53, v68 offset:16
  ds_write_b16_d16_hi v53, v68 offset:174
  ds_write_b16 v53, v69 offset:32
  ds_write_b16 v53, v69 offset:190
  ds_write_b16_d16_hi v53, v69 offset:48
  ds_write_b16_d16_hi v53, v69 offset:206
  s_mov_b32 exec_lo, 0xfffffffe
  s_mov_b32 exec_hi, 1
  ds_write_b16 v53, v68 offset:0
  ds_write_b16 v53, v68 offset:158
  s_mov_b64 exec, 1
  ds_write_b16 v62, v66 offset:62
  ds_write_b16 v62, v66 offset:702
  ds_write_b16 v62, v66 offset:700
  ds_write_b16_d16_hi v62, v66 offset:698
  ds_write_b16 v62, v68 offset:3200
  v_mov_b32 v63, s92
  ds_write_b32 v62, v63 offset:3204
  s_mov_b32 exec_lo, 0
  s_mov_b32 exec_hi, 1
  ds_write_b16 v62, v66 offset:1910
  s_mov_b64 exec, -1
  s_cmp_lg_u32 s68, 2
  s_cbranch_scc1 L_nost_31
  ds_read_b128 v[88:91], v81 offset:0
  ds_read_b128 v[92:95], v81 offset:1024
  ds_read_b128 v[96:99], v81 offset:2048
  ds_read_b128 v[100:103], v81 offset:3072
  s_mul_i32 s96, s65, 3584
  s_add_u32 s96, s96, 13500416
  s_waitcnt lgkmcnt(3)
  buffer_store_dwordx4 v[88:91], v80, s[20:23], s96 offen offset:0 sc1
  s_waitcnt lgkmcnt(2)
  buffer_store_dwordx4 v[92:95], v80, s[20:23], s96 offen offset:1024 sc1
  s_waitcnt lgkmcnt(1)
  buffer_store_dwordx4 v[96:99], v80, s[20:23], s96 offen offset:2048 sc1
  s_waitcnt lgkmcnt(0)
  s_mov_b64 exec, 0xffff
  buffer_store_dwordx4 v[100:103], v80, s[20:23], s96 offen offset:3072 sc1
  s_mov_b64 exec, -1
L_nost_31:
  s_mov_b32 s70, 0
  s_branch L_k1_pdone
L_k1_side:
  s_cmp_eq_u32 s3, 11
  s_cbranch_scc1 L_k1_xs
  s_cmp_eq_u32 s3, 12
  s_cbranch_scc1 L_k1_xc
  s_cmp_lt_u32 s3, 15
  s_cbranch_scc1 L_k1_xu
  v_mov_b32 v3, 163776
  v_mov_b64 v[4:5], 0
  v_mov_b64 v[6:7], 0
  s_mov_b64 exec, 1
  ds_write_b128 v3, v[4:7]
  ds_write_b128 v3, v[4:7] offset:16
  ds_write_b128 v3, v[4:7] offset:32
  s_lshl_b32 s96, s69, 2
  s_add_u32 s96, s96, 15890432
  buffer_store_dword v4, v4, s[20:23], s96 offen sc1
  s_lshl_b32 s96, s52, 7
  s_lshl_b32 s97, s53, 2
  s_add_u32 s96, s96, s97
  s_add_u32 s96, s96, 15888384
  s_cmp_ge_u32 s56, 30
  s_cselect_b32 s96, 15890304, s96
  buffer_store_dword v4, v4, s[20:23], s96 offen sc1
  s_mov_b64 exec, -1
  s_branch L_k1_idle
L_k1_xs:
  v_lshrrev_b32 v5, 4, v0
  v_and_b32 v6, 15, v0
  v_mul_u32_u24 v7, 1280, v5
  v_lshl_add_u32 v7, v6, 4, v7
  s_and_b32 s58, s57, 1
  s_lshl_b32 s58, s58, 10
  s_lshr_b32 s59, s57, 1
  s_lshl_b32 s59, s59, 8
  s_add_u32 s58, s58, s59
  s_lshl_b32 s59, s56, 3
  s_add_u32 s58, s58, s59
  s_mul_i32 s59, s58, 1280
  s_add_u32 s60, s59, 5120
  buffer_load_dwordx4 v[8:11], v7, s[4:7], s59 offen offset:0
  buffer_load_dwordx4 v[12:15], v7, s[4:7], s59 offen offset:256
  buffer_load_dwordx4 v[16:19], v7, s[4:7], s59 offen offset:512
  buffer_load_dwordx4 v[20:23], v7, s[4:7], s59 offen offset:768
  buffer_load_dwordx4 v[24:27], v7, s[4:7], s59 offen offset:1024
  buffer_load_dwordx4 v[28:31], v7, s[4:7], s60 offen offset:0
  buffer_load_dwordx4 v[32:35], v7, s[4:7], s60 offen offset:256
  buffer_load_dwordx4 v[36:39], v7, s[4:7], s60 offen offset:512
  buffer_load_dwordx4 v[40:43], v7, s[4:7], s60 offen offset:768
  buffer_load_dwordx4 v[44:47], v7, s[4:7], s60 offen offset:1024
  s_barrier
  v_mov_b32 v72, 0x3f803f80
  s_mov_b32 s92, 0x9999999a
  s_mov_b32 s93, 0x3f599999
  s_mov_b32 s94, 0x3727c5ac
  s_lshl_b32 s59, s58, 3
  v_lshl_add_u32 v73, v5, 3, s59
  v_lshrrev_b32 v74, 1, v5
  v_lshlrev_b32 v74, 12, v74
  v_and_b32 v75, 1, v5
  v_lshl_add_u32 v74, v75, 3, v74
  s_lshl_b32 s59, s58, 1
  v_add_u32 v74, s59, v74
  v_mov_b64 v[48:49], 0
  v_mov_b64 v[50:51], 0
  v_mov_b64 v[52:53], 0
  v_mov_b64 v[54:55], 0
  s_waitcnt vmcnt(5)
  v_dot2c_f32_bf16 v48, v8, v72
  v_dot2c_f32_bf16 v50, v8, v8
  v_dot2c_f32_bf16 v49, v9, v72
  v_dot2c_f32_bf16 v51, v9, v9
  v_dot2c_f32_bf16 v48, v10, v72
  v_dot2c_f32_bf16 v50, v10, v10
  v_dot2c_f32_bf16 v49, v11, v72
  v_dot2c_f32_bf16 v51, v11, v11
  v_dot2c_f32_bf16 v48, v12, v72
  v_dot2c_f32_bf16 v50, v12, v12
  v_dot2c_f32_bf16 v49, v13, v72
  v_dot2c_f32_bf16 v51, v13, v13
  v_dot2c_f32_bf16 v48, v14, v72
  v_dot2c_f32_bf16 v50, v14, v14
  v_dot2c_f32_bf16 v49, v15, v72
  v_dot2c_f32_bf16 v51, v15, v15
  v_dot2c_f32_bf16 v48, v16, v72
  v_dot2c_f32_bf16 v50, v16, v16
  v_dot2c_f32_bf16 v49, v17, v72
  v_dot2c_f32_bf16 v51, v17, v17
  v_dot2c_f32_bf16 v48, v18, v72
  v_dot2c_f32_bf16 v50, v18, v18
  v_dot2c_f32_bf16 v49, v19, v72
  v_dot2c_f32_bf16 v51, v19, v19
  v_dot2c_f32_bf16 v48, v20, v72
  v_dot2c_f32_bf16 v50, v20, v20
  v_dot2c_f32_bf16 v49, v21, v72
  v_dot2c_f32_bf16 v51, v21, v21
  v_dot2c_f32_bf16 v48, v22, v72
  v_dot2c_f32_bf16 v50, v22, v22
  v_dot2c_f32_bf16 v49, v23, v72
  v_dot2c_f32_bf16 v51, v23, v23
  v_dot2c_f32_bf16 v48, v24, v72
  v_dot2c_f32_bf16 v50, v24, v24
  v_dot2c_f32_bf16 v49, v25, v72
  v_dot2c_f32_bf16 v51, v25, v25
  v_dot2c_f32_bf16 v48, v26, v72
  v_dot2c_f32_bf16 v50, v26, v26
  v_dot2c_f32_bf16 v49, v27, v72
  v_dot2c_f32_bf16 v51, v27, v27
  s_waitcnt vmcnt(0)
  v_dot2c_f32_bf16 v52, v28, v72
  v_dot2c_f32_bf16 v54, v28, v28
  v_dot2c_f32_bf16 v53, v29, v72
  v_dot2c_f32_bf16 v55, v29, v29
  v_dot2c_f32_bf16 v52, v30, v72
  v_dot2c_f32_bf16 v54, v30, v30
  v_dot2c_f32_bf16 v53, v31, v72
  v_dot2c_f32_bf16 v55, v31, v31
  v_dot2c_f32_bf16 v52, v32, v72
  v_dot2c_f32_bf16 v54, v32, v32
  v_dot2c_f32_bf16 v53, v33, v72
  v_dot2c_f32_bf16 v55, v33, v33
  v_dot2c_f32_bf16 v52, v34, v72
  v_dot2c_f32_bf16 v54, v34, v34
  v_dot2c_f32_bf16 v53, v35, v72
  v_dot2c_f32_bf16 v55, v35, v35
  v_dot2c_f32_bf16 v52, v36, v72
  v_dot2c_f32_bf16 v54, v36, v36
  v_dot2c_f32_bf16 v53, v37, v72
  v_dot2c_f32_bf16 v55, v37, v37
  v_dot2c_f32_bf16 v52, v38, v72
  v_dot2c_f32_bf16 v54, v38, v38
  v_dot2c_f32_bf16 v53, v39, v72
  v_dot2c_f32_bf16 v55, v39, v39
  v_dot2c_f32_bf16 v52, v40, v72
  v_dot2c_f32_bf16 v54, v40, v40
  v_dot2c_f32_bf16 v53, v41, v72
  v_dot2c_f32_bf16 v55, v41, v41
  v_dot2c_f32_bf16 v52, v42, v72
  v_dot2c_f32_bf16 v54, v42, v42
  v_dot2c_f32_bf16 v53, v43, v72
  v_dot2c_f32_bf16 v55, v43, v43
  v_dot2c_f32_bf16 v52, v44, v72
  v_dot2c_f32_bf16 v54, v44, v44
  v_dot2c_f32_bf16 v53, v45, v72
  v_dot2c_f32_bf16 v55, v45, v45
  v_dot2c_f32_bf16 v52, v46, v72
  v_dot2c_f32_bf16 v54, v46, v46
  v_dot2c_f32_bf16 v53, v47, v72
  v_dot2c_f32_bf16 v55, v47, v47
  s_nop 2
  v_cvt_f64_f32 v[56:57], v48
  v_cvt_f64_f32 v[64:65], v49
  v_cvt_f64_f32 v[58:59], v50
  v_cvt_f64_f32 v[66:67], v51
  v_cvt_f64_f32 v[60:61], v52
  v_cvt_f64_f32 v[68:69], v53
  v_cvt_f64_f32 v[62:63], v54
  v_cvt_f64_f32 v[70:71], v55
  v_add_f64 v[56:57], v[56:57], v[64:65]
  v_add_f64 v[58:59], v[58:59], v[66:67]
  v_add_f64 v[60:61], v[60:61], v[68:69]
  v_add_f64 v[62:63], v[62:63], v[70:71]
  v_mov_b32_dpp v64, v56 row_ror:8 row_mask:0xf bank_mask:0xf
  v_mov_b32_dpp v65, v57 row_ror:8 row_mask:0xf bank_mask:0xf
  v_mov_b32_dpp v66, v58 row_ror:8 row_mask:0xf bank_mask:0xf
  v_mov_b32_dpp v67, v59 row_ror:8 row_mask:0xf bank_mask:0xf
  v_mov_b32_dpp v68, v60 row_ror:8 row_mask:0xf bank_mask:0xf
  v_mov_b32_dpp v69, v61 row_ror:8 row_mask:0xf bank_mask:0xf
  v_mov_b32_dpp v70, v62 row_ror:8 row_mask:0xf bank_mask:0xf
  v_mov_b32_dpp v71, v63 row_ror:8 row_mask:0xf bank_mask:0xf
  v_add_f64 v[56:57], v[56:57], v[64:65]
  v_add_f64 v[58:59], v[58:59], v[66:67]
  v_add_f64 v[60:61], v[60:61], v[68:69]
  v_add_f64 v[62:63], v[62:63], v[70:71]
  v_mov_b32_dpp v64, v56 row_ror:4 row_mask:0xf bank_mask:0xf
  v_mov_b32_dpp v65, v57 row_ror:4 row_mask:0xf bank_mask:0xf
  v_mov_b32_dpp v66, v58 row_ror:4 row_mask:0xf bank_mask:0xf
  v_mov_b32_dpp v67, v59 row_ror:4 row_mask:0xf bank_mask:0xf
  v_mov_b32_dpp v68, v60 row_ror:4 row_mask:0xf bank_mask:0xf
  v_mov_b32_dpp v69, v61 row_ror:4 row_mask:0xf bank_mask:0xf
  v_mov_b32_dpp v70, v62 row_ror:4 row_mask:0xf bank_mask:0xf
  v_mov_b32_dpp v71, v63 row_ror:4 row_mask:0xf bank_mask:0xf
  v_add_f64 v[56:57], v[56:57], v[64:65]
  v_add_f64 v[58:59], v[58:59], v[66:67]
  v_add_f64 v[60:61], v[60:61], v[68:69]
  v_add_f64 v[62:63], v[62:63], v[70:71]
  v_mov_b32_dpp v64, v56 row_ror:2 row_mask:0xf bank_mask:0xf
  v_mov_b32_dpp v65, v57 row_ror:2 row_mask:0xf bank_mask:0xf
  v_mov_b32_dpp v66, v58 row_ror:2 row_mask:0xf bank_mask:0xf
  v_mov_b32_dpp v67, v59 row_ror:2 row_mask:0xf bank_mask:0xf
  v_mov_b32_dpp v68, v60 row_ror:2 row_mask:0xf bank_mask:0xf
  v_mov_b32_dpp v69, v61 row_ror:2 row_mask:0xf bank_mask:0xf
  v_mov_b32_dpp v70, v62 row_ror:2 row_mask:0xf bank_mask:0xf
  v_mov_b32_dpp v71, v63 row_ror:2 row_mask:0xf bank_mask:0xf
  v_add_f64 v[56:57], v[56:57], v[64:65]
  v_add_f64 v[58:59], v[58:59], v[66:67]
  v_add_f64 v[60:61], v[60:61], v[68:69]
  v_add_f64 v[62:63], v[62:63], v[70:71]
  v_mov_b32_dpp v64, v56 row_ror:1 row_mask:0xf bank_mask:0xf
  v_mov_b32_dpp v65, v57 row_ror:1 row_mask:0xf bank_mask:0xf
  v_mov_b32_dpp v66, v58 row_ror:1 row_mask:0xf bank_mask:0xf
  v_mov_b32_dpp v67, v59 row_ror:1 row_mask:0xf bank_mask:0xf
  v_mov_b32_dpp v68, v60 row_ror:1 row_mask:0xf bank_mask:0xf
  v_mov_b32_dpp v69, v61 row_ror:1 row_mask:0xf bank_mask:0xf
  v_mov_b32_dpp v70, v62 row_ror:1 row_mask:0xf bank_mask:0xf
  v_mov_b32_dpp v71, v63 row_ror:1 row_mask:0xf bank_mask:0xf
  v_add_f64 v[56:57], v[56:57], v[64:65]
  v_add_f64 v[58:59], v[58:59], v[66:67]
  v_add_f64 v[60:61], v[60:61], v[68:69]
  v_add_f64 v[62:63], v[62:63], v[70:71]
  v_mul_f64 v[56:57], v[56:57], s[92:93]
  v_mul_f64 v[58:59], v[58:59], s[92:93]
  v_fma_f64 v[58:59], -v[56:57], v[56:57], v[58:59]
  v_cvt_f32_f64 v76, v[56:57]
  v_cvt_f32_f64 v77, v[58:59]
  v_max_f32 v77, 0, v77
  v_cvt_pk_bf16_f32 v78, v76, v76
  v_lshlrev_b32 v78, 16, v78
  v_cvt_pk_bf16_f32 v77, v77, v77
  v_lshlrev_b32 v77, 16, v77
  v_add_f32 v77, s94, v77
  v_cvt_pk_bf16_f32 v77, v77, v77
  v_lshlrev_b32 v77, 16, v77
  v_sqrt_f32 v77, v77
  s_nop 0
  v_cvt_pk_bf16_f32 v79, v77, v77
  v_lshlrev_b32 v79, 16, v79
  v_rcp_f32 v80, v79
  s_nop 0
  v_mul_f32_e64 v81, -v78, v80
  v_cmp_eq_u32 vcc, 0, v6
  s_and_saveexec_b64 s[96:97], vcc
  s_mov_b32 s98, 15810560
  s_mov_b32 s99, 15794176
  buffer_store_dwordx2 v[78:79], v73, s[20:23], s98 offen sc1
  buffer_store_dwordx2 v[80:81], v74, s[20:23], s99 offen sc1
  s_mov_b64 exec, -1
  v_mul_f64 v[60:61], v[60:61], s[92:93]
  v_mul_f64 v[62:63], v[62:63], s[92:93]
  v_fma_f64 v[62:63], -v[60:61], v[60:61], v[62:63]
  v_cvt_f32_f64 v76, v[60:61]
  v_cvt_f32_f64 v77, v[62:63]
  v_max_f32 v77, 0, v77
  v_cvt_pk_bf16_f32 v78, v76, v76
  v_lshlrev_b32 v78, 16, v78
  v_cvt_pk_bf16_f32 v77, v77, v77
  v_lshlrev_b32 v77, 16, v77
  v_add_f32 v77, s94, v77
  v_cvt_pk_bf16_f32 v77, v77, v77
  v_lshlrev_b32 v77, 16, v77
  v_sqrt_f32 v77, v77
  s_nop 0
  v_cvt_pk_bf16_f32 v79, v77, v77
  v_lshlrev_b32 v79, 16, v79
  v_rcp_f32 v80, v79
  s_nop 0
  v_mul_f32_e64 v81, -v78, v80
  v_cmp_eq_u32 vcc, 0, v6
  s_and_saveexec_b64 s[96:97], vcc
  s_mov_b32 s98, 15810592
  s_mov_b32 s99, 15802368
  buffer_store_dwordx2 v[78:79], v73, s[20:23], s98 offen sc1
  buffer_store_dwordx2 v[80:81], v74, s[20:23], s99 offen sc1
  s_mov_b64 exec, -1
  s_branch L_k1_x
L_k1_xc:
  s_cmp_ge_u32 s56, 30
  s_cbranch_scc1 L_k1_idle
  v_lshrrev_b32 v5, 3, v0
  v_and_b32 v6, 7, v0
  v_mul_u32_u24 v7, 3072, v5
  v_lshl_add_u32 v7, v6, 4, v7
  s_and_b32 s58, s57, 1
  s_mul_i32 s58, s58, 30
  s_add_u32 s58, s58, s56
  s_mul_i32 s59, s58, 43
  s_lshr_b32 s59, s59, 9
  s_mul_i32 s60, s59, 12
  s_sub_u32 s60, s58, s60
  s_cmp_ge_u32 s60, 6
  s_cselect_b32 s48, s12, s8
  s_cselect_b32 s49, s13, s9
  s_cselect_b32 s96, 6, 0
  s_cselect_b32 s97, 24, 0
  s_mov_b32 s50, 1966080
  s_mov_b32 s51, 0x00020000
  s_sub_u32 s60, s60, s96
  s_lshr_b32 s96, s57, 1
  s_mul_i32 s96, s96, 6
  s_add_u32 s60, s60, s96
  s_lshl_b32 s96, s60, 7
  s_mul_i32 s98, s59, 393216
  s_add_u32 s96, s96, s98
  s_add_u32 s60, s60, s97
  s_add_u32 s98, s96, 0
  buffer_load_dwordx4 v[8:11], v7, s[48:51], s98 offen
  s_add_u32 s98, s96, 24576
  buffer_load_dwordx4 v[12:15], v7, s[48:51], s98 offen
  s_add_u32 s98, s96, 49152
  buffer_load_dwordx4 v[16:19], v7, s[48:51], s98 offen
  s_add_u32 s98, s96, 73728
  buffer_load_dwordx4 v[20:23], v7, s[48:51], s98 offen
  s_add_u32 s98, s96, 98304
  buffer_load_dwordx4 v[24:27], v7, s[48:51], s98 offen
  s_add_u32 s98, s96, 122880
  buffer_load_dwordx4 v[28:31], v7, s[48:51], s98 offen
  s_add_u32 s98, s96, 147456
  buffer_load_dwordx4 v[32:35], v7, s[48:51], s98 offen
  s_add_u32 s98, s96, 172032
  buffer_load_dwordx4 v[36:39], v7, s[48:51], s98 offen
  s_add_u32 s98, s96, 196608
  buffer_load_dwordx4 v[40:43], v7, s[48:51], s98 offen
  s_add_u32 s98, s96, 221184
  buffer_load_dwordx4 v[44:47], v7, s[48:51], s98 offen
  s_add_u32 s98, s96, 245760
  buffer_load_dwordx4 v[48:51], v7, s[48:51], s98 offen
  s_add_u32 s98, s96, 270336
  buffer_load_dwordx4 v[52:55], v7, s[48:51], s98 offen
  s_add_u32 s98, s96, 294912
  buffer_load_dwordx4 v[56:59], v7, s[48:51], s98 offen
  s_add_u32 s98, s96, 319488
  buffer_load_dwordx4 v[60:63], v7, s[48:51], s98 offen
  s_add_u32 s98, s96, 344064
  buffer_load_dwordx4 v[64:67], v7, s[48:51], s98 offen
  s_add_u32 s98, s96, 368640
  buffer_load_dwordx4 v[68:71], v7, s[48:51], s98 offen
  s_barrier
  v_mov_b32 v80, 0x00003f80
  v_mov_b32 v81, 0x3f800000
  v_mov_b64 v[72:73], 0
  v_mov_b64 v[74:75], 0
  v_mov_b64 v[76:77], 0
  v_mov_b64 v[78:79], 0
  s_waitcnt vmcnt(12)
  v_dot2c_f32_bf16 v72, v8, v80
  v_dot2c_f32_bf16 v73, v8, v81
  v_dot2c_f32_bf16 v74, v9, v80
  v_dot2c_f32_bf16 v75, v9, v81
  v_dot2c_f32_bf16 v76, v10, v80
  v_dot2c_f32_bf16 v77, v10, v81
  v_dot2c_f32_bf16 v78, v11, v80
  v_dot2c_f32_bf16 v79, v11, v81
  v_dot2c_f32_bf16 v72, v12, v80
  v_dot2c_f32_bf16 v73, v12, v81
  v_dot2c_f32_bf16 v74, v13, v80
  v_dot2c_f32_bf16 v75, v13, v81
  v_dot2c_f32_bf16 v76, v14, v80
  v_dot2c_f32_bf16 v77, v14, v81
  v_dot2c_f32_bf16 v78, v15, v80
  v_dot2c_f32_bf16 v79, v15, v81
  v_dot2c_f32_bf16 v72, v16, v80
  v_dot2c_f32_bf16 v73, v16, v81
  v_dot2c_f32_bf16 v74, v17, v80
  v_dot2c_f32_bf16 v75, v17, v81
  v_dot2c_f32_bf16 v76, v18, v80
  v_dot2c_f32_bf16 v77, v18, v81
  v_dot2c_f32_bf16 v78, v19, v80
  v_dot2c_f32_bf16 v79, v19, v81
  v_dot2c_f32_bf16 v72, v20, v80
  v_dot2c_f32_bf16 v73, v20, v81
  v_dot2c_f32_bf16 v74, v21, v80
  v_dot2c_f32_bf16 v75, v21, v81
  v_dot2c_f32_bf16 v76, v22, v80
  v_dot2c_f32_bf16 v77, v22, v81
  v_dot2c_f32_bf16 v78, v23, v80
  v_dot2c_f32_bf16 v79, v23, v81
  s_waitcnt vmcnt(8)
  v_dot2c_f32_bf16 v72, v24, v80
  v_dot2c_f32_bf16 v73, v24, v81
  v_dot2c_f32_bf16 v74, v25, v80
  v_dot2c_f32_bf16 v75, v25, v81
  v_dot2c_f32_bf16 v76, v26, v80
  v_dot2c_f32_bf16 v77, v26, v81
  v_dot2c_f32_bf16 v78, v27, v80
  v_dot2c_f32_bf16 v79, v27, v81
  v_dot2c_f32_bf16 v72, v28, v80
  v_dot2c_f32_bf16 v73, v28, v81
  v_dot2c_f32_bf16 v74, v29, v80
  v_dot2c_f32_bf16 v75, v29, v81
  v_dot2c_f32_bf16 v76, v30, v80
  v_dot2c_f32_bf16 v77, v30, v81
  v_dot2c_f32_bf16 v78, v31, v80
  v_dot2c_f32_bf16 v79, v31, v81
  v_dot2c_f32_bf16 v72, v32, v80
  v_dot2c_f32_bf16 v73, v32, v81
  v_dot2c_f32_bf16 v74, v33, v80
  v_dot2c_f32_bf16 v75, v33, v81
  v_dot2c_f32_bf16 v76, v34, v80
  v_dot2c_f32_bf16 v77, v34, v81
  v_dot2c_f32_bf16 v78, v35, v80
  v_dot2c_f32_bf16 v79, v35, v81
  v_dot2c_f32_bf16 v72, v36, v80
  v_dot2c_f32_bf16 v73, v36, v81
  v_dot2c_f32_bf16 v74, v37, v80
  v_dot2c_f32_bf16 v75, v37, v81
  v_dot2c_f32_bf16 v76, v38, v80
  v_dot2c_f32_bf16 v77, v38, v81
  v_dot2c_f32_bf16 v78, v39, v80
  v_dot2c_f32_bf16 v79, v39, v81
  s_waitcnt vmcnt(4)
  v_dot2c_f32_bf16 v72, v40, v80
  v_dot2c_f32_bf16 v73, v40, v81
  v_dot2c_f32_bf16 v74, v41, v80
  v_dot2c_f32_bf16 v75, v41, v81
  v_dot2c_f32_bf16 v76, v42, v80
  v_dot2c_f32_bf16 v77, v42, v81
  v_dot2c_f32_bf16 v78, v43, v80
  v_dot2c_f32_bf16 v79, v43, v81
  v_dot2c_f32_bf16 v72, v44, v80
  v_dot2c_f32_bf16 v73, v44, v81
  v_dot2c_f32_bf16 v74, v45, v80
  v_dot2c_f32_bf16 v75, v45, v81
  v_dot2c_f32_bf16 v76, v46, v80
  v_dot2c_f32_bf16 v77, v46, v81
  v_dot2c_f32_bf16 v78, v47, v80
  v_dot2c_f32_bf16 v79, v47, v81
  v_dot2c_f32_bf16 v72, v48, v80
  v_dot2c_f32_bf16 v73, v48, v81
  v_dot2c_f32_bf16 v74, v49, v80
  v_dot2c_f32_bf16 v75, v49, v81
  v_dot2c_f32_bf16 v76, v50, v80
  v_dot2c_f32_bf16 v77, v50, v81
  v_dot2c_f32_bf16 v78, v51, v80
  v_dot2c_f32_bf16 v79, v51, v81
  v_dot2c_f32_bf16 v72, v52, v80
  v_dot2c_f32_bf16 v73, v52, v81
  v_dot2c_f32_bf16 v74, v53, v80
  v_dot2c_f32_bf16 v75, v53, v81
  v_dot2c_f32_bf16 v76, v54, v80
  v_dot2c_f32_bf16 v77, v54, v81
  v_dot2c_f32_bf16 v78, v55, v80
  v_dot2c_f32_bf16 v79, v55, v81
  s_waitcnt vmcnt(0)
  v_dot2c_f32_bf16 v72, v56, v80
  v_dot2c_f32_bf16 v73, v56, v81
  v_dot2c_f32_bf16 v74, v57, v80
  v_dot2c_f32_bf16 v75, v57, v81
  v_dot2c_f32_bf16 v76, v58, v80
  v_dot2c_f32_bf16 v77, v58, v81
  v_dot2c_f32_bf16 v78, v59, v80
  v_dot2c_f32_bf16 v79, v59, v81
  v_dot2c_f32_bf16 v72, v60, v80
  v_dot2c_f32_bf16 v73, v60, v81
  v_dot2c_f32_bf16 v74, v61, v80
  v_dot2c_f32_bf16 v75, v61, v81
  v_dot2c_f32_bf16 v76, v62, v80
  v_dot2c_f32_bf16 v77, v62, v81
  v_dot2c_f32_bf16 v78, v63, v80
  v_dot2c_f32_bf16 v79, v63, v81
  v_dot2c_f32_bf16 v72, v64, v80
  v_dot2c_f32_bf16 v73, v64, v81
  v_dot2c_f32_bf16 v74, v65, v80
  v_dot2c_f32_bf16 v75, v65, v81
  v_dot2c_f32_bf16 v76, v66, v80
  v_dot2c_f32_bf16 v77, v66, v81
  v_dot2c_f32_bf16 v78, v67, v80
  v_dot2c_f32_bf16 v79, v67, v81
  v_dot2c_f32_bf16 v72, v68, v80
  v_dot2c_f32_bf16 v73, v68, v81
  v_dot2c_f32_bf16 v74, v69, v80
  v_dot2c_f32_bf16 v75, v69, v81
  v_dot2c_f32_bf16 v76, v70, v80
  v_dot2c_f32_bf16 v77, v70, v81
  v_dot2c_f32_bf16 v78, v71, v80
  v_dot2c_f32_bf16 v79, v71, v81
  v_lshlrev_b32 v80, 5, v0
  v_add_u32 v80, 129024, v80
  v_lshlrev_b32 v81, 2, v0
  v_add_u32 v82, 129024, v81
  ds_write_b128 v80, v[72:75]
  ds_write_b128 v80, v[76:79] offset:16
  ds_read_b32 v8, v82 offset:0
  ds_read_b32 v9, v82 offset:256
  ds_read_b32 v10, v82 offset:512
  ds_read_b32 v11, v82 offset:768
  ds_read_b32 v12, v82 offset:1024
  ds_read_b32 v13, v82 offset:1280
  ds_read_b32 v14, v82 offset:1536
  ds_read_b32 v15, v82 offset:1792
  s_waitcnt lgkmcnt(0)
  v_add_f32 v8, v8, v9
  v_add_f32 v8, v8, v10
  v_add_f32 v8, v8, v11
  v_add_f32 v8, v8, v12
  v_add_f32 v8, v8, v13
  v_add_f32 v8, v8, v14
  v_add_f32 v8, v8, v15
  s_mul_i32 s96, s59, 12288
  s_lshl_b32 s97, s60, 8
  s_add_u32 s96, s96, s97
  s_add_u32 s96, s96, 15826944
  buffer_store_dword v8, v81, s[20:23], s96 offen sc1
  s_branch L_k1_x
L_k1_xu:
  s_sub_u32 s94, s3, 13
  s_mov_b32 s95, 141568
  s_cmp_ge_u32 s56, 20
  s_cselect_b32 s96, 12, 9
  s_lshl_b32 s96, s96, 10
  s_mul_i32 s96, s96, s94
  s_add_u32 s95, s95, s96
  v_lshrrev_b32 v100, 3, v0
  v_and_b32 v101, 7, v0
  v_mul_u32_u24 v102, 1280, v100
  v_lshl_add_u32 v102, v101, 4, v102
  s_cmp_ge_u32 s56, 20
  s_cbranch_scc1 L_uwd_32
  s_lshr_b32 s96, s57, 1
  s_mul_i32 s96, s96, 20
  s_add_u32 s96, s96, s56
  s_mul_i32 s97, s96, 103
  s_lshr_b32 s97, s97, 10
  s_mul_i32 s98, s97, 10
  s_sub_u32 s62, s96, s98
  s_and_b32 s96, s57, 1
  s_lshl_b32 s96, s96, 3
  s_add_u32 s97, s97, s96
  s_lshl_b32 s97, s97, 1
  s_add_u32 s97, s97, s94
  s_lshl_b32 s61, s97, 6
  s_mul_i32 s96, s61, 1280
  s_lshl_b32 s97, s62, 7
  s_add_u32 s96, s96, s97
  s_add_u32 m0, s95, 0
  s_add_u32 s97, s96, 0
  buffer_load_dwordx4 v102, s[4:7], s97 offen lds
  s_add_u32 m0, s95, 1024
  s_add_u32 s97, s96, 10240
  buffer_load_dwordx4 v102, s[4:7], s97 offen lds
  s_add_u32 m0, s95, 2048
  s_add_u32 s97, s96, 20480
  buffer_load_dwordx4 v102, s[4:7], s97 offen lds
  s_add_u32 m0, s95, 3072
  s_add_u32 s97, s96, 30720
  buffer_load_dwordx4 v102, s[4:7], s97 offen lds
  s_add_u32 m0, s95, 4096
  s_add_u32 s97, s96, 40960
  buffer_load_dwordx4 v102, s[4:7], s97 offen lds
  s_add_u32 m0, s95, 5120
  s_add_u32 s97, s96, 51200
  buffer_load_dwordx4 v102, s[4:7], s97 offen lds
  s_add_u32 m0, s95, 6144
  s_add_u32 s97, s96, 61440
  buffer_load_dwordx4 v102, s[4:7], s97 offen lds
  s_add_u32 m0, s95, 7168
  s_add_u32 s97, s96, 71680
  buffer_load_dwordx4 v102, s[4:7], s97 offen lds
  s_branch L_upe_33
L_uwd_32:
  s_mul_i32 s96, s57, 12
  s_add_u32 s96, s96, s56
  s_sub_u32 s96, s96, 20
  s_lshr_b32 s61, s96, 1
  s_and_b32 s96, s96, 1
  s_mul_i32 s96, s96, 5
  s_mul_i32 s97, s94, 3
  s_add_u32 s62, s96, s97
  s_mul_i32 s96, s61, 40960
  s_lshl_b32 s97, s62, 7
  s_add_u32 s96, s96, s97
  s_add_u32 m0, s95, 0
  s_add_u32 s97, s96, 0
  buffer_load_dwordx4 v102, s[16:19], s97 offen lds
  s_add_u32 m0, s95, 1024
  s_add_u32 s97, s96, 10240
  buffer_load_dwordx4 v102, s[16:19], s97 offen lds
  s_add_u32 m0, s95, 2048
  s_add_u32 s97, s96, 20480
  buffer_load_dwordx4 v102, s[16:19], s97 offen lds
  s_add_u32 m0, s95, 3072
  s_add_u32 s97, s96, 30720
  buffer_load_dwordx4 v102, s[16:19], s97 offen lds
  s_add_u32 m0, s95, 4096
  s_add_u32 s97, s96, 128
  buffer_load_dwordx4 v102, s[16:19], s97 offen lds
  s_add_u32 m0, s95, 5120
  s_add_u32 s97, s96, 10368
  buffer_load_dwordx4 v102, s[16:19], s97 offen lds
  s_add_u32 m0, s95, 6144
  s_add_u32 s97, s96, 20608
  buffer_load_dwordx4 v102, s[16:19], s97 offen lds
  s_add_u32 m0, s95, 7168
  s_add_u32 s97, s96, 30848
  buffer_load_dwordx4 v102, s[16:19], s97 offen lds
  s_cmp_eq_u32 s94, 1
  s_cbranch_scc1 L_upe_33
  s_add_u32 m0, s95, 8192
  s_add_u32 s97, s96, 256
  buffer_load_dwordx4 v102, s[16:19], s97 offen lds
  s_add_u32 m0, s95, 9216
  s_add_u32 s97, s96, 10496
  buffer_load_dwordx4 v102, s[16:19], s97 offen lds
  s_add_u32 m0, s95, 10240
  s_add_u32 s97, s96, 20736
  buffer_load_dwordx4 v102, s[16:19], s97 offen lds
  s_add_u32 m0, s95, 11264
  s_add_u32 s97, s96, 30976
  buffer_load_dwordx4 v102, s[16:19], s97 offen lds
L_upe_33:
  s_barrier
  v_lshrrev_b32 v103, 2, v0
  v_and_b32 v104, 3, v0
  v_lshlrev_b32 v103, 7, v103
  v_lshl_add_u32 v103, v104, 3, v103
  v_add_u32 v103, s95, v103
  s_waitcnt vmcnt(0)
  s_cmp_ge_u32 s56, 20
  s_cbranch_scc1 L_uwd_34
  v_and_b32 v104, 15, v0
  v_lshrrev_b32 v105, 4, v0
  v_mul_u32_u24 v104, 144, v104
  v_lshl_add_u32 v104, v105, 3, v104
  s_mov_b32 s96, s95
  v_add_u32 v104, s96, v104
  v_mul_u32_u24 v105, 144, v100
  v_lshl_add_u32 v105, v101, 4, v105
  v_add_u32 v105, s96, v105
  v_lshlrev_b32 v106, 12, v100
  v_lshl_add_u32 v106, v101, 4, v106
  ds_read_b64_tr_b16 v[8:9], v103 offset:0
  ds_read_b64_tr_b16 v[10:11], v103 offset:2048
  ds_read_b64_tr_b16 v[12:13], v103 offset:4096
  ds_read_b64_tr_b16 v[14:15], v103 offset:6144
  ds_read_b64_tr_b16 v[16:17], v103 offset:32
  ds_read_b64_tr_b16 v[18:19], v103 offset:2080
  ds_read_b64_tr_b16 v[20:21], v103 offset:4128
  ds_read_b64_tr_b16 v[22:23], v103 offset:6176
  ds_read_b64_tr_b16 v[24:25], v103 offset:64
  ds_read_b64_tr_b16 v[26:27], v103 offset:2112
  ds_read_b64_tr_b16 v[28:29], v103 offset:4160
  ds_read_b64_tr_b16 v[30:31], v103 offset:6208
  ds_read_b64_tr_b16 v[32:33], v103 offset:96
  ds_read_b64_tr_b16 v[34:35], v103 offset:2144
  ds_read_b64_tr_b16 v[36:37], v103 offset:4192
  ds_read_b64_tr_b16 v[38:39], v103 offset:6240
  s_waitcnt lgkmcnt(15)
  ds_write_b64 v104, v[8:9] offset:0
  s_waitcnt lgkmcnt(15)
  ds_write_b64 v104, v[10:11] offset:32
  s_waitcnt lgkmcnt(15)
  ds_write_b64 v104, v[12:13] offset:64
  s_waitcnt lgkmcnt(15)
  ds_write_b64 v104, v[14:15] offset:96
  s_waitcnt lgkmcnt(15)
  ds_write_b64 v104, v[16:17] offset:2304
  s_waitcnt lgkmcnt(15)
  ds_write_b64 v104, v[18:19] offset:2336
  s_waitcnt lgkmcnt(15)
  ds_write_b64 v104, v[20:21] offset:2368
  s_waitcnt lgkmcnt(15)
  ds_write_b64 v104, v[22:23] offset:2400
  s_waitcnt lgkmcnt(15)
  ds_write_b64 v104, v[24:25] offset:4608
  s_waitcnt lgkmcnt(15)
  ds_write_b64 v104, v[26:27] offset:4640
  s_waitcnt lgkmcnt(15)
  ds_write_b64 v104, v[28:29] offset:4672
  s_waitcnt lgkmcnt(15)
  ds_write_b64 v104, v[30:31] offset:4704
  s_waitcnt lgkmcnt(15)
  ds_write_b64 v104, v[32:33] offset:6912
  s_waitcnt lgkmcnt(15)
  ds_write_b64 v104, v[34:35] offset:6944
  s_waitcnt lgkmcnt(15)
  ds_write_b64 v104, v[36:37] offset:6976
  s_waitcnt lgkmcnt(15)
  ds_write_b64 v104, v[38:39] offset:7008
  ds_read_b128 v[48:51], v105 offset:0
  ds_read_b128 v[52:55], v105 offset:1152
  ds_read_b128 v[56:59], v105 offset:2304
  ds_read_b128 v[60:63], v105 offset:3456
  ds_read_b128 v[64:67], v105 offset:4608
  ds_read_b128 v[68:71], v105 offset:5760
  ds_read_b128 v[72:75], v105 offset:6912
  ds_read_b128 v[76:79], v105 offset:8064
  s_lshl_b32 s96, s62, 18
  s_lshl_b32 s97, s61, 1
  s_add_u32 s96, s96, s97
  s_add_u32 s96, s96, 8257536
  s_waitcnt lgkmcnt(7)
  s_add_u32 s97, s96, 0
  buffer_store_dwordx4 v[48:51], v106, s[20:23], s97 offen sc1
  s_waitcnt lgkmcnt(6)
  s_add_u32 s97, s96, 32768
  buffer_store_dwordx4 v[52:55], v106, s[20:23], s97 offen sc1
  s_waitcnt lgkmcnt(5)
  s_add_u32 s97, s96, 65536
  buffer_store_dwordx4 v[56:59], v106, s[20:23], s97 offen sc1
  s_waitcnt lgkmcnt(4)
  s_add_u32 s97, s96, 98304
  buffer_store_dwordx4 v[60:63], v106, s[20:23], s97 offen sc1
  s_waitcnt lgkmcnt(3)
  s_add_u32 s97, s96, 131072
  buffer_store_dwordx4 v[64:67], v106, s[20:23], s97 offen sc1
  s_waitcnt lgkmcnt(2)
  s_add_u32 s97, s96, 163840
  buffer_store_dwordx4 v[68:71], v106, s[20:23], s97 offen sc1
  s_waitcnt lgkmcnt(1)
  s_add_u32 s97, s96, 196608
  buffer_store_dwordx4 v[72:75], v106, s[20:23], s97 offen sc1
  s_waitcnt lgkmcnt(0)
  s_add_u32 s97, s96, 229376
  buffer_store_dwordx4 v[76:79], v106, s[20:23], s97 offen sc1
  s_branch L_uend_35
L_uwd_34:
  v_lshlrev_b32 v106, 4, v0
  s_mul_i32 s63, s61, 5120
  s_add_u32 s63, s63, 6291456
  ds_read_b64_tr_b16 v[8:9], v103 offset:0
  ds_read_b64_tr_b16 v[10:11], v103 offset:2048
  ds_read_b64_tr_b16 v[12:13], v103 offset:32
  ds_read_b64_tr_b16 v[14:15], v103 offset:2080
  ds_read_b64_tr_b16 v[16:17], v103 offset:64
  ds_read_b64_tr_b16 v[18:19], v103 offset:2112
  ds_read_b64_tr_b16 v[20:21], v103 offset:96
  ds_read_b64_tr_b16 v[22:23], v103 offset:2144
  s_lshl_b32 s96, s62, 2
  s_add_u32 s96, s96, 0
  s_mul_i32 s97, s96, 52
  s_lshr_b32 s97, s97, 8
  s_mul_i32 s98, s97, 5
  s_sub_u32 s96, s96, s98
  s_mul_i32 s97, s97, 245760
  s_lshl_b32 s96, s96, 10
  s_add_u32 s96, s96, s97
  s_add_u32 s96, s96, s63
  s_waitcnt lgkmcnt(6)
  buffer_store_dwordx4 v[8:11], v106, s[20:23], s96 offen sc1
  s_lshl_b32 s96, s62, 2
  s_add_u32 s96, s96, 1
  s_mul_i32 s97, s96, 52
  s_lshr_b32 s97, s97, 8
  s_mul_i32 s98, s97, 5
  s_sub_u32 s96, s96, s98
  s_mul_i32 s97, s97, 245760
  s_lshl_b32 s96, s96, 10
  s_add_u32 s96, s96, s97
  s_add_u32 s96, s96, s63
  s_waitcnt lgkmcnt(4)
  buffer_store_dwordx4 v[12:15], v106, s[20:23], s96 offen sc1
  s_lshl_b32 s96, s62, 2
  s_add_u32 s96, s96, 2
  s_mul_i32 s97, s96, 52
  s_lshr_b32 s97, s97, 8
  s_mul_i32 s98, s97, 5
  s_sub_u32 s96, s96, s98
  s_mul_i32 s97, s97, 245760
  s_lshl_b32 s96, s96, 10
  s_add_u32 s96, s96, s97
  s_add_u32 s96, s96, s63
  s_waitcnt lgkmcnt(2)
  buffer_store_dwordx4 v[16:19], v106, s[20:23], s96 offen sc1
  s_lshl_b32 s96, s62, 2
  s_add_u32 s96, s96, 3
  s_mul_i32 s97, s96, 52
  s_lshr_b32 s97, s97, 8
  s_mul_i32 s98, s97, 5
  s_sub_u32 s96, s96, s98
  s_mul_i32 s97, s97, 245760
  s_lshl_b32 s96, s96, 10
  s_add_u32 s96, s96, s97
  s_add_u32 s96, s96, s63
  s_waitcnt lgkmcnt(0)
  buffer_store_dwordx4 v[20:23], v106, s[20:23], s96 offen sc1
  ds_read_b64_tr_b16 v[24:25], v103 offset:4096
  ds_read_b64_tr_b16 v[26:27], v103 offset:6144
  ds_read_b64_tr_b16 v[28:29], v103 offset:4128
  ds_read_b64_tr_b16 v[30:31], v103 offset:6176
  ds_read_b64_tr_b16 v[32:33], v103 offset:4160
  ds_read_b64_tr_b16 v[34:35], v103 offset:6208
  ds_read_b64_tr_b16 v[36:37], v103 offset:4192
  ds_read_b64_tr_b16 v[38:39], v103 offset:6240
  s_lshl_b32 s96, s62, 2
  s_add_u32 s96, s96, 4
  s_mul_i32 s97, s96, 52
  s_lshr_b32 s97, s97, 8
  s_mul_i32 s98, s97, 5
  s_sub_u32 s96, s96, s98
  s_mul_i32 s97, s97, 245760
  s_lshl_b32 s96, s96, 10
  s_add_u32 s96, s96, s97
  s_add_u32 s96, s96, s63
  s_waitcnt lgkmcnt(6)
  buffer_store_dwordx4 v[24:27], v106, s[20:23], s96 offen sc1
  s_lshl_b32 s96, s62, 2
  s_add_u32 s96, s96, 5
  s_mul_i32 s97, s96, 52
  s_lshr_b32 s97, s97, 8
  s_mul_i32 s98, s97, 5
  s_sub_u32 s96, s96, s98
  s_mul_i32 s97, s97, 245760
  s_lshl_b32 s96, s96, 10
  s_add_u32 s96, s96, s97
  s_add_u32 s96, s96, s63
  s_waitcnt lgkmcnt(4)
  buffer_store_dwordx4 v[28:31], v106, s[20:23], s96 offen sc1
  s_lshl_b32 s96, s62, 2
  s_add_u32 s96, s96, 6
  s_mul_i32 s97, s96, 52
  s_lshr_b32 s97, s97, 8
  s_mul_i32 s98, s97, 5
  s_sub_u32 s96, s96, s98
  s_mul_i32 s97, s97, 245760
  s_lshl_b32 s96, s96, 10
  s_add_u32 s96, s96, s97
  s_add_u32 s96, s96, s63
  s_waitcnt lgkmcnt(2)
  buffer_store_dwordx4 v[32:35], v106, s[20:23], s96 offen sc1
  s_lshl_b32 s96, s62, 2
  s_add_u32 s96, s96, 7
  s_mul_i32 s97, s96, 52
  s_lshr_b32 s97, s97, 8
  s_mul_i32 s98, s97, 5
  s_sub_u32 s96, s96, s98
  s_mul_i32 s97, s97, 245760
  s_lshl_b32 s96, s96, 10
  s_add_u32 s96, s96, s97
  s_add_u32 s96, s96, s63
  s_waitcnt lgkmcnt(0)
  buffer_store_dwordx4 v[36:39], v106, s[20:23], s96 offen sc1
  s_cmp_eq_u32 s94, 1
  s_cbranch_scc1 L_uend_35
  ds_read_b64_tr_b16 v[40:41], v103 offset:8192
  ds_read_b64_tr_b16 v[42:43], v103 offset:10240
  ds_read_b64_tr_b16 v[44:45], v103 offset:8224
  ds_read_b64_tr_b16 v[46:47], v103 offset:10272
  ds_read_b64_tr_b16 v[48:49], v103 offset:8256
  ds_read_b64_tr_b16 v[50:51], v103 offset:10304
  ds_read_b64_tr_b16 v[52:53], v103 offset:8288
  ds_read_b64_tr_b16 v[54:55], v103 offset:10336
  s_lshl_b32 s96, s62, 2
  s_add_u32 s96, s96, 8
  s_mul_i32 s97, s96, 52
  s_lshr_b32 s97, s97, 8
  s_mul_i32 s98, s97, 5
  s_sub_u32 s96, s96, s98
  s_mul_i32 s97, s97, 245760
  s_lshl_b32 s96, s96, 10
  s_add_u32 s96, s96, s97
  s_add_u32 s96, s96, s63
  s_waitcnt lgkmcnt(6)
  buffer_store_dwordx4 v[40:43], v106, s[20:23], s96 offen sc1
  s_lshl_b32 s96, s62, 2
  s_add_u32 s96, s96, 9
  s_mul_i32 s97, s96, 52
  s_lshr_b32 s97, s97, 8
  s_mul_i32 s98, s97, 5
  s_sub_u32 s96, s96, s98
  s_mul_i32 s97, s97, 245760
  s_lshl_b32 s96, s96, 10
  s_add_u32 s96, s96, s97
  s_add_u32 s96, s96, s63
  s_waitcnt lgkmcnt(4)
  buffer_store_dwordx4 v[44:47], v106, s[20:23], s96 offen sc1
  s_lshl_b32 s96, s62, 2
  s_add_u32 s96, s96, 10
  s_mul_i32 s97, s96, 52
  s_lshr_b32 s97, s97, 8
  s_mul_i32 s98, s97, 5
  s_sub_u32 s96, s96, s98
  s_mul_i32 s97, s97, 245760
  s_lshl_b32 s96, s96, 10
  s_add_u32 s96, s96, s97
  s_add_u32 s96, s96, s63
  s_waitcnt lgkmcnt(2)
  buffer_store_dwordx4 v[48:51], v106, s[20:23], s96 offen sc1
  s_lshl_b32 s96, s62, 2
  s_add_u32 s96, s96, 11
  s_mul_i32 s97, s96, 52
  s_lshr_b32 s97, s97, 8
  s_mul_i32 s98, s97, 5
  s_sub_u32 s96, s96, s98
  s_mul_i32 s97, s97, 245760
  s_lshl_b32 s96, s96, 10
  s_add_u32 s96, s96, s97
  s_add_u32 s96, s96, s63
  s_waitcnt lgkmcnt(0)
  buffer_store_dwordx4 v[52:55], v106, s[20:23], s96 offen sc1
L_uend_35:
  s_branch L_k1_x
L_k1_pdone:
  s_cmp_ge_u32 s3, 10
  s_cbranch_scc1 L_k1_x0
  s_cmp_ge_u32 s56, 30
  s_cbranch_scc1 L_k1_gsp
  s_cmp_ge_u32 s3, 6
  s_cbranch_scc1 L_k1_g2
  s_cmp_ge_u32 s3, 4
  s_cbranch_scc1 L_k1_g1
L_k1_g0:
  s_sub_u32 s62, s3, 2
  s_and_b32 s95, s62, 1
  s_lshr_b32 s94, s62, 1
  v_and_b32 v38, 15, v0
  v_lshrrev_b32 v39, 4, v0
  v_and_b32 v40, 7, v38
  v_xor_b32 v40, v40, v39
  v_lshlrev_b32 v2, 7, v38
  v_lshl_add_u32 v2, v40, 4, v2
  s_mul_i32 s62, s94, 6144
  v_add_u32 v2, s62, v2
  v_xor_b32 v3, 64, v2
  v_lshrrev_b32 v40, 2, v38
  v_and_b32 v41, 3, v38
  v_lshrrev_b32 v42, 1, v40
  v_and_b32 v43, 1, v39
  v_lshl_or_b32 v42, v43, 1, v42
  s_lshl_b32 s62, s95, 1
  v_xor_b32 v42, s62, v42
  v_lshl_add_u32 v43, v39, 3, v40
  v_lshlrev_b32 v4, 7, v43
  v_lshl_add_u32 v4, v42, 5, v4
  v_lshl_add_u32 v4, v41, 3, v4
  v_add_u32 v4, 26624, v4
  v_xor_b32 v5, 32, v4
  v_mov_b64 v[70:71], 0
  v_mov_b64 v[72:73], 0
  v_mov_b64 v[74:75], 0
  v_mov_b64 v[76:77], 0
  v_mov_b64 v[78:79], 0
  v_mov_b64 v[80:81], 0
  v_mov_b64 v[82:83], 0
  v_mov_b64 v[84:85], 0
  v_mov_b64 v[86:87], 0
  v_mov_b64 v[88:89], 0
  v_mov_b64 v[90:91], 0
  v_mov_b64 v[92:93], 0
  v_mov_b64 v[94:95], 0
  v_mov_b64 v[96:97], 0
  v_mov_b64 v[98:99], 0
  v_mov_b64 v[100:101], 0
  v_mov_b64 v[102:103], 0
  v_mov_b64 v[104:105], 0
  v_mov_b64 v[106:107], 0
  v_mov_b64 v[108:109], 0
  v_mov_b64 v[110:111], 0
  v_mov_b64 v[112:113], 0
  v_mov_b64 v[114:115], 0
  v_mov_b64 v[116:117], 0
  v_mov_b64 v[118:119], 0
  v_mov_b64 v[120:121], 0
  v_mov_b64 v[122:123], 0
  v_mov_b64 v[124:125], 0
  s_cmp_eq_u32 s70, 0
  s_cbranch_scc1 L_p1_36
  s_waitcnt lgkmcnt(0)
  s_barrier
L_p1_36:
  s_mov_b32 s60, 0
  s_mov_b32 s58, 0
  s_mov_b32 s63, 4294881280
  s_setprio 2
  s_waitcnt lgkmcnt(0)
  s_barrier
  ds_read_b64_tr_b16 v[6:7], v4 offset:0
  ds_read_b64_tr_b16 v[8:9], v4 offset:512
  ds_read_b128 v[38:41], v2 offset:0
  ds_read_b64_tr_b16 v[10:11], v4 offset:8192
  ds_read_b64_tr_b16 v[12:13], v4 offset:8704
  ds_read_b64_tr_b16 v[14:15], v5 offset:0
  ds_read_b64_tr_b16 v[16:17], v5 offset:512
  ds_read_b64_tr_b16 v[18:19], v5 offset:8192
  ds_read_b64_tr_b16 v[20:21], v5 offset:8704
  ds_read_b128 v[42:45], v2 offset:2048
  ds_read_b128 v[46:49], v2 offset:4096
  ds_read_b128 v[50:53], v2 offset:24576
L_gloop_37:
  s_waitcnt lgkmcnt(9)
  v_mfma_f32_16x16x32_bf16 v[70:73], v[6:9], v[38:41], v[70:73]
  ds_read_b64_tr_b16 v[22:23], v4 offset:4096
  s_waitcnt lgkmcnt(8)
  v_mfma_f32_16x16x32_bf16 v[74:77], v[10:13], v[38:41], v[74:77]
  ds_read_b64_tr_b16 v[24:25], v4 offset:4608
  s_waitcnt lgkmcnt(7)
  v_mfma_f32_16x16x32_bf16 v[78:81], v[14:17], v[38:41], v[78:81]
  ds_read_b128 v[54:57], v3 offset:0
  s_waitcnt lgkmcnt(6)
  v_mfma_f32_16x16x32_bf16 v[82:85], v[18:21], v[38:41], v[82:85]
  ds_read_b64_tr_b16 v[26:27], v4 offset:12288
  s_waitcnt lgkmcnt(6)
  v_mfma_f32_16x16x32_bf16 v[86:89], v[6:9], v[42:45], v[86:89]
  ds_read_b64_tr_b16 v[28:29], v4 offset:12800
  v_mfma_f32_16x16x32_bf16 v[90:93], v[10:13], v[42:45], v[90:93]
  ds_read_b64_tr_b16 v[30:31], v5 offset:4096
  v_mfma_f32_16x16x32_bf16 v[94:97], v[14:17], v[42:45], v[94:97]
  ds_read_b64_tr_b16 v[32:33], v5 offset:4608
  v_mfma_f32_16x16x32_bf16 v[98:101], v[18:21], v[42:45], v[98:101]
  ds_read_b64_tr_b16 v[34:35], v5 offset:12288
  s_waitcnt lgkmcnt(9)
  v_mfma_f32_16x16x32_bf16 v[102:105], v[6:9], v[46:49], v[102:105]
  ds_read_b64_tr_b16 v[36:37], v5 offset:12800
  v_mfma_f32_16x16x32_bf16 v[106:109], v[10:13], v[46:49], v[106:109]
  ds_read_b128 v[58:61], v3 offset:2048
  v_mfma_f32_16x16x32_bf16 v[110:113], v[14:17], v[46:49], v[110:113]
  ds_read_b128 v[62:65], v3 offset:4096
  v_mfma_f32_16x16x32_bf16 v[114:117], v[18:21], v[46:49], v[114:117]
  ds_read_b128 v[66:69], v3 offset:24576
  s_waitcnt lgkmcnt(12)
  v_mfma_f32_16x16x32_bf16 v[118:121], v[6:9], v[50:53], v[118:121]
  v_mfma_f32_16x16x32_bf16 v[122:125], v[10:13], v[50:53], v[122:125]
  s_add_u32 s60, s60, 1
  s_cmp_eq_u32 s60, 3
  s_cselect_b32 s62, s63, 43008
  s_cselect_b32 s60, 0, s60
  s_waitcnt lgkmcnt(0)
  s_waitcnt vmcnt(0)
  v_add_u32 v4, s62, v4
  v_add_u32 v2, s62, v2
  v_add_u32 v5, s62, v5
  v_add_u32 v3, s62, v3
  s_barrier
  v_mfma_f32_16x16x32_bf16 v[70:73], v[22:25], v[54:57], v[70:73]
  ds_read_b64_tr_b16 v[6:7], v4 offset:0
  v_mfma_f32_16x16x32_bf16 v[74:77], v[26:29], v[54:57], v[74:77]
  ds_read_b64_tr_b16 v[8:9], v4 offset:512
  v_mfma_f32_16x16x32_bf16 v[78:81], v[30:33], v[54:57], v[78:81]
  ds_read_b128 v[38:41], v2 offset:0
  v_mfma_f32_16x16x32_bf16 v[82:85], v[34:37], v[54:57], v[82:85]
  ds_read_b64_tr_b16 v[10:11], v4 offset:8192
  v_mfma_f32_16x16x32_bf16 v[86:89], v[22:25], v[58:61], v[86:89]
  ds_read_b64_tr_b16 v[12:13], v4 offset:8704
  v_mfma_f32_16x16x32_bf16 v[90:93], v[26:29], v[58:61], v[90:93]
  ds_read_b64_tr_b16 v[14:15], v5 offset:0
  v_mfma_f32_16x16x32_bf16 v[94:97], v[30:33], v[58:61], v[94:97]
  ds_read_b64_tr_b16 v[16:17], v5 offset:512
  v_mfma_f32_16x16x32_bf16 v[98:101], v[34:37], v[58:61], v[98:101]
  ds_read_b64_tr_b16 v[18:19], v5 offset:8192
  v_mfma_f32_16x16x32_bf16 v[102:105], v[22:25], v[62:65], v[102:105]
  ds_read_b64_tr_b16 v[20:21], v5 offset:8704
  v_mfma_f32_16x16x32_bf16 v[106:109], v[26:29], v[62:65], v[106:109]
  ds_read_b128 v[42:45], v2 offset:2048
  v_mfma_f32_16x16x32_bf16 v[110:113], v[30:33], v[62:65], v[110:113]
  ds_read_b128 v[46:49], v2 offset:4096
  v_mfma_f32_16x16x32_bf16 v[114:117], v[34:37], v[62:65], v[114:117]
  ds_read_b128 v[50:53], v2 offset:24576
  v_mfma_f32_16x16x32_bf16 v[118:121], v[22:25], v[66:69], v[118:121]
  v_mfma_f32_16x16x32_bf16 v[122:125], v[26:29], v[66:69], v[122:125]
  s_add_u32 s58, s58, 1
  s_cmp_lt_u32 s58, 9
  s_cbranch_scc1 L_gloop_37
  s_waitcnt lgkmcnt(9)
  v_mfma_f32_16x16x32_bf16 v[70:73], v[6:9], v[38:41], v[70:73]
  ds_read_b64_tr_b16 v[22:23], v4 offset:4096
  s_waitcnt lgkmcnt(8)
  v_mfma_f32_16x16x32_bf16 v[74:77], v[10:13], v[38:41], v[74:77]
  ds_read_b64_tr_b16 v[24:25], v4 offset:4608
  s_waitcnt lgkmcnt(7)
  v_mfma_f32_16x16x32_bf16 v[78:81], v[14:17], v[38:41], v[78:81]
  ds_read_b128 v[54:57], v3 offset:0
  s_waitcnt lgkmcnt(6)
  v_mfma_f32_16x16x32_bf16 v[82:85], v[18:21], v[38:41], v[82:85]
  ds_read_b64_tr_b16 v[26:27], v4 offset:12288
  s_waitcnt lgkmcnt(6)
  v_mfma_f32_16x16x32_bf16 v[86:89], v[6:9], v[42:45], v[86:89]
  ds_read_b64_tr_b16 v[28:29], v4 offset:12800
  v_mfma_f32_16x16x32_bf16 v[90:93], v[10:13], v[42:45], v[90:93]
  ds_read_b64_tr_b16 v[30:31], v5 offset:4096
  v_mfma_f32_16x16x32_bf16 v[94:97], v[14:17], v[42:45], v[94:97]
  ds_read_b64_tr_b16 v[32:33], v5 offset:4608
  v_mfma_f32_16x16x32_bf16 v[98:101], v[18:21], v[42:45], v[98:101]
  ds_read_b64_tr_b16 v[34:35], v5 offset:12288
  s_waitcnt lgkmcnt(9)
  v_mfma_f32_16x16x32_bf16 v[102:105], v[6:9], v[46:49], v[102:105]
  ds_read_b64_tr_b16 v[36:37], v5 offset:12800
  v_mfma_f32_16x16x32_bf16 v[106:109], v[10:13], v[46:49], v[106:109]
  ds_read_b128 v[58:61], v3 offset:2048
  v_mfma_f32_16x16x32_bf16 v[110:113], v[14:17], v[46:49], v[110:113]
  ds_read_b128 v[62:65], v3 offset:4096
  v_mfma_f32_16x16x32_bf16 v[114:117], v[18:21], v[46:49], v[114:117]
  ds_read_b128 v[66:69], v3 offset:24576
  s_waitcnt lgkmcnt(12)
  v_mfma_f32_16x16x32_bf16 v[118:121], v[6:9], v[50:53], v[118:121]
  v_mfma_f32_16x16x32_bf16 v[122:125], v[10:13], v[50:53], v[122:125]
  s_waitcnt lgkmcnt(0)
  v_mov_b32 v2, 163776
  v_mov_b32 v3, 1
  s_mov_b64 exec, 1
  ds_add_u32 v2, v3 offset:28
  s_mov_b64 exec, -1
  v_mfma_f32_16x16x32_bf16 v[70:73], v[22:25], v[54:57], v[70:73]
  v_mfma_f32_16x16x32_bf16 v[74:77], v[26:29], v[54:57], v[74:77]
  v_mfma_f32_16x16x32_bf16 v[78:81], v[30:33], v[54:57], v[78:81]
  v_mfma_f32_16x16x32_bf16 v[82:85], v[34:37], v[54:57], v[82:85]
  v_mfma_f32_16x16x32_bf16 v[86:89], v[22:25], v[58:61], v[86:89]
  v_mfma_f32_16x16x32_bf16 v[90:93], v[26:29], v[58:61], v[90:93]
  v_mfma_f32_16x16x32_bf16 v[94:97], v[30:33], v[58:61], v[94:97]
  v_mfma_f32_16x16x32_bf16 v[98:101], v[34:37], v[58:61], v[98:101]
  v_mfma_f32_16x16x32_bf16 v[102:105], v[22:25], v[62:65], v[102:105]
  v_mfma_f32_16x16x32_bf16 v[106:109], v[26:29], v[62:65], v[106:109]
  v_mfma_f32_16x16x32_bf16 v[110:113], v[30:33], v[62:65], v[110:113]
  v_mfma_f32_16x16x32_bf16 v[114:117], v[34:37], v[62:65], v[114:117]
  v_mfma_f32_16x16x32_bf16 v[118:121], v[22:25], v[66:69], v[118:121]
  v_mfma_f32_16x16x32_bf16 v[122:125], v[26:29], v[66:69], v[122:125]
  v_and_b32 v38, 15, v0
  v_lshrrev_b32 v39, 4, v0
  s_mul_i32 s62, s94, 384
  s_add_u32 s62, s62, 129024
  v_lshl_add_u32 v2, v38, 3, s62
  s_lshl_b32 s62, s95, 7
  s_add_u32 s62, s62, 131072
  v_lshl_add_u32 v3, v39, 4, s62
  ds_read_b128 v[8:11], v3
  ds_read_b128 v[12:15], v3 offset:256
  ds_read_b128 v[16:19], v3 offset:64
  ds_read_b128 v[20:23], v3 offset:320
  ds_read_b64 v[24:25], v2 offset:0
  ds_read_b64 v[26:27], v2 offset:128
  ds_read_b64 v[28:29], v2 offset:256
  ds_read_b64 v[30:31], v2 offset:1536
  v_lshlrev_b32 v4, 4, v0
  s_lshr_b32 s96, s54, 4
  s_mul_i32 s96, s96, 49152
  s_lshl_b32 s97, s53, 1
  s_add_u32 s97, s97, s95
  s_lshl_b32 s97, s97, 10
  s_add_u32 s96, s96, s97
  s_add_u32 s96, s96, 0
  s_mul_i32 s97, s94, 147456
  s_add_u32 s99, s96, s97
  s_mov_b32 s98, 0xbfb8aa3b
  s_waitcnt lgkmcnt(0)
  s_cmp_eq_u32 s52, 9
  s_cbranch_scc1 L_skipst_38
  v_rcp_f32 v56, v25
  s_nop 0
  v_mul_f32 v56, s98, v56
  v_fma_f32 v40, -v24, v8, v70
  v_fma_f32 v41, -v24, v9, v71
  v_fma_f32 v42, -v24, v10, v72
  v_fma_f32 v43, -v24, v11, v73
  v_mul_f32 v40, v40, v56
  v_mul_f32 v41, v41, v56
  v_mul_f32 v42, v42, v56
  v_mul_f32 v43, v43, v56
  v_exp_f32 v40, v40
  v_exp_f32 v41, v41
  v_exp_f32 v42, v42
  v_exp_f32 v43, v43
  v_fma_f32 v44, -v24, v12, v74
  v_fma_f32 v45, -v24, v13, v75
  v_fma_f32 v46, -v24, v14, v76
  v_fma_f32 v47, -v24, v15, v77
  v_fma_f32 v40, v40, v25, v25
  v_fma_f32 v41, v41, v25, v25
  v_fma_f32 v42, v42, v25, v25
  v_fma_f32 v43, v43, v25, v25
  v_rcp_f32 v40, v40
  v_rcp_f32 v41, v41
  v_rcp_f32 v42, v42
  v_rcp_f32 v43, v43
  s_nop 0
  v_mul_f32 v44, v44, v40
  v_mul_f32 v45, v45, v41
  v_mul_f32 v46, v46, v42
  v_mul_f32 v47, v47, v43
  v_cvt_pk_bf16_f32 v48, v44, v45
  v_cvt_pk_bf16_f32 v49, v46, v47
  v_fma_f32 v40, -v24, v16, v78
  v_fma_f32 v41, -v24, v17, v79
  v_fma_f32 v42, -v24, v18, v80
  v_fma_f32 v43, -v24, v19, v81
  v_mul_f32 v40, v40, v56
  v_mul_f32 v41, v41, v56
  v_mul_f32 v42, v42, v56
  v_mul_f32 v43, v43, v56
  v_exp_f32 v40, v40
  v_exp_f32 v41, v41
  v_exp_f32 v42, v42
  v_exp_f32 v43, v43
  v_fma_f32 v44, -v24, v20, v82
  v_fma_f32 v45, -v24, v21, v83
  v_fma_f32 v46, -v24, v22, v84
  v_fma_f32 v47, -v24, v23, v85
  v_fma_f32 v40, v40, v25, v25
  v_fma_f32 v41, v41, v25, v25
  v_fma_f32 v42, v42, v25, v25
  v_fma_f32 v43, v43, v25, v25
  v_rcp_f32 v40, v40
  v_rcp_f32 v41, v41
  v_rcp_f32 v42, v42
  v_rcp_f32 v43, v43
  s_nop 0
  v_mul_f32 v44, v44, v40
  v_mul_f32 v45, v45, v41
  v_mul_f32 v46, v46, v42
  v_mul_f32 v47, v47, v43
  v_cvt_pk_bf16_f32 v50, v44, v45
  v_cvt_pk_bf16_f32 v51, v46, v47
  s_add_u32 s97, s99, 0
  buffer_store_dwordx4 v[48:51], v4, s[20:23], s97 offen sc1
L_skipst_38:
  s_cmp_eq_u32 s52, 9
  s_cbranch_scc1 L_skipst_39
  v_rcp_f32 v56, v27
  s_nop 0
  v_mul_f32 v56, s98, v56
  v_fma_f32 v40, -v26, v8, v86
  v_fma_f32 v41, -v26, v9, v87
  v_fma_f32 v42, -v26, v10, v88
  v_fma_f32 v43, -v26, v11, v89
  v_mul_f32 v40, v40, v56
  v_mul_f32 v41, v41, v56
  v_mul_f32 v42, v42, v56
  v_mul_f32 v43, v43, v56
  v_exp_f32 v40, v40
  v_exp_f32 v41, v41
  v_exp_f32 v42, v42
  v_exp_f32 v43, v43
  v_fma_f32 v44, -v26, v12, v90
  v_fma_f32 v45, -v26, v13, v91
  v_fma_f32 v46, -v26, v14, v92
  v_fma_f32 v47, -v26, v15, v93
  v_fma_f32 v40, v40, v27, v27
  v_fma_f32 v41, v41, v27, v27
  v_fma_f32 v42, v42, v27, v27
  v_fma_f32 v43, v43, v27, v27
  v_rcp_f32 v40, v40
  v_rcp_f32 v41, v41
  v_rcp_f32 v42, v42
  v_rcp_f32 v43, v43
  s_nop 0
  v_mul_f32 v44, v44, v40
  v_mul_f32 v45, v45, v41
  v_mul_f32 v46, v46, v42
  v_mul_f32 v47, v47, v43
  v_cvt_pk_bf16_f32 v52, v44, v45
  v_cvt_pk_bf16_f32 v53, v46, v47
  v_fma_f32 v40, -v26, v16, v94
  v_fma_f32 v41, -v26, v17, v95
  v_fma_f32 v42, -v26, v18, v96
  v_fma_f32 v43, -v26, v19, v97
  v_mul_f32 v40, v40, v56
  v_mul_f32 v41, v41, v56
  v_mul_f32 v42, v42, v56
  v_mul_f32 v43, v43, v56
  v_exp_f32 v40, v40
  v_exp_f32 v41, v41
  v_exp_f32 v42, v42
  v_exp_f32 v43, v43
  v_fma_f32 v44, -v26, v20, v98
  v_fma_f32 v45, -v26, v21, v99
  v_fma_f32 v46, -v26, v22, v100
  v_fma_f32 v47, -v26, v23, v101
  v_fma_f32 v40, v40, v27, v27
  v_fma_f32 v41, v41, v27, v27
  v_fma_f32 v42, v42, v27, v27
  v_fma_f32 v43, v43, v27, v27
  v_rcp_f32 v40, v40
  v_rcp_f32 v41, v41
  v_rcp_f32 v42, v42
  v_rcp_f32 v43, v43
  s_nop 0
  v_mul_f32 v44, v44, v40
  v_mul_f32 v45, v45, v41
  v_mul_f32 v46, v46, v42
  v_mul_f32 v47, v47, v43
  v_cvt_pk_bf16_f32 v54, v44, v45
  v_cvt_pk_bf16_f32 v55, v46, v47
  s_add_u32 s97, s99, 49152
  buffer_store_dwordx4 v[52:55], v4, s[20:23], s97 offen sc1
L_skipst_39:
  v_rcp_f32 v56, v29
  s_nop 0
  v_mul_f32 v56, s98, v56
  v_fma_f32 v40, -v28, v8, v102
  v_fma_f32 v41, -v28, v9, v103
  v_fma_f32 v42, -v28, v10, v104
  v_fma_f32 v43, -v28, v11, v105
  v_mul_f32 v40, v40, v56
  v_mul_f32 v41, v41, v56
  v_mul_f32 v42, v42, v56
  v_mul_f32 v43, v43, v56
  v_exp_f32 v40, v40
  v_exp_f32 v41, v41
  v_exp_f32 v42, v42
  v_exp_f32 v43, v43
  v_fma_f32 v44, -v28, v12, v106
  v_fma_f32 v45, -v28, v13, v107
  v_fma_f32 v46, -v28, v14, v108
  v_fma_f32 v47, -v28, v15, v109
  v_fma_f32 v40, v40, v29, v29
  v_fma_f32 v41, v41, v29, v29
  v_fma_f32 v42, v42, v29, v29
  v_fma_f32 v43, v43, v29, v29
  v_rcp_f32 v40, v40
  v_rcp_f32 v41, v41
  v_rcp_f32 v42, v42
  v_rcp_f32 v43, v43
  s_nop 0
  v_mul_f32 v44, v44, v40
  v_mul_f32 v45, v45, v41
  v_mul_f32 v46, v46, v42
  v_mul_f32 v47, v47, v43
  v_cvt_pk_bf16_f32 v48, v44, v45
  v_cvt_pk_bf16_f32 v49, v46, v47
  v_fma_f32 v40, -v28, v16, v110
  v_fma_f32 v41, -v28, v17, v111
  v_fma_f32 v42, -v28, v18, v112
  v_fma_f32 v43, -v28, v19, v113
  v_mul_f32 v40, v40, v56
  v_mul_f32 v41, v41, v56
  v_mul_f32 v42, v42, v56
  v_mul_f32 v43, v43, v56
  v_exp_f32 v40, v40
  v_exp_f32 v41, v41
  v_exp_f32 v42, v42
  v_exp_f32 v43, v43
  v_fma_f32 v44, -v28, v20, v114
  v_fma_f32 v45, -v28, v21, v115
  v_fma_f32 v46, -v28, v22, v116
  v_fma_f32 v47, -v28, v23, v117
  v_fma_f32 v40, v40, v29, v29
  v_fma_f32 v41, v41, v29, v29
  v_fma_f32 v42, v42, v29, v29
  v_fma_f32 v43, v43, v29, v29
  v_rcp_f32 v40, v40
  v_rcp_f32 v41, v41
  v_rcp_f32 v42, v42
  v_rcp_f32 v43, v43
  s_nop 0
  v_mul_f32 v44, v44, v40
  v_mul_f32 v45, v45, v41
  v_mul_f32 v46, v46, v42
  v_mul_f32 v47, v47, v43
  v_cvt_pk_bf16_f32 v50, v44, v45
  v_cvt_pk_bf16_f32 v51, v46, v47
  s_add_u32 s97, s99, 98304
  buffer_store_dwordx4 v[48:51], v4, s[20:23], s97 offen sc1
  v_rcp_f32 v56, v31
  s_nop 0
  v_mul_f32 v56, s98, v56
  v_fma_f32 v40, -v30, v8, v118
  v_fma_f32 v41, -v30, v9, v119
  v_fma_f32 v42, -v30, v10, v120
  v_fma_f32 v43, -v30, v11, v121
  v_mul_f32 v40, v40, v56
  v_mul_f32 v41, v41, v56
  v_mul_f32 v42, v42, v56
  v_mul_f32 v43, v43, v56
  v_exp_f32 v40, v40
  v_exp_f32 v41, v41
  v_exp_f32 v42, v42
  v_exp_f32 v43, v43
  v_fma_f32 v44, -v30, v12, v122
  v_fma_f32 v45, -v30, v13, v123
  v_fma_f32 v46, -v30, v14, v124
  v_fma_f32 v47, -v30, v15, v125
  v_fma_f32 v40, v40, v31, v31
  v_fma_f32 v41, v41, v31, v31
  v_fma_f32 v42, v42, v31, v31
  v_fma_f32 v43, v43, v31, v31
  v_rcp_f32 v40, v40
  v_rcp_f32 v41, v41
  v_rcp_f32 v42, v42
  v_rcp_f32 v43, v43
  s_nop 0
  v_mul_f32 v44, v44, v40
  v_mul_f32 v45, v45, v41
  v_mul_f32 v46, v46, v42
  v_mul_f32 v47, v47, v43
  v_cvt_pk_bf16_f32 v52, v44, v45
  v_cvt_pk_bf16_f32 v53, v46, v47
  s_add_u32 s97, s96, 589824
  buffer_store_dwordx2 v[52:53], v4, s[20:23], s97 offen sc1
  s_branch L_k1_hsig
L_k1_g1:
  s_sub_u32 s62, s3, 2
  s_and_b32 s95, s62, 1
  s_lshr_b32 s94, s62, 1
  v_and_b32 v38, 15, v0
  v_lshrrev_b32 v39, 4, v0
  v_and_b32 v40, 7, v38
  v_xor_b32 v40, v40, v39
  v_lshlrev_b32 v2, 7, v38
  v_lshl_add_u32 v2, v40, 4, v2
  s_mul_i32 s62, s94, 6144
  v_add_u32 v2, s62, v2
  v_xor_b32 v3, 64, v2
  v_lshrrev_b32 v40, 2, v38
  v_and_b32 v41, 3, v38
  v_lshrrev_b32 v42, 1, v40
  v_and_b32 v43, 1, v39
  v_lshl_or_b32 v42, v43, 1, v42
  s_lshl_b32 s62, s95, 1
  v_xor_b32 v42, s62, v42
  v_lshl_add_u32 v43, v39, 3, v40
  v_lshlrev_b32 v4, 7, v43
  v_lshl_add_u32 v4, v42, 5, v4
  v_lshl_add_u32 v4, v41, 3, v4
  v_add_u32 v4, 26624, v4
  v_xor_b32 v5, 32, v4
  v_mov_b64 v[70:71], 0
  v_mov_b64 v[72:73], 0
  v_mov_b64 v[74:75], 0
  v_mov_b64 v[76:77], 0
  v_mov_b64 v[78:79], 0
  v_mov_b64 v[80:81], 0
  v_mov_b64 v[82:83], 0
  v_mov_b64 v[84:85], 0
  v_mov_b64 v[86:87], 0
  v_mov_b64 v[88:89], 0
  v_mov_b64 v[90:91], 0
  v_mov_b64 v[92:93], 0
  v_mov_b64 v[94:95], 0
  v_mov_b64 v[96:97], 0
  v_mov_b64 v[98:99], 0
  v_mov_b64 v[100:101], 0
  v_mov_b64 v[102:103], 0
  v_mov_b64 v[104:105], 0
  v_mov_b64 v[106:107], 0
  v_mov_b64 v[108:109], 0
  v_mov_b64 v[110:111], 0
  v_mov_b64 v[112:113], 0
  v_mov_b64 v[114:115], 0
  v_mov_b64 v[116:117], 0
  v_mov_b64 v[118:119], 0
  v_mov_b64 v[120:121], 0
  v_mov_b64 v[122:123], 0
  v_mov_b64 v[124:125], 0
  s_cmp_eq_u32 s70, 0
  s_cbranch_scc1 L_p1_40
  s_waitcnt lgkmcnt(0)
  s_barrier
L_p1_40:
  s_mov_b32 s60, 0
  s_mov_b32 s58, 0
  s_mov_b32 s63, 4294881280
  s_setprio 2
  s_waitcnt lgkmcnt(0)
  s_barrier
  ds_read_b64_tr_b16 v[6:7], v4 offset:0
  ds_read_b64_tr_b16 v[8:9], v4 offset:512
  ds_read_b128 v[38:41], v2 offset:0
  ds_read_b64_tr_b16 v[10:11], v4 offset:8192
  ds_read_b64_tr_b16 v[12:13], v4 offset:8704
  ds_read_b64_tr_b16 v[14:15], v5 offset:0
  ds_read_b64_tr_b16 v[16:17], v5 offset:512
  ds_read_b64_tr_b16 v[18:19], v5 offset:8192
  ds_read_b64_tr_b16 v[20:21], v5 offset:8704
  ds_read_b128 v[42:45], v2 offset:2048
  ds_read_b128 v[46:49], v2 offset:4096
  ds_read_b128 v[50:53], v2 offset:18432
L_gloop_41:
  s_waitcnt lgkmcnt(9)
  v_mfma_f32_16x16x32_bf16 v[70:73], v[6:9], v[38:41], v[70:73]
  ds_read_b64_tr_b16 v[22:23], v4 offset:4096
  s_waitcnt lgkmcnt(8)
  v_mfma_f32_16x16x32_bf16 v[74:77], v[10:13], v[38:41], v[74:77]
  ds_read_b64_tr_b16 v[24:25], v4 offset:4608
  s_waitcnt lgkmcnt(7)
  v_mfma_f32_16x16x32_bf16 v[78:81], v[14:17], v[38:41], v[78:81]
  ds_read_b128 v[54:57], v3 offset:0
  s_waitcnt lgkmcnt(6)
  v_mfma_f32_16x16x32_bf16 v[82:85], v[18:21], v[38:41], v[82:85]
  ds_read_b64_tr_b16 v[26:27], v4 offset:12288
  s_waitcnt lgkmcnt(6)
  v_mfma_f32_16x16x32_bf16 v[86:89], v[6:9], v[42:45], v[86:89]
  ds_read_b64_tr_b16 v[28:29], v4 offset:12800
  v_mfma_f32_16x16x32_bf16 v[90:93], v[10:13], v[42:45], v[90:93]
  ds_read_b64_tr_b16 v[30:31], v5 offset:4096
  v_mfma_f32_16x16x32_bf16 v[94:97], v[14:17], v[42:45], v[94:97]
  ds_read_b64_tr_b16 v[32:33], v5 offset:4608
  v_mfma_f32_16x16x32_bf16 v[98:101], v[18:21], v[42:45], v[98:101]
  ds_read_b64_tr_b16 v[34:35], v5 offset:12288
  s_waitcnt lgkmcnt(9)
  v_mfma_f32_16x16x32_bf16 v[102:105], v[6:9], v[46:49], v[102:105]
  ds_read_b64_tr_b16 v[36:37], v5 offset:12800
  v_mfma_f32_16x16x32_bf16 v[106:109], v[10:13], v[46:49], v[106:109]
  ds_read_b128 v[58:61], v3 offset:2048
  v_mfma_f32_16x16x32_bf16 v[110:113], v[14:17], v[46:49], v[110:113]
  ds_read_b128 v[62:65], v3 offset:4096
  v_mfma_f32_16x16x32_bf16 v[114:117], v[18:21], v[46:49], v[114:117]
  ds_read_b128 v[66:69], v3 offset:18432
  s_waitcnt lgkmcnt(12)
  v_mfma_f32_16x16x32_bf16 v[118:121], v[14:17], v[50:53], v[118:121]
  v_mfma_f32_16x16x32_bf16 v[122:125], v[18:21], v[50:53], v[122:125]
  s_add_u32 s60, s60, 1
  s_cmp_eq_u32 s60, 3
  s_cselect_b32 s62, s63, 43008
  s_cselect_b32 s60, 0, s60
  s_waitcnt lgkmcnt(0)
  s_waitcnt vmcnt(0)
  v_add_u32 v4, s62, v4
  v_add_u32 v2, s62, v2
  v_add_u32 v5, s62, v5
  v_add_u32 v3, s62, v3
  s_barrier
  v_mfma_f32_16x16x32_bf16 v[70:73], v[22:25], v[54:57], v[70:73]
  ds_read_b64_tr_b16 v[6:7], v4 offset:0
  v_mfma_f32_16x16x32_bf16 v[74:77], v[26:29], v[54:57], v[74:77]
  ds_read_b64_tr_b16 v[8:9], v4 offset:512
  v_mfma_f32_16x16x32_bf16 v[78:81], v[30:33], v[54:57], v[78:81]
  ds_read_b128 v[38:41], v2 offset:0
  v_mfma_f32_16x16x32_bf16 v[82:85], v[34:37], v[54:57], v[82:85]
  ds_read_b64_tr_b16 v[10:11], v4 offset:8192
  v_mfma_f32_16x16x32_bf16 v[86:89], v[22:25], v[58:61], v[86:89]
  ds_read_b64_tr_b16 v[12:13], v4 offset:8704
  v_mfma_f32_16x16x32_bf16 v[90:93], v[26:29], v[58:61], v[90:93]
  ds_read_b64_tr_b16 v[14:15], v5 offset:0
  v_mfma_f32_16x16x32_bf16 v[94:97], v[30:33], v[58:61], v[94:97]
  ds_read_b64_tr_b16 v[16:17], v5 offset:512
  v_mfma_f32_16x16x32_bf16 v[98:101], v[34:37], v[58:61], v[98:101]
  ds_read_b64_tr_b16 v[18:19], v5 offset:8192
  v_mfma_f32_16x16x32_bf16 v[102:105], v[22:25], v[62:65], v[102:105]
  ds_read_b64_tr_b16 v[20:21], v5 offset:8704
  v_mfma_f32_16x16x32_bf16 v[106:109], v[26:29], v[62:65], v[106:109]
  ds_read_b128 v[42:45], v2 offset:2048
  v_mfma_f32_16x16x32_bf16 v[110:113], v[30:33], v[62:65], v[110:113]
  ds_read_b128 v[46:49], v2 offset:4096
  v_mfma_f32_16x16x32_bf16 v[114:117], v[34:37], v[62:65], v[114:117]
  ds_read_b128 v[50:53], v2 offset:18432
  v_mfma_f32_16x16x32_bf16 v[118:121], v[30:33], v[66:69], v[118:121]
  v_mfma_f32_16x16x32_bf16 v[122:125], v[34:37], v[66:69], v[122:125]
  s_add_u32 s58, s58, 1
  s_cmp_lt_u32 s58, 9
  s_cbranch_scc1 L_gloop_41
  s_waitcnt lgkmcnt(9)
  v_mfma_f32_16x16x32_bf16 v[70:73], v[6:9], v[38:41], v[70:73]
  ds_read_b64_tr_b16 v[22:23], v4 offset:4096
  s_waitcnt lgkmcnt(8)
  v_mfma_f32_16x16x32_bf16 v[74:77], v[10:13], v[38:41], v[74:77]
  ds_read_b64_tr_b16 v[24:25], v4 offset:4608
  s_waitcnt lgkmcnt(7)
  v_mfma_f32_16x16x32_bf16 v[78:81], v[14:17], v[38:41], v[78:81]
  ds_read_b128 v[54:57], v3 offset:0
  s_waitcnt lgkmcnt(6)
  v_mfma_f32_16x16x32_bf16 v[82:85], v[18:21], v[38:41], v[82:85]
  ds_read_b64_tr_b16 v[26:27], v4 offset:12288
  s_waitcnt lgkmcnt(6)
  v_mfma_f32_16x16x32_bf16 v[86:89], v[6:9], v[42:45], v[86:89]
  ds_read_b64_tr_b16 v[28:29], v4 offset:12800
  v_mfma_f32_16x16x32_bf16 v[90:93], v[10:13], v[42:45], v[90:93]
  ds_read_b64_tr_b16 v[30:31], v5 offset:4096
  v_mfma_f32_16x16x32_bf16 v[94:97], v[14:17], v[42:45], v[94:97]
  ds_read_b64_tr_b16 v[32:33], v5 offset:4608
  v_mfma_f32_16x16x32_bf16 v[98:101], v[18:21], v[42:45], v[98:101]
  ds_read_b64_tr_b16 v[34:35], v5 offset:12288
  s_waitcnt lgkmcnt(9)
  v_mfma_f32_16x16x32_bf16 v[102:105], v[6:9], v[46:49], v[102:105]
  ds_read_b64_tr_b16 v[36:37], v5 offset:12800
  v_mfma_f32_16x16x32_bf16 v[106:109], v[10:13], v[46:49], v[106:109]
  ds_read_b128 v[58:61], v3 offset:2048
  v_mfma_f32_16x16x32_bf16 v[110:113], v[14:17], v[46:49], v[110:113]
  ds_read_b128 v[62:65], v3 offset:4096
  v_mfma_f32_16x16x32_bf16 v[114:117], v[18:21], v[46:49], v[114:117]
  ds_read_b128 v[66:69], v3 offset:18432
  s_waitcnt lgkmcnt(12)
  v_mfma_f32_16x16x32_bf16 v[118:121], v[14:17], v[50:53], v[118:121]
  v_mfma_f32_16x16x32_bf16 v[122:125], v[18:21], v[50:53], v[122:125]
  s_waitcnt lgkmcnt(0)
  v_mov_b32 v2, 163776
  v_mov_b32 v3, 1
  s_mov_b64 exec, 1
  ds_add_u32 v2, v3 offset:28
  s_mov_b64 exec, -1
  v_mfma_f32_16x16x32_bf16 v[70:73], v[22:25], v[54:57], v[70:73]
  v_mfma_f32_16x16x32_bf16 v[74:77], v[26:29], v[54:57], v[74:77]
  v_mfma_f32_16x16x32_bf16 v[78:81], v[30:33], v[54:57], v[78:81]
  v_mfma_f32_16x16x32_bf16 v[82:85], v[34:37], v[54:57], v[82:85]
  v_mfma_f32_16x16x32_bf16 v[86:89], v[22:25], v[58:61], v[86:89]
  v_mfma_f32_16x16x32_bf16 v[90:93], v[26:29], v[58:61], v[90:93]
  v_mfma_f32_16x16x32_bf16 v[94:97], v[30:33], v[58:61], v[94:97]
  v_mfma_f32_16x16x32_bf16 v[98:101], v[34:37], v[58:61], v[98:101]
  v_mfma_f32_16x16x32_bf16 v[102:105], v[22:25], v[62:65], v[102:105]
  v_mfma_f32_16x16x32_bf16 v[106:109], v[26:29], v[62:65], v[106:109]
  v_mfma_f32_16x16x32_bf16 v[110:113], v[30:33], v[62:65], v[110:113]
  v_mfma_f32_16x16x32_bf16 v[114:117], v[34:37], v[62:65], v[114:117]
  v_mfma_f32_16x16x32_bf16 v[118:121], v[30:33], v[66:69], v[118:121]
  v_mfma_f32_16x16x32_bf16 v[122:125], v[34:37], v[66:69], v[122:125]
  v_and_b32 v38, 15, v0
  v_lshrrev_b32 v39, 4, v0
  s_mul_i32 s62, s94, 384
  s_add_u32 s62, s62, 129024
  v_lshl_add_u32 v2, v38, 3, s62
  s_lshl_b32 s62, s95, 7
  s_add_u32 s62, s62, 131072
  v_lshl_add_u32 v3, v39, 4, s62
  ds_read_b128 v[8:11], v3
  ds_read_b128 v[12:15], v3 offset:256
  ds_read_b128 v[16:19], v3 offset:64
  ds_read_b128 v[20:23], v3 offset:320
  ds_read_b64 v[24:25], v2 offset:0
  ds_read_b64 v[26:27], v2 offset:128
  ds_read_b64 v[28:29], v2 offset:256
  ds_read_b64 v[30:31], v2 offset:1152
  v_lshlrev_b32 v4, 4, v0
  s_lshr_b32 s96, s54, 4
  s_mul_i32 s96, s96, 49152
  s_lshl_b32 s97, s53, 1
  s_add_u32 s97, s97, s95
  s_lshl_b32 s97, s97, 10
  s_add_u32 s96, s96, s97
  s_add_u32 s96, s96, 0
  s_mul_i32 s97, s94, 147456
  s_add_u32 s99, s96, s97
  s_mov_b32 s98, 0xbfb8aa3b
  s_waitcnt lgkmcnt(0)
  v_rcp_f32 v56, v25
  s_nop 0
  v_mul_f32 v56, s98, v56
  v_fma_f32 v40, -v24, v8, v70
  v_fma_f32 v41, -v24, v9, v71
  v_fma_f32 v42, -v24, v10, v72
  v_fma_f32 v43, -v24, v11, v73
  v_mul_f32 v40, v40, v56
  v_mul_f32 v41, v41, v56
  v_mul_f32 v42, v42, v56
  v_mul_f32 v43, v43, v56
  v_exp_f32 v40, v40
  v_exp_f32 v41, v41
  v_exp_f32 v42, v42
  v_exp_f32 v43, v43
  v_fma_f32 v44, -v24, v12, v74
  v_fma_f32 v45, -v24, v13, v75
  v_fma_f32 v46, -v24, v14, v76
  v_fma_f32 v47, -v24, v15, v77
  v_fma_f32 v40, v40, v25, v25
  v_fma_f32 v41, v41, v25, v25
  v_fma_f32 v42, v42, v25, v25
  v_fma_f32 v43, v43, v25, v25
  v_rcp_f32 v40, v40
  v_rcp_f32 v41, v41
  v_rcp_f32 v42, v42
  v_rcp_f32 v43, v43
  s_nop 0
  v_mul_f32 v44, v44, v40
  v_mul_f32 v45, v45, v41
  v_mul_f32 v46, v46, v42
  v_mul_f32 v47, v47, v43
  v_cvt_pk_bf16_f32 v48, v44, v45
  v_cvt_pk_bf16_f32 v49, v46, v47
  v_fma_f32 v40, -v24, v16, v78
  v_fma_f32 v41, -v24, v17, v79
  v_fma_f32 v42, -v24, v18, v80
  v_fma_f32 v43, -v24, v19, v81
  v_mul_f32 v40, v40, v56
  v_mul_f32 v41, v41, v56
  v_mul_f32 v42, v42, v56
  v_mul_f32 v43, v43, v56
  v_exp_f32 v40, v40
  v_exp_f32 v41, v41
  v_exp_f32 v42, v42
  v_exp_f32 v43, v43
  v_fma_f32 v44, -v24, v20, v82
  v_fma_f32 v45, -v24, v21, v83
  v_fma_f32 v46, -v24, v22, v84
  v_fma_f32 v47, -v24, v23, v85
  v_fma_f32 v40, v40, v25, v25
  v_fma_f32 v41, v41, v25, v25
  v_fma_f32 v42, v42, v25, v25
  v_fma_f32 v43, v43, v25, v25
  v_rcp_f32 v40, v40
  v_rcp_f32 v41, v41
  v_rcp_f32 v42, v42
  v_rcp_f32 v43, v43
  s_nop 0
  v_mul_f32 v44, v44, v40
  v_mul_f32 v45, v45, v41
  v_mul_f32 v46, v46, v42
  v_mul_f32 v47, v47, v43
  v_cvt_pk_bf16_f32 v50, v44, v45
  v_cvt_pk_bf16_f32 v51, v46, v47
  s_add_u32 s97, s99, 0
  buffer_store_dwordx4 v[48:51], v4, s[20:23], s97 offen sc1
  v_rcp_f32 v56, v27
  s_nop 0
  v_mul_f32 v56, s98, v56
  v_fma_f32 v40, -v26, v8, v86
  v_fma_f32 v41, -v26, v9, v87
  v_fma_f32 v42, -v26, v10, v88
  v_fma_f32 v43, -v26, v11, v89
  v_mul_f32 v40, v40, v56
  v_mul_f32 v41, v41, v56
  v_mul_f32 v42, v42, v56
  v_mul_f32 v43, v43, v56
  v_exp_f32 v40, v40
  v_exp_f32 v41, v41
  v_exp_f32 v42, v42
  v_exp_f32 v43, v43
  v_fma_f32 v44, -v26, v12, v90
  v_fma_f32 v45, -v26, v13, v91
  v_fma_f32 v46, -v26, v14, v92
  v_fma_f32 v47, -v26, v15, v93
  v_fma_f32 v40, v40, v27, v27
  v_fma_f32 v41, v41, v27, v27
  v_fma_f32 v42, v42, v27, v27
  v_fma_f32 v43, v43, v27, v27
  v_rcp_f32 v40, v40
  v_rcp_f32 v41, v41
  v_rcp_f32 v42, v42
  v_rcp_f32 v43, v43
  s_nop 0
  v_mul_f32 v44, v44, v40
  v_mul_f32 v45, v45, v41
  v_mul_f32 v46, v46, v42
  v_mul_f32 v47, v47, v43
  v_cvt_pk_bf16_f32 v52, v44, v45
  v_cvt_pk_bf16_f32 v53, v46, v47
  v_fma_f32 v40, -v26, v16, v94
  v_fma_f32 v41, -v26, v17, v95
  v_fma_f32 v42, -v26, v18, v96
  v_fma_f32 v43, -v26, v19, v97
  v_mul_f32 v40, v40, v56
  v_mul_f32 v41, v41, v56
  v_mul_f32 v42, v42, v56
  v_mul_f32 v43, v43, v56
  v_exp_f32 v40, v40
  v_exp_f32 v41, v41
  v_exp_f32 v42, v42
  v_exp_f32 v43, v43
  v_fma_f32 v44, -v26, v20, v98
  v_fma_f32 v45, -v26, v21, v99
  v_fma_f32 v46, -v26, v22, v100
  v_fma_f32 v47, -v26, v23, v101
  v_fma_f32 v40, v40, v27, v27
  v_fma_f32 v41, v41, v27, v27
  v_fma_f32 v42, v42, v27, v27
  v_fma_f32 v43, v43, v27, v27
  v_rcp_f32 v40, v40
  v_rcp_f32 v41, v41
  v_rcp_f32 v42, v42
  v_rcp_f32 v43, v43
  s_nop 0
  v_mul_f32 v44, v44, v40
  v_mul_f32 v45, v45, v41
  v_mul_f32 v46, v46, v42
  v_mul_f32 v47, v47, v43
  v_cvt_pk_bf16_f32 v54, v44, v45
  v_cvt_pk_bf16_f32 v55, v46, v47
  s_add_u32 s97, s99, 49152
  buffer_store_dwordx4 v[52:55], v4, s[20:23], s97 offen sc1
  v_rcp_f32 v56, v29
  s_nop 0
  v_mul_f32 v56, s98, v56
  v_fma_f32 v40, -v28, v8, v102
  v_fma_f32 v41, -v28, v9, v103
  v_fma_f32 v42, -v28, v10, v104
  v_fma_f32 v43, -v28, v11, v105
  v_mul_f32 v40, v40, v56
  v_mul_f32 v41, v41, v56
  v_mul_f32 v42, v42, v56
  v_mul_f32 v43, v43, v56
  v_exp_f32 v40, v40
  v_exp_f32 v41, v41
  v_exp_f32 v42, v42
  v_exp_f32 v43, v43
  v_fma_f32 v44, -v28, v12, v106
  v_fma_f32 v45, -v28, v13, v107
  v_fma_f32 v46, -v28, v14, v108
  v_fma_f32 v47, -v28, v15, v109
  v_fma_f32 v40, v40, v29, v29
  v_fma_f32 v41, v41, v29, v29
  v_fma_f32 v42, v42, v29, v29
  v_fma_f32 v43, v43, v29, v29
  v_rcp_f32 v40, v40
  v_rcp_f32 v41, v41
  v_rcp_f32 v42, v42
  v_rcp_f32 v43, v43
  s_nop 0
  v_mul_f32 v44, v44, v40
  v_mul_f32 v45, v45, v41
  v_mul_f32 v46, v46, v42
  v_mul_f32 v47, v47, v43
  v_cvt_pk_bf16_f32 v48, v44, v45
  v_cvt_pk_bf16_f32 v49, v46, v47
  v_fma_f32 v40, -v28, v16, v110
  v_fma_f32 v41, -v28, v17, v111
  v_fma_f32 v42, -v28, v18, v112
  v_fma_f32 v43, -v28, v19, v113
  v_mul_f32 v40, v40, v56
  v_mul_f32 v41, v41, v56
  v_mul_f32 v42, v42, v56
  v_mul_f32 v43, v43, v56
  v_exp_f32 v40, v40
  v_exp_f32 v41, v41
  v_exp_f32 v42, v42
  v_exp_f32 v43, v43
  v_fma_f32 v44, -v28, v20, v114
  v_fma_f32 v45, -v28, v21, v115
  v_fma_f32 v46, -v28, v22, v116
  v_fma_f32 v47, -v28, v23, v117
  v_fma_f32 v40, v40, v29, v29
  v_fma_f32 v41, v41, v29, v29
  v_fma_f32 v42, v42, v29, v29
  v_fma_f32 v43, v43, v29, v29
  v_rcp_f32 v40, v40
  v_rcp_f32 v41, v41
  v_rcp_f32 v42, v42
  v_rcp_f32 v43, v43
  s_nop 0
  v_mul_f32 v44, v44, v40
  v_mul_f32 v45, v45, v41
  v_mul_f32 v46, v46, v42
  v_mul_f32 v47, v47, v43
  v_cvt_pk_bf16_f32 v50, v44, v45
  v_cvt_pk_bf16_f32 v51, v46, v47
  s_add_u32 s97, s99, 98304
  buffer_store_dwordx4 v[48:51], v4, s[20:23], s97 offen sc1
  v_rcp_f32 v56, v31
  s_nop 0
  v_mul_f32 v56, s98, v56
  v_fma_f32 v40, -v30, v16, v118
  v_fma_f32 v41, -v30, v17, v119
  v_fma_f32 v42, -v30, v18, v120
  v_fma_f32 v43, -v30, v19, v121
  v_mul_f32 v40, v40, v56
  v_mul_f32 v41, v41, v56
  v_mul_f32 v42, v42, v56
  v_mul_f32 v43, v43, v56
  v_exp_f32 v40, v40
  v_exp_f32 v41, v41
  v_exp_f32 v42, v42
  v_exp_f32 v43, v43
  v_fma_f32 v44, -v30, v20, v122
  v_fma_f32 v45, -v30, v21, v123
  v_fma_f32 v46, -v30, v22, v124
  v_fma_f32 v47, -v30, v23, v125
  v_fma_f32 v40, v40, v31, v31
  v_fma_f32 v41, v41, v31, v31
  v_fma_f32 v42, v42, v31, v31
  v_fma_f32 v43, v43, v31, v31
  v_rcp_f32 v40, v40
  v_rcp_f32 v41, v41
  v_rcp_f32 v42, v42
  v_rcp_f32 v43, v43
  s_nop 0
  v_mul_f32 v44, v44, v40
  v_mul_f32 v45, v45, v41
  v_mul_f32 v46, v46, v42
  v_mul_f32 v47, v47, v43
  v_cvt_pk_bf16_f32 v52, v44, v45
  v_cvt_pk_bf16_f32 v53, v46, v47
  s_add_u32 s97, s96, 589832
  buffer_store_dwordx2 v[52:53], v4, s[20:23], s97 offen sc1
  s_branch L_k1_hsig
L_k1_g2:
  s_sub_u32 s62, s3, 2
  s_and_b32 s95, s62, 1
  s_lshr_b32 s94, s62, 1
  v_and_b32 v38, 15, v0
  v_lshrrev_b32 v39, 4, v0
  v_and_b32 v40, 7, v38
  v_xor_b32 v40, v40, v39
  v_lshlrev_b32 v2, 7, v38
  v_lshl_add_u32 v2, v40, 4, v2
  s_mul_i32 s62, s94, 6144
  v_add_u32 v2, s62, v2
  v_xor_b32 v3, 64, v2
  v_lshrrev_b32 v40, 2, v38
  v_and_b32 v41, 3, v38
  v_lshrrev_b32 v42, 1, v40
  v_and_b32 v43, 1, v39
  v_lshl_or_b32 v42, v43, 1, v42
  s_lshl_b32 s62, s95, 1
  v_xor_b32 v42, s62, v42
  v_lshl_add_u32 v43, v39, 3, v40
  v_lshlrev_b32 v4, 7, v43
  v_lshl_add_u32 v4, v42, 5, v4
  v_lshl_add_u32 v4, v41, 3, v4
  v_add_u32 v4, 26624, v4
  v_xor_b32 v5, 32, v4
  v_mov_b64 v[70:71], 0
  v_mov_b64 v[72:73], 0
  v_mov_b64 v[74:75], 0
  v_mov_b64 v[76:77], 0
  v_mov_b64 v[78:79], 0
  v_mov_b64 v[80:81], 0
  v_mov_b64 v[82:83], 0
  v_mov_b64 v[84:85], 0
  v_mov_b64 v[86:87], 0
  v_mov_b64 v[88:89], 0
  v_mov_b64 v[90:91], 0
  v_mov_b64 v[92:93], 0
  v_mov_b64 v[94:95], 0
  v_mov_b64 v[96:97], 0
  v_mov_b64 v[98:99], 0
  v_mov_b64 v[100:101], 0
  v_mov_b64 v[102:103], 0
  v_mov_b64 v[104:105], 0
  v_mov_b64 v[106:107], 0
  v_mov_b64 v[108:109], 0
  v_mov_b64 v[110:111], 0
  v_mov_b64 v[112:113], 0
  v_mov_b64 v[114:115], 0
  v_mov_b64 v[116:117], 0
  s_cmp_eq_u32 s70, 0
  s_cbranch_scc1 L_p1_42
  s_waitcnt lgkmcnt(0)
  s_barrier
L_p1_42:
  s_mov_b32 s60, 0
  s_mov_b32 s58, 0
  s_mov_b32 s63, 4294881280
  s_setprio 2
  s_waitcnt lgkmcnt(0)
  s_barrier
  ds_read_b64_tr_b16 v[6:7], v4 offset:0
  ds_read_b64_tr_b16 v[8:9], v4 offset:512
  ds_read_b128 v[38:41], v2 offset:0
  ds_read_b64_tr_b16 v[10:11], v4 offset:8192
  ds_read_b64_tr_b16 v[12:13], v4 offset:8704
  ds_read_b64_tr_b16 v[14:15], v5 offset:0
  ds_read_b64_tr_b16 v[16:17], v5 offset:512
  ds_read_b64_tr_b16 v[18:19], v5 offset:8192
  ds_read_b64_tr_b16 v[20:21], v5 offset:8704
  ds_read_b128 v[42:45], v2 offset:2048
  ds_read_b128 v[46:49], v2 offset:4096
L_gloop_43:
  s_waitcnt lgkmcnt(8)
  v_mfma_f32_16x16x32_bf16 v[70:73], v[6:9], v[38:41], v[70:73]
  ds_read_b64_tr_b16 v[22:23], v4 offset:4096
  s_waitcnt lgkmcnt(7)
  v_mfma_f32_16x16x32_bf16 v[74:77], v[10:13], v[38:41], v[74:77]
  ds_read_b64_tr_b16 v[24:25], v4 offset:4608
  s_waitcnt lgkmcnt(6)
  v_mfma_f32_16x16x32_bf16 v[78:81], v[14:17], v[38:41], v[78:81]
  ds_read_b128 v[54:57], v3 offset:0
  s_waitcnt lgkmcnt(5)
  v_mfma_f32_16x16x32_bf16 v[82:85], v[18:21], v[38:41], v[82:85]
  ds_read_b64_tr_b16 v[26:27], v4 offset:12288
  s_waitcnt lgkmcnt(5)
  v_mfma_f32_16x16x32_bf16 v[86:89], v[6:9], v[42:45], v[86:89]
  ds_read_b64_tr_b16 v[28:29], v4 offset:12800
  v_mfma_f32_16x16x32_bf16 v[90:93], v[10:13], v[42:45], v[90:93]
  ds_read_b64_tr_b16 v[30:31], v5 offset:4096
  v_mfma_f32_16x16x32_bf16 v[94:97], v[14:17], v[42:45], v[94:97]
  ds_read_b64_tr_b16 v[32:33], v5 offset:4608
  v_mfma_f32_16x16x32_bf16 v[98:101], v[18:21], v[42:45], v[98:101]
  ds_read_b64_tr_b16 v[34:35], v5 offset:12288
  s_waitcnt lgkmcnt(8)
  v_mfma_f32_16x16x32_bf16 v[102:105], v[6:9], v[46:49], v[102:105]
  ds_read_b64_tr_b16 v[36:37], v5 offset:12800
  v_mfma_f32_16x16x32_bf16 v[106:109], v[10:13], v[46:49], v[106:109]
  ds_read_b128 v[58:61], v3 offset:2048
  v_mfma_f32_16x16x32_bf16 v[110:113], v[14:17], v[46:49], v[110:113]
  ds_read_b128 v[62:65], v3 offset:4096
  v_mfma_f32_16x16x32_bf16 v[114:117], v[18:21], v[46:49], v[114:117]
  s_add_u32 s60, s60, 1
  s_cmp_eq_u32 s60, 3
  s_cselect_b32 s62, s63, 43008
  s_cselect_b32 s60, 0, s60
  s_waitcnt lgkmcnt(0)
  s_waitcnt vmcnt(0)
  v_add_u32 v4, s62, v4
  v_add_u32 v2, s62, v2
  v_add_u32 v5, s62, v5
  v_add_u32 v3, s62, v3
  s_barrier
  v_mfma_f32_16x16x32_bf16 v[70:73], v[22:25], v[54:57], v[70:73]
  ds_read_b64_tr_b16 v[6:7], v4 offset:0
  v_mfma_f32_16x16x32_bf16 v[74:77], v[26:29], v[54:57], v[74:77]
  ds_read_b64_tr_b16 v[8:9], v4 offset:512
  v_mfma_f32_16x16x32_bf16 v[78:81], v[30:33], v[54:57], v[78:81]
  ds_read_b128 v[38:41], v2 offset:0
  v_mfma_f32_16x16x32_bf16 v[82:85], v[34:37], v[54:57], v[82:85]
  ds_read_b64_tr_b16 v[10:11], v4 offset:8192
  v_mfma_f32_16x16x32_bf16 v[86:89], v[22:25], v[58:61], v[86:89]
  ds_read_b64_tr_b16 v[12:13], v4 offset:8704
  v_mfma_f32_16x16x32_bf16 v[90:93], v[26:29], v[58:61], v[90:93]
  ds_read_b64_tr_b16 v[14:15], v5 offset:0
  v_mfma_f32_16x16x32_bf16 v[94:97], v[30:33], v[58:61], v[94:97]
  ds_read_b64_tr_b16 v[16:17], v5 offset:512
  v_mfma_f32_16x16x32_bf16 v[98:101], v[34:37], v[58:61], v[98:101]
  ds_read_b64_tr_b16 v[18:19], v5 offset:8192
  v_mfma_f32_16x16x32_bf16 v[102:105], v[22:25], v[62:65], v[102:105]
  ds_read_b64_tr_b16 v[20:21], v5 offset:8704
  v_mfma_f32_16x16x32_bf16 v[106:109], v[26:29], v[62:65], v[106:109]
  ds_read_b128 v[42:45], v2 offset:2048
  v_mfma_f32_16x16x32_bf16 v[110:113], v[30:33], v[62:65], v[110:113]
  ds_read_b128 v[46:49], v2 offset:4096
  v_mfma_f32_16x16x32_bf16 v[114:117], v[34:37], v[62:65], v[114:117]
  s_add_u32 s58, s58, 1
  s_cmp_lt_u32 s58, 9
  s_cbranch_scc1 L_gloop_43
  s_waitcnt lgkmcnt(8)
  v_mfma_f32_16x16x32_bf16 v[70:73], v[6:9], v[38:41], v[70:73]
  ds_read_b64_tr_b16 v[22:23], v4 offset:4096
  s_waitcnt lgkmcnt(7)
  v_mfma_f32_16x16x32_bf16 v[74:77], v[10:13], v[38:41], v[74:77]
  ds_read_b64_tr_b16 v[24:25], v4 offset:4608
  s_waitcnt lgkmcnt(6)
  v_mfma_f32_16x16x32_bf16 v[78:81], v[14:17], v[38:41], v[78:81]
  ds_read_b128 v[54:57], v3 offset:0
  s_waitcnt lgkmcnt(5)
  v_mfma_f32_16x16x32_bf16 v[82:85], v[18:21], v[38:41], v[82:85]
  ds_read_b64_tr_b16 v[26:27], v4 offset:12288
  s_waitcnt lgkmcnt(5)
  v_mfma_f32_16x16x32_bf16 v[86:89], v[6:9], v[42:45], v[86:89]
  ds_read_b64_tr_b16 v[28:29], v4 offset:12800
  v_mfma_f32_16x16x32_bf16 v[90:93], v[10:13], v[42:45], v[90:93]
  ds_read_b64_tr_b16 v[30:31], v5 offset:4096
  v_mfma_f32_16x16x32_bf16 v[94:97], v[14:17], v[42:45], v[94:97]
  ds_read_b64_tr_b16 v[32:33], v5 offset:4608
  v_mfma_f32_16x16x32_bf16 v[98:101], v[18:21], v[42:45], v[98:101]
  ds_read_b64_tr_b16 v[34:35], v5 offset:12288
  s_waitcnt lgkmcnt(8)
  v_mfma_f32_16x16x32_bf16 v[102:105], v[6:9], v[46:49], v[102:105]
  ds_read_b64_tr_b16 v[36:37], v5 offset:12800
  v_mfma_f32_16x16x32_bf16 v[106:109], v[10:13], v[46:49], v[106:109]
  ds_read_b128 v[58:61], v3 offset:2048
  v_mfma_f32_16x16x32_bf16 v[110:113], v[14:17], v[46:49], v[110:113]
  ds_read_b128 v[62:65], v3 offset:4096
  v_mfma_f32_16x16x32_bf16 v[114:117], v[18:21], v[46:49], v[114:117]
  s_waitcnt lgkmcnt(0)
  v_mov_b32 v2, 163776
  v_mov_b32 v3, 1
  s_mov_b64 exec, 1
  ds_add_u32 v2, v3 offset:28
  s_mov_b64 exec, -1
  v_mfma_f32_16x16x32_bf16 v[70:73], v[22:25], v[54:57], v[70:73]
  v_mfma_f32_16x16x32_bf16 v[74:77], v[26:29], v[54:57], v[74:77]
  v_mfma_f32_16x16x32_bf16 v[78:81], v[30:33], v[54:57], v[78:81]
  v_mfma_f32_16x16x32_bf16 v[82:85], v[34:37], v[54:57], v[82:85]
  v_mfma_f32_16x16x32_bf16 v[86:89], v[22:25], v[58:61], v[86:89]
  v_mfma_f32_16x16x32_bf16 v[90:93], v[26:29], v[58:61], v[90:93]
  v_mfma_f32_16x16x32_bf16 v[94:97], v[30:33], v[58:61], v[94:97]
  v_mfma_f32_16x16x32_bf16 v[98:101], v[34:37], v[58:61], v[98:101]
  v_mfma_f32_16x16x32_bf16 v[102:105], v[22:25], v[62:65], v[102:105]
  v_mfma_f32_16x16x32_bf16 v[106:109], v[26:29], v[62:65], v[106:109]
  v_mfma_f32_16x16x32_bf16 v[110:113], v[30:33], v[62:65], v[110:113]
  v_mfma_f32_16x16x32_bf16 v[114:117], v[34:37], v[62:65], v[114:117]
  v_and_b32 v38, 15, v0
  v_lshrrev_b32 v39, 4, v0
  s_mul_i32 s62, s94, 384
  s_add_u32 s62, s62, 129024
  v_lshl_add_u32 v2, v38, 3, s62
  s_lshl_b32 s62, s95, 7
  s_add_u32 s62, s62, 131072
  v_lshl_add_u32 v3, v39, 4, s62
  ds_read_b128 v[8:11], v3
  ds_read_b128 v[12:15], v3 offset:256
  ds_read_b128 v[16:19], v3 offset:64
  ds_read_b128 v[20:23], v3 offset:320
  ds_read_b64 v[24:25], v2 offset:0
  ds_read_b64 v[26:27], v2 offset:128
  ds_read_b64 v[28:29], v2 offset:256
  v_lshlrev_b32 v4, 4, v0
  s_lshr_b32 s96, s54, 4
  s_mul_i32 s96, s96, 49152
  s_lshl_b32 s97, s53, 1
  s_add_u32 s97, s97, s95
  s_lshl_b32 s97, s97, 10
  s_add_u32 s96, s96, s97
  s_add_u32 s96, s96, 0
  s_mul_i32 s97, s94, 147456
  s_add_u32 s99, s96, s97
  s_mov_b32 s98, 0xbfb8aa3b
  s_waitcnt lgkmcnt(0)
  v_rcp_f32 v56, v25
  s_nop 0
  v_mul_f32 v56, s98, v56
  v_fma_f32 v40, -v24, v8, v70
  v_fma_f32 v41, -v24, v9, v71
  v_fma_f32 v42, -v24, v10, v72
  v_fma_f32 v43, -v24, v11, v73
  v_mul_f32 v40, v40, v56
  v_mul_f32 v41, v41, v56
  v_mul_f32 v42, v42, v56
  v_mul_f32 v43, v43, v56
  v_exp_f32 v40, v40
  v_exp_f32 v41, v41
  v_exp_f32 v42, v42
  v_exp_f32 v43, v43
  v_fma_f32 v44, -v24, v12, v74
  v_fma_f32 v45, -v24, v13, v75
  v_fma_f32 v46, -v24, v14, v76
  v_fma_f32 v47, -v24, v15, v77
  v_fma_f32 v40, v40, v25, v25
  v_fma_f32 v41, v41, v25, v25
  v_fma_f32 v42, v42, v25, v25
  v_fma_f32 v43, v43, v25, v25
  v_rcp_f32 v40, v40
  v_rcp_f32 v41, v41
  v_rcp_f32 v42, v42
  v_rcp_f32 v43, v43
  s_nop 0
  v_mul_f32 v44, v44, v40
  v_mul_f32 v45, v45, v41
  v_mul_f32 v46, v46, v42
  v_mul_f32 v47, v47, v43
  v_cvt_pk_bf16_f32 v48, v44, v45
  v_cvt_pk_bf16_f32 v49, v46, v47
  v_fma_f32 v40, -v24, v16, v78
  v_fma_f32 v41, -v24, v17, v79
  v_fma_f32 v42, -v24, v18, v80
  v_fma_f32 v43, -v24, v19, v81
  v_mul_f32 v40, v40, v56
  v_mul_f32 v41, v41, v56
  v_mul_f32 v42, v42, v56
  v_mul_f32 v43, v43, v56
  v_exp_f32 v40, v40
  v_exp_f32 v41, v41
  v_exp_f32 v42, v42
  v_exp_f32 v43, v43
  v_fma_f32 v44, -v24, v20, v82
  v_fma_f32 v45, -v24, v21, v83
  v_fma_f32 v46, -v24, v22, v84
  v_fma_f32 v47, -v24, v23, v85
  v_fma_f32 v40, v40, v25, v25
  v_fma_f32 v41, v41, v25, v25
  v_fma_f32 v42, v42, v25, v25
  v_fma_f32 v43, v43, v25, v25
  v_rcp_f32 v40, v40
  v_rcp_f32 v41, v41
  v_rcp_f32 v42, v42
  v_rcp_f32 v43, v43
  s_nop 0
  v_mul_f32 v44, v44, v40
  v_mul_f32 v45, v45, v41
  v_mul_f32 v46, v46, v42
  v_mul_f32 v47, v47, v43
  v_cvt_pk_bf16_f32 v50, v44, v45
  v_cvt_pk_bf16_f32 v51, v46, v47
  s_add_u32 s97, s99, 0
  buffer_store_dwordx4 v[48:51], v4, s[20:23], s97 offen sc1
  v_rcp_f32 v56, v27
  s_nop 0
  v_mul_f32 v56, s98, v56
  v_fma_f32 v40, -v26, v8, v86
  v_fma_f32 v41, -v26, v9, v87
  v_fma_f32 v42, -v26, v10, v88
  v_fma_f32 v43, -v26, v11, v89
  v_mul_f32 v40, v40, v56
  v_mul_f32 v41, v41, v56
  v_mul_f32 v42, v42, v56
  v_mul_f32 v43, v43, v56
  v_exp_f32 v40, v40
  v_exp_f32 v41, v41
  v_exp_f32 v42, v42
  v_exp_f32 v43, v43
  v_fma_f32 v44, -v26, v12, v90
  v_fma_f32 v45, -v26, v13, v91
  v_fma_f32 v46, -v26, v14, v92
  v_fma_f32 v47, -v26, v15, v93
  v_fma_f32 v40, v40, v27, v27
  v_fma_f32 v41, v41, v27, v27
  v_fma_f32 v42, v42, v27, v27
  v_fma_f32 v43, v43, v27, v27
  v_rcp_f32 v40, v40
  v_rcp_f32 v41, v41
  v_rcp_f32 v42, v42
  v_rcp_f32 v43, v43
  s_nop 0
  v_mul_f32 v44, v44, v40
  v_mul_f32 v45, v45, v41
  v_mul_f32 v46, v46, v42
  v_mul_f32 v47, v47, v43
  v_cvt_pk_bf16_f32 v52, v44, v45
  v_cvt_pk_bf16_f32 v53, v46, v47
  v_fma_f32 v40, -v26, v16, v94
  v_fma_f32 v41, -v26, v17, v95
  v_fma_f32 v42, -v26, v18, v96
  v_fma_f32 v43, -v26, v19, v97
  v_mul_f32 v40, v40, v56
  v_mul_f32 v41, v41, v56
  v_mul_f32 v42, v42, v56
  v_mul_f32 v43, v43, v56
  v_exp_f32 v40, v40
  v_exp_f32 v41, v41
  v_exp_f32 v42, v42
  v_exp_f32 v43, v43
  v_fma_f32 v44, -v26, v20, v98
  v_fma_f32 v45, -v26, v21, v99
  v_fma_f32 v46, -v26, v22, v100
  v_fma_f32 v47, -v26, v23, v101
  v_fma_f32 v40, v40, v27, v27
  v_fma_f32 v41, v41, v27, v27
  v_fma_f32 v42, v42, v27, v27
  v_fma_f32 v43, v43, v27, v27
  v_rcp_f32 v40, v40
  v_rcp_f32 v41, v41
  v_rcp_f32 v42, v42
  v_rcp_f32 v43, v43
  s_nop 0
  v_mul_f32 v44, v44, v40
  v_mul_f32 v45, v45, v41
  v_mul_f32 v46, v46, v42
  v_mul_f32 v47, v47, v43
  v_cvt_pk_bf16_f32 v54, v44, v45
  v_cvt_pk_bf16_f32 v55, v46, v47
  s_add_u32 s97, s99, 49152
  buffer_store_dwordx4 v[52:55], v4, s[20:23], s97 offen sc1
  v_rcp_f32 v56, v29
  s_nop 0
  v_mul_f32 v56, s98, v56
  v_fma_f32 v40, -v28, v8, v102
  v_fma_f32 v41, -v28, v9, v103
  v_fma_f32 v42, -v28, v10, v104
  v_fma_f32 v43, -v28, v11, v105
  v_mul_f32 v40, v40, v56
  v_mul_f32 v41, v41, v56
  v_mul_f32 v42, v42, v56
  v_mul_f32 v43, v43, v56
  v_exp_f32 v40, v40
  v_exp_f32 v41, v41
  v_exp_f32 v42, v42
  v_exp_f32 v43, v43
  v_fma_f32 v44, -v28, v12, v106
  v_fma_f32 v45, -v28, v13, v107
  v_fma_f32 v46, -v28, v14, v108
  v_fma_f32 v47, -v28, v15, v109
  v_fma_f32 v40, v40, v29, v29
  v_fma_f32 v41, v41, v29, v29
  v_fma_f32 v42, v42, v29, v29
  v_fma_f32 v43, v43, v29, v29
  v_rcp_f32 v40, v40
  v_rcp_f32 v41, v41
  v_rcp_f32 v42, v42
  v_rcp_f32 v43, v43
  s_nop 0
  v_mul_f32 v44, v44, v40
  v_mul_f32 v45, v45, v41
  v_mul_f32 v46, v46, v42
  v_mul_f32 v47, v47, v43
  v_cvt_pk_bf16_f32 v48, v44, v45
  v_cvt_pk_bf16_f32 v49, v46, v47
  v_fma_f32 v40, -v28, v16, v110
  v_fma_f32 v41, -v28, v17, v111
  v_fma_f32 v42, -v28, v18, v112
  v_fma_f32 v43, -v28, v19, v113
  v_mul_f32 v40, v40, v56
  v_mul_f32 v41, v41, v56
  v_mul_f32 v42, v42, v56
  v_mul_f32 v43, v43, v56
  v_exp_f32 v40, v40
  v_exp_f32 v41, v41
  v_exp_f32 v42, v42
  v_exp_f32 v43, v43
  v_fma_f32 v44, -v28, v20, v114
  v_fma_f32 v45, -v28, v21, v115
  v_fma_f32 v46, -v28, v22, v116
  v_fma_f32 v47, -v28, v23, v117
  v_fma_f32 v40, v40, v29, v29
  v_fma_f32 v41, v41, v29, v29
  v_fma_f32 v42, v42, v29, v29
  v_fma_f32 v43, v43, v29, v29
  v_rcp_f32 v40, v40
  v_rcp_f32 v41, v41
  v_rcp_f32 v42, v42
  v_rcp_f32 v43, v43
  s_nop 0
  v_mul_f32 v44, v44, v40
  v_mul_f32 v45, v45, v41
  v_mul_f32 v46, v46, v42
  v_mul_f32 v47, v47, v43
  v_cvt_pk_bf16_f32 v50, v44, v45
  v_cvt_pk_bf16_f32 v51, v46, v47
  s_add_u32 s97, s99, 98304
  buffer_store_dwordx4 v[48:51], v4, s[20:23], s97 offen sc1
  s_branch L_k1_hsig
L_k1_gsp:
  s_waitcnt vmcnt(0) lgkmcnt(0)
  s_cmp_eq_u32 s70, 0
  s_cbranch_scc1 L_p1_44
  s_barrier
L_p1_44:
  s_barrier
  s_barrier
  s_barrier
  s_barrier
  s_barrier
  s_barrier
  s_barrier
  s_barrier
  s_barrier
  s_barrier
  s_branch L_k1_p2
L_k1_hsig:
  s_waitcnt vmcnt(0)
  v_mov_b32 v3, 163776
  v_mov_b32 v4, 1
  v_mov_b32 v5, 0
  s_mov_b64 exec, 1
  ds_add_rtn_u32 v6, v3, v4 offset:16
  s_waitcnt lgkmcnt(0)
  v_readfirstlane_b32 s96, v6
  s_cmp_lg_u32 s96, 7
  s_cbranch_scc1 L_hs_45
  s_lshl_b32 s96, s52, 7
  s_lshl_b32 s97, s53, 2
  s_add_u32 s96, s96, s97
  s_add_u32 s96, s96, 15888384
  buffer_store_dword v4, v5, s[20:23], s96 offen sc1
L_hs_45:
  s_mov_b64 exec, -1
L_k1_p2:
  s_cmp_ge_u32 s3, 6
  s_cbranch_scc1 L_k1_p2b
  s_setprio 1
  s_sub_u32 s60, s3, 2
  s_lshl_b32 s61, s80, 2
  s_add_u32 s61, s61, s60
  s_mul_i32 s62, s81, 160
  v_lshlrev_b32 v2, 4, v0
  s_lshl_b32 s96, s60, 11
  s_add_u32 s96, s96, 81920
  v_add_u32 v3, s96, v2
  v_add_u32 v124, 0x10000, v2
  v_and_b32 v4, 15, v0
  v_lshrrev_b32 v5, 4, v0
  v_mul_u32_u24 v4, 176, v4
  v_lshl_add_u32 v4, v5, 3, v4
  s_mul_i32 s63, s60, 2816
  s_add_u32 s63, s63, 149504
  v_add_u32 v4, s63, v4
  s_mul_i32 s96, s60, 2560
  s_add_u32 s96, s96, 0
  v_lshlrev_b32 v5, 3, v0
  v_add_u32 v5, s96, v5
  v_mov_b64 v[8:9], 0
  v_mov_b64 v[10:11], 0
  v_mov_b64 v[12:13], 0
  v_mov_b64 v[14:15], 0
  v_mov_b64 v[16:17], 0
  v_mov_b64 v[18:19], 0
  v_mov_b64 v[20:21], 0
  v_mov_b64 v[22:23], 0
  v_mov_b64 v[24:25], 0
  v_mov_b64 v[26:27], 0
  s_barrier
  s_barrier
  ds_read_b128 v[48:51], v3 offset:0
  ds_read_b128 v[28:31], v2 offset:0
  ds_read_b128 v[32:35], v2 offset:1024
  ds_read_b128 v[36:39], v2 offset:2048
  ds_read_b128 v[40:43], v2 offset:3072
  ds_read_b128 v[44:47], v2 offset:4096
  ds_read_b128 v[72:75], v3 offset:1024
  ds_read_b128 v[52:55], v2 offset:5120
  ds_read_b128 v[56:59], v2 offset:6144
  ds_read_b128 v[60:63], v2 offset:7168
  ds_read_b128 v[64:67], v2 offset:8192
  ds_read_b128 v[68:71], v2 offset:9216
  s_waitcnt lgkmcnt(0)
  s_barrier
  ds_read_b128 v[96:99], v3 offset:8192
  ds_read_b128 v[76:79], v2 offset:10240
  ds_read_b128 v[80:83], v2 offset:11264
  v_mfma_f32_16x16x32_bf16 v[8:11], v[28:31], v[48:51], v[8:11]
  ds_read_b128 v[84:87], v2 offset:12288
  v_mfma_f32_16x16x32_bf16 v[12:15], v[32:35], v[48:51], v[12:15]
  ds_read_b128 v[88:91], v2 offset:13312
  v_mfma_f32_16x16x32_bf16 v[16:19], v[36:39], v[48:51], v[16:19]
  ds_read_b128 v[92:95], v2 offset:14336
  v_mfma_f32_16x16x32_bf16 v[20:23], v[40:43], v[48:51], v[20:23]
  ds_read_b128 v[120:123], v3 offset:9216
  v_mfma_f32_16x16x32_bf16 v[24:27], v[44:47], v[48:51], v[24:27]
  ds_read_b128 v[100:103], v2 offset:15360
  v_mfma_f32_16x16x32_bf16 v[8:11], v[52:55], v[72:75], v[8:11]
  ds_read_b128 v[104:107], v2 offset:16384
  v_mfma_f32_16x16x32_bf16 v[12:15], v[56:59], v[72:75], v[12:15]
  ds_read_b128 v[108:111], v2 offset:17408
  v_mfma_f32_16x16x32_bf16 v[16:19], v[60:63], v[72:75], v[16:19]
  ds_read_b128 v[112:115], v2 offset:18432
  v_mfma_f32_16x16x32_bf16 v[20:23], v[64:67], v[72:75], v[20:23]
  ds_read_b128 v[116:119], v2 offset:19456
  v_mfma_f32_16x16x32_bf16 v[24:27], v[68:71], v[72:75], v[24:27]
  s_waitcnt lgkmcnt(0)
  s_barrier
  ds_read_b128 v[48:51], v3 offset:16384
  ds_read_b128 v[28:31], v2 offset:20480
  ds_read_b128 v[32:35], v2 offset:21504
  v_mfma_f32_16x16x32_bf16 v[8:11], v[76:79], v[96:99], v[8:11]
  ds_read_b128 v[36:39], v2 offset:22528
  v_mfma_f32_16x16x32_bf16 v[12:15], v[80:83], v[96:99], v[12:15]
  ds_read_b128 v[40:43], v2 offset:23552
  v_mfma_f32_16x16x32_bf16 v[16:19], v[84:87], v[96:99], v[16:19]
  ds_read_b128 v[44:47], v2 offset:24576
  v_mfma_f32_16x16x32_bf16 v[20:23], v[88:91], v[96:99], v[20:23]
  ds_read_b128 v[72:75], v3 offset:17408
  v_mfma_f32_16x16x32_bf16 v[24:27], v[92:95], v[96:99], v[24:27]
  ds_read_b128 v[52:55], v2 offset:25600
  v_mfma_f32_16x16x32_bf16 v[8:11], v[100:103], v[120:123], v[8:11]
  ds_read_b128 v[56:59], v2 offset:26624
  v_mfma_f32_16x16x32_bf16 v[12:15], v[104:107], v[120:123], v[12:15]
  ds_read_b128 v[60:63], v2 offset:27648
  v_mfma_f32_16x16x32_bf16 v[16:19], v[108:111], v[120:123], v[16:19]
  ds_read_b128 v[64:67], v2 offset:28672
  v_mfma_f32_16x16x32_bf16 v[20:23], v[112:115], v[120:123], v[20:23]
  ds_read_b128 v[68:71], v2 offset:29696
  v_mfma_f32_16x16x32_bf16 v[24:27], v[116:119], v[120:123], v[24:27]
  s_waitcnt lgkmcnt(0)
  s_barrier
  ds_read_b128 v[96:99], v3 offset:24576
  ds_read_b128 v[76:79], v2 offset:30720
  ds_read_b128 v[80:83], v2 offset:31744
  v_mfma_f32_16x16x32_bf16 v[8:11], v[28:31], v[48:51], v[8:11]
  ds_read_b128 v[84:87], v2 offset:32768
  v_mfma_f32_16x16x32_bf16 v[12:15], v[32:35], v[48:51], v[12:15]
  ds_read_b128 v[88:91], v2 offset:33792
  v_mfma_f32_16x16x32_bf16 v[16:19], v[36:39], v[48:51], v[16:19]
  ds_read_b128 v[92:95], v2 offset:34816
  v_mfma_f32_16x16x32_bf16 v[20:23], v[40:43], v[48:51], v[20:23]
  ds_read_b128 v[120:123], v3 offset:25600
  v_mfma_f32_16x16x32_bf16 v[24:27], v[44:47], v[48:51], v[24:27]
  ds_read_b128 v[100:103], v2 offset:35840
  v_mfma_f32_16x16x32_bf16 v[8:11], v[52:55], v[72:75], v[8:11]
  ds_read_b128 v[104:107], v2 offset:36864
  v_mfma_f32_16x16x32_bf16 v[12:15], v[56:59], v[72:75], v[12:15]
  ds_read_b128 v[108:111], v2 offset:37888
  v_mfma_f32_16x16x32_bf16 v[16:19], v[60:63], v[72:75], v[16:19]
  ds_read_b128 v[112:115], v2 offset:38912
  v_mfma_f32_16x16x32_bf16 v[20:23], v[64:67], v[72:75], v[20:23]
  ds_read_b128 v[116:119], v2 offset:39936
  v_mfma_f32_16x16x32_bf16 v[24:27], v[68:71], v[72:75], v[24:27]
  s_waitcnt lgkmcnt(0)
  s_barrier
  ds_read_b128 v[48:51], v3 offset:32768
  ds_read_b128 v[28:31], v2 offset:40960
  ds_read_b128 v[32:35], v2 offset:41984
  v_mfma_f32_16x16x32_bf16 v[8:11], v[76:79], v[96:99], v[8:11]
  ds_read_b128 v[36:39], v2 offset:43008
  v_mfma_f32_16x16x32_bf16 v[12:15], v[80:83], v[96:99], v[12:15]
  ds_read_b128 v[40:43], v2 offset:44032
  v_mfma_f32_16x16x32_bf16 v[16:19], v[84:87], v[96:99], v[16:19]
  ds_read_b128 v[44:47], v2 offset:45056
  v_mfma_f32_16x16x32_bf16 v[20:23], v[88:91], v[96:99], v[20:23]
  ds_read_b128 v[72:75], v3 offset:33792
  v_mfma_f32_16x16x32_bf16 v[24:27], v[92:95], v[96:99], v[24:27]
  ds_read_b128 v[52:55], v2 offset:46080
  v_mfma_f32_16x16x32_bf16 v[8:11], v[100:103], v[120:123], v[8:11]
  ds_read_b128 v[56:59], v2 offset:47104
  v_mfma_f32_16x16x32_bf16 v[12:15], v[104:107], v[120:123], v[12:15]
  ds_read_b128 v[60:63], v2 offset:48128
  v_mfma_f32_16x16x32_bf16 v[16:19], v[108:111], v[120:123], v[16:19]
  ds_read_b128 v[64:67], v2 offset:49152
  v_mfma_f32_16x16x32_bf16 v[20:23], v[112:115], v[120:123], v[20:23]
  ds_read_b128 v[68:71], v2 offset:50176
  v_mfma_f32_16x16x32_bf16 v[24:27], v[116:119], v[120:123], v[24:27]
  s_waitcnt lgkmcnt(0)
  s_barrier
  ds_read_b128 v[96:99], v3 offset:40960
  ds_read_b128 v[76:79], v2 offset:51200
  ds_read_b128 v[80:83], v2 offset:52224
  v_mfma_f32_16x16x32_bf16 v[8:11], v[28:31], v[48:51], v[8:11]
  ds_read_b128 v[84:87], v2 offset:53248
  v_mfma_f32_16x16x32_bf16 v[12:15], v[32:35], v[48:51], v[12:15]
  ds_read_b128 v[88:91], v2 offset:54272
  v_mfma_f32_16x16x32_bf16 v[16:19], v[36:39], v[48:51], v[16:19]
  ds_read_b128 v[92:95], v2 offset:55296
  v_mfma_f32_16x16x32_bf16 v[20:23], v[40:43], v[48:51], v[20:23]
  ds_read_b128 v[120:123], v3 offset:41984
  v_mfma_f32_16x16x32_bf16 v[24:27], v[44:47], v[48:51], v[24:27]
  ds_read_b128 v[100:103], v2 offset:56320
  v_mfma_f32_16x16x32_bf16 v[8:11], v[52:55], v[72:75], v[8:11]
  ds_read_b128 v[104:107], v2 offset:57344
  v_mfma_f32_16x16x32_bf16 v[12:15], v[56:59], v[72:75], v[12:15]
  ds_read_b128 v[108:111], v2 offset:58368
  v_mfma_f32_16x16x32_bf16 v[16:19], v[60:63], v[72:75], v[16:19]
  ds_read_b128 v[112:115], v2 offset:59392
  v_mfma_f32_16x16x32_bf16 v[20:23], v[64:67], v[72:75], v[20:23]
  ds_read_b128 v[116:119], v2 offset:60416
  v_mfma_f32_16x16x32_bf16 v[24:27], v[68:71], v[72:75], v[24:27]
  s_waitcnt lgkmcnt(0)
  s_barrier
  ds_read_b128 v[48:51], v3 offset:49152
  ds_read_b128 v[28:31], v2 offset:61440
  ds_read_b128 v[32:35], v2 offset:62464
  v_mfma_f32_16x16x32_bf16 v[8:11], v[76:79], v[96:99], v[8:11]
  ds_read_b128 v[36:39], v2 offset:63488
  v_mfma_f32_16x16x32_bf16 v[12:15], v[80:83], v[96:99], v[12:15]
  ds_read_b128 v[40:43], v2 offset:64512
  v_mfma_f32_16x16x32_bf16 v[16:19], v[84:87], v[96:99], v[16:19]
  ds_read_b128 v[44:47], v124 offset:0
  v_mfma_f32_16x16x32_bf16 v[20:23], v[88:91], v[96:99], v[20:23]
  ds_read_b128 v[72:75], v3 offset:50176
  v_mfma_f32_16x16x32_bf16 v[24:27], v[92:95], v[96:99], v[24:27]
  ds_read_b128 v[52:55], v124 offset:1024
  v_mfma_f32_16x16x32_bf16 v[8:11], v[100:103], v[120:123], v[8:11]
  ds_read_b128 v[56:59], v124 offset:2048
  v_mfma_f32_16x16x32_bf16 v[12:15], v[104:107], v[120:123], v[12:15]
  ds_read_b128 v[60:63], v124 offset:3072
  v_mfma_f32_16x16x32_bf16 v[16:19], v[108:111], v[120:123], v[16:19]
  ds_read_b128 v[64:67], v124 offset:4096
  v_mfma_f32_16x16x32_bf16 v[20:23], v[112:115], v[120:123], v[20:23]
  ds_read_b128 v[68:71], v124 offset:5120
  v_mfma_f32_16x16x32_bf16 v[24:27], v[116:119], v[120:123], v[24:27]
  s_waitcnt lgkmcnt(0)
  s_barrier
  ds_read_b128 v[96:99], v3 offset:57344
  ds_read_b128 v[76:79], v124 offset:6144
  ds_read_b128 v[80:83], v124 offset:7168
  v_mfma_f32_16x16x32_bf16 v[8:11], v[28:31], v[48:51], v[8:11]
  ds_read_b128 v[84:87], v124 offset:8192
  v_mfma_f32_16x16x32_bf16 v[12:15], v[32:35], v[48:51], v[12:15]
  ds_read_b128 v[88:91], v124 offset:9216
  v_mfma_f32_16x16x32_bf16 v[16:19], v[36:39], v[48:51], v[16:19]
  ds_read_b128 v[92:95], v124 offset:10240
  v_mfma_f32_16x16x32_bf16 v[20:23], v[40:43], v[48:51], v[20:23]
  ds_read_b128 v[120:123], v3 offset:58368
  v_mfma_f32_16x16x32_bf16 v[24:27], v[44:47], v[48:51], v[24:27]
  ds_read_b128 v[100:103], v124 offset:11264
  v_mfma_f32_16x16x32_bf16 v[8:11], v[52:55], v[72:75], v[8:11]
  ds_read_b128 v[104:107], v124 offset:12288
  v_mfma_f32_16x16x32_bf16 v[12:15], v[56:59], v[72:75], v[12:15]
  ds_read_b128 v[108:111], v124 offset:13312
  v_mfma_f32_16x16x32_bf16 v[16:19], v[60:63], v[72:75], v[16:19]
  ds_read_b128 v[112:115], v124 offset:14336
  v_mfma_f32_16x16x32_bf16 v[20:23], v[64:67], v[72:75], v[20:23]
  ds_read_b128 v[116:119], v124 offset:15360
  v_mfma_f32_16x16x32_bf16 v[24:27], v[68:71], v[72:75], v[24:27]
  s_waitcnt lgkmcnt(0)
  s_barrier
  ds_read_b128 v[48:51], v3 offset:0
  ds_read_b128 v[28:31], v2 offset:0
  ds_read_b128 v[32:35], v2 offset:1024
  v_mfma_f32_16x16x32_bf16 v[8:11], v[76:79], v[96:99], v[8:11]
  ds_read_b128 v[36:39], v2 offset:2048
  v_mfma_f32_16x16x32_bf16 v[12:15], v[80:83], v[96:99], v[12:15]
  ds_read_b128 v[40:43], v2 offset:3072
  v_mfma_f32_16x16x32_bf16 v[16:19], v[84:87], v[96:99], v[16:19]
  ds_read_b128 v[44:47], v2 offset:4096
  v_mfma_f32_16x16x32_bf16 v[20:23], v[88:91], v[96:99], v[20:23]
  ds_read_b128 v[72:75], v3 offset:1024
  v_mfma_f32_16x16x32_bf16 v[24:27], v[92:95], v[96:99], v[24:27]
  ds_read_b128 v[52:55], v2 offset:5120
  v_mfma_f32_16x16x32_bf16 v[8:11], v[100:103], v[120:123], v[8:11]
  ds_read_b128 v[56:59], v2 offset:6144
  v_mfma_f32_16x16x32_bf16 v[12:15], v[104:107], v[120:123], v[12:15]
  ds_read_b128 v[60:63], v2 offset:7168
  v_mfma_f32_16x16x32_bf16 v[16:19], v[108:111], v[120:123], v[16:19]
  ds_read_b128 v[64:67], v2 offset:8192
  v_mfma_f32_16x16x32_bf16 v[20:23], v[112:115], v[120:123], v[20:23]
  ds_read_b128 v[68:71], v2 offset:9216
  v_mfma_f32_16x16x32_bf16 v[24:27], v[116:119], v[120:123], v[24:27]
  s_waitcnt lgkmcnt(0)
  s_barrier
  ds_read_b128 v[96:99], v3 offset:8192
  ds_read_b128 v[76:79], v2 offset:10240
  ds_read_b128 v[80:83], v2 offset:11264
  v_mfma_f32_16x16x32_bf16 v[8:11], v[28:31], v[48:51], v[8:11]
  ds_read_b128 v[84:87], v2 offset:12288
  v_mfma_f32_16x16x32_bf16 v[12:15], v[32:35], v[48:51], v[12:15]
  ds_read_b128 v[88:91], v2 offset:13312
  v_mfma_f32_16x16x32_bf16 v[16:19], v[36:39], v[48:51], v[16:19]
  ds_read_b128 v[92:95], v2 offset:14336
  v_mfma_f32_16x16x32_bf16 v[20:23], v[40:43], v[48:51], v[20:23]
  ds_read_b128 v[120:123], v3 offset:9216
  v_mfma_f32_16x16x32_bf16 v[24:27], v[44:47], v[48:51], v[24:27]
  ds_read_b128 v[100:103], v2 offset:15360
  v_mfma_f32_16x16x32_bf16 v[8:11], v[52:55], v[72:75], v[8:11]
  ds_read_b128 v[104:107], v2 offset:16384
  v_mfma_f32_16x16x32_bf16 v[12:15], v[56:59], v[72:75], v[12:15]
  ds_read_b128 v[108:111], v2 offset:17408
  v_mfma_f32_16x16x32_bf16 v[16:19], v[60:63], v[72:75], v[16:19]
  ds_read_b128 v[112:115], v2 offset:18432
  v_mfma_f32_16x16x32_bf16 v[20:23], v[64:67], v[72:75], v[20:23]
  ds_read_b128 v[116:119], v2 offset:19456
  v_mfma_f32_16x16x32_bf16 v[24:27], v[68:71], v[72:75], v[24:27]
  s_waitcnt lgkmcnt(0)
  s_barrier
  ds_read_b128 v[48:51], v3 offset:16384
  ds_read_b128 v[28:31], v2 offset:20480
  ds_read_b128 v[32:35], v2 offset:21504
  v_mfma_f32_16x16x32_bf16 v[8:11], v[76:79], v[96:99], v[8:11]
  ds_read_b128 v[36:39], v2 offset:22528
  v_mfma_f32_16x16x32_bf16 v[12:15], v[80:83], v[96:99], v[12:15]
  ds_read_b128 v[40:43], v2 offset:23552
  v_mfma_f32_16x16x32_bf16 v[16:19], v[84:87], v[96:99], v[16:19]
  ds_read_b128 v[44:47], v2 offset:24576
  v_mfma_f32_16x16x32_bf16 v[20:23], v[88:91], v[96:99], v[20:23]
  ds_read_b128 v[72:75], v3 offset:17408
  v_mfma_f32_16x16x32_bf16 v[24:27], v[92:95], v[96:99], v[24:27]
  ds_read_b128 v[52:55], v2 offset:25600
  v_mfma_f32_16x16x32_bf16 v[8:11], v[100:103], v[120:123], v[8:11]
  ds_read_b128 v[56:59], v2 offset:26624
  v_mfma_f32_16x16x32_bf16 v[12:15], v[104:107], v[120:123], v[12:15]
  ds_read_b128 v[60:63], v2 offset:27648
  v_mfma_f32_16x16x32_bf16 v[16:19], v[108:111], v[120:123], v[16:19]
  ds_read_b128 v[64:67], v2 offset:28672
  v_mfma_f32_16x16x32_bf16 v[20:23], v[112:115], v[120:123], v[20:23]
  ds_read_b128 v[68:71], v2 offset:29696
  v_mfma_f32_16x16x32_bf16 v[24:27], v[116:119], v[120:123], v[24:27]
  s_waitcnt lgkmcnt(0)
  s_barrier
  ds_read_b128 v[96:99], v3 offset:24576
  ds_read_b128 v[76:79], v2 offset:30720
  ds_read_b128 v[80:83], v2 offset:31744
  v_mfma_f32_16x16x32_bf16 v[8:11], v[28:31], v[48:51], v[8:11]
  ds_read_b128 v[84:87], v2 offset:32768
  v_mfma_f32_16x16x32_bf16 v[12:15], v[32:35], v[48:51], v[12:15]
  ds_read_b128 v[88:91], v2 offset:33792
  v_mfma_f32_16x16x32_bf16 v[16:19], v[36:39], v[48:51], v[16:19]
  ds_read_b128 v[92:95], v2 offset:34816
  v_mfma_f32_16x16x32_bf16 v[20:23], v[40:43], v[48:51], v[20:23]
  ds_read_b128 v[120:123], v3 offset:25600
  v_mfma_f32_16x16x32_bf16 v[24:27], v[44:47], v[48:51], v[24:27]
  ds_read_b128 v[100:103], v2 offset:35840
  v_mfma_f32_16x16x32_bf16 v[8:11], v[52:55], v[72:75], v[8:11]
  ds_read_b128 v[104:107], v2 offset:36864
  v_mfma_f32_16x16x32_bf16 v[12:15], v[56:59], v[72:75], v[12:15]
  ds_read_b128 v[108:111], v2 offset:37888
  v_mfma_f32_16x16x32_bf16 v[16:19], v[60:63], v[72:75], v[16:19]
  ds_read_b128 v[112:115], v2 offset:38912
  v_mfma_f32_16x16x32_bf16 v[20:23], v[64:67], v[72:75], v[20:23]
  ds_read_b128 v[116:119], v2 offset:39936
  v_mfma_f32_16x16x32_bf16 v[24:27], v[68:71], v[72:75], v[24:27]
  s_waitcnt lgkmcnt(0)
  s_barrier
  ds_read_b128 v[48:51], v3 offset:32768
  ds_read_b128 v[28:31], v2 offset:40960
  ds_read_b128 v[32:35], v2 offset:41984
  v_mfma_f32_16x16x32_bf16 v[8:11], v[76:79], v[96:99], v[8:11]
  ds_read_b128 v[36:39], v2 offset:43008
  v_mfma_f32_16x16x32_bf16 v[12:15], v[80:83], v[96:99], v[12:15]
  ds_read_b128 v[40:43], v2 offset:44032
  v_mfma_f32_16x16x32_bf16 v[16:19], v[84:87], v[96:99], v[16:19]
  ds_read_b128 v[44:47], v2 offset:45056
  v_mfma_f32_16x16x32_bf16 v[20:23], v[88:91], v[96:99], v[20:23]
  ds_read_b128 v[72:75], v3 offset:33792
  v_mfma_f32_16x16x32_bf16 v[24:27], v[92:95], v[96:99], v[24:27]
  ds_read_b128 v[52:55], v2 offset:46080
  v_mfma_f32_16x16x32_bf16 v[8:11], v[100:103], v[120:123], v[8:11]
  ds_read_b128 v[56:59], v2 offset:47104
  v_mfma_f32_16x16x32_bf16 v[12:15], v[104:107], v[120:123], v[12:15]
  ds_read_b128 v[60:63], v2 offset:48128
  v_mfma_f32_16x16x32_bf16 v[16:19], v[108:111], v[120:123], v[16:19]
  ds_read_b128 v[64:67], v2 offset:49152
  v_mfma_f32_16x16x32_bf16 v[20:23], v[112:115], v[120:123], v[20:23]
  ds_read_b128 v[68:71], v2 offset:50176
  v_mfma_f32_16x16x32_bf16 v[24:27], v[116:119], v[120:123], v[24:27]
  s_waitcnt lgkmcnt(0)
  s_barrier
  ds_read_b128 v[96:99], v3 offset:40960
  ds_read_b128 v[76:79], v2 offset:51200
  ds_read_b128 v[80:83], v2 offset:52224
  v_mfma_f32_16x16x32_bf16 v[8:11], v[28:31], v[48:51], v[8:11]
  ds_read_b128 v[84:87], v2 offset:53248
  v_mfma_f32_16x16x32_bf16 v[12:15], v[32:35], v[48:51], v[12:15]
  ds_read_b128 v[88:91], v2 offset:54272
  v_mfma_f32_16x16x32_bf16 v[16:19], v[36:39], v[48:51], v[16:19]
  ds_read_b128 v[92:95], v2 offset:55296
  v_mfma_f32_16x16x32_bf16 v[20:23], v[40:43], v[48:51], v[20:23]
  ds_read_b128 v[120:123], v3 offset:41984
  v_mfma_f32_16x16x32_bf16 v[24:27], v[44:47], v[48:51], v[24:27]
  ds_read_b128 v[100:103], v2 offset:56320
  v_mfma_f32_16x16x32_bf16 v[8:11], v[52:55], v[72:75], v[8:11]
  ds_read_b128 v[104:107], v2 offset:57344
  v_mfma_f32_16x16x32_bf16 v[12:15], v[56:59], v[72:75], v[12:15]
  ds_read_b128 v[108:111], v2 offset:58368
  v_mfma_f32_16x16x32_bf16 v[16:19], v[60:63], v[72:75], v[16:19]
  ds_read_b128 v[112:115], v2 offset:59392
  v_mfma_f32_16x16x32_bf16 v[20:23], v[64:67], v[72:75], v[20:23]
  ds_read_b128 v[116:119], v2 offset:60416
  v_mfma_f32_16x16x32_bf16 v[24:27], v[68:71], v[72:75], v[24:27]
  s_waitcnt lgkmcnt(0)
  s_barrier
  ds_read_b128 v[48:51], v3 offset:49152
  ds_read_b128 v[28:31], v2 offset:61440
  ds_read_b128 v[32:35], v2 offset:62464
  v_mfma_f32_16x16x32_bf16 v[8:11], v[76:79], v[96:99], v[8:11]
  ds_read_b128 v[36:39], v2 offset:63488
  v_mfma_f32_16x16x32_bf16 v[12:15], v[80:83], v[96:99], v[12:15]
  ds_read_b128 v[40:43], v2 offset:64512
  v_mfma_f32_16x16x32_bf16 v[16:19], v[84:87], v[96:99], v[16:19]
  ds_read_b128 v[44:47], v124 offset:0
  v_mfma_f32_16x16x32_bf16 v[20:23], v[88:91], v[96:99], v[20:23]
  ds_read_b128 v[72:75], v3 offset:50176
  v_mfma_f32_16x16x32_bf16 v[24:27], v[92:95], v[96:99], v[24:27]
  ds_read_b128 v[52:55], v124 offset:1024
  v_mfma_f32_16x16x32_bf16 v[8:11], v[100:103], v[120:123], v[8:11]
  ds_read_b128 v[56:59], v124 offset:2048
  v_mfma_f32_16x16x32_bf16 v[12:15], v[104:107], v[120:123], v[12:15]
  ds_read_b128 v[60:63], v124 offset:3072
  v_mfma_f32_16x16x32_bf16 v[16:19], v[108:111], v[120:123], v[16:19]
  ds_read_b128 v[64:67], v124 offset:4096
  v_mfma_f32_16x16x32_bf16 v[20:23], v[112:115], v[120:123], v[20:23]
  ds_read_b128 v[68:71], v124 offset:5120
  v_mfma_f32_16x16x32_bf16 v[24:27], v[116:119], v[120:123], v[24:27]
  s_waitcnt lgkmcnt(0)
  s_barrier
  ds_read_b128 v[96:99], v3 offset:57344
  ds_read_b128 v[76:79], v124 offset:6144
  ds_read_b128 v[80:83], v124 offset:7168
  v_mfma_f32_16x16x32_bf16 v[8:11], v[28:31], v[48:51], v[8:11]
  ds_read_b128 v[84:87], v124 offset:8192
  v_mfma_f32_16x16x32_bf16 v[12:15], v[32:35], v[48:51], v[12:15]
  ds_read_b128 v[88:91], v124 offset:9216
  v_mfma_f32_16x16x32_bf16 v[16:19], v[36:39], v[48:51], v[16:19]
  ds_read_b128 v[92:95], v124 offset:10240
  v_mfma_f32_16x16x32_bf16 v[20:23], v[40:43], v[48:51], v[20:23]
  ds_read_b128 v[120:123], v3 offset:58368
  v_mfma_f32_16x16x32_bf16 v[24:27], v[44:47], v[48:51], v[24:27]
  ds_read_b128 v[100:103], v124 offset:11264
  v_mfma_f32_16x16x32_bf16 v[8:11], v[52:55], v[72:75], v[8:11]
  ds_read_b128 v[104:107], v124 offset:12288
  v_mfma_f32_16x16x32_bf16 v[12:15], v[56:59], v[72:75], v[12:15]
  ds_read_b128 v[108:111], v124 offset:13312
  v_mfma_f32_16x16x32_bf16 v[16:19], v[60:63], v[72:75], v[16:19]
  ds_read_b128 v[112:115], v124 offset:14336
  v_mfma_f32_16x16x32_bf16 v[20:23], v[64:67], v[72:75], v[20:23]
  ds_read_b128 v[116:119], v124 offset:15360
  v_mfma_f32_16x16x32_bf16 v[24:27], v[68:71], v[72:75], v[24:27]
  s_waitcnt lgkmcnt(0)
  s_barrier
  ds_read_b128 v[48:51], v3 offset:0
  ds_read_b128 v[28:31], v2 offset:0
  ds_read_b128 v[32:35], v2 offset:1024
  v_mfma_f32_16x16x32_bf16 v[8:11], v[76:79], v[96:99], v[8:11]
  ds_read_b128 v[36:39], v2 offset:2048
  v_mfma_f32_16x16x32_bf16 v[12:15], v[80:83], v[96:99], v[12:15]
  ds_read_b128 v[40:43], v2 offset:3072
  v_mfma_f32_16x16x32_bf16 v[16:19], v[84:87], v[96:99], v[16:19]
  ds_read_b128 v[44:47], v2 offset:4096
  v_mfma_f32_16x16x32_bf16 v[20:23], v[88:91], v[96:99], v[20:23]
  ds_read_b128 v[72:75], v3 offset:1024
  v_mfma_f32_16x16x32_bf16 v[24:27], v[92:95], v[96:99], v[24:27]
  ds_read_b128 v[52:55], v2 offset:5120
  v_mfma_f32_16x16x32_bf16 v[8:11], v[100:103], v[120:123], v[8:11]
  ds_read_b128 v[56:59], v2 offset:6144
  v_mfma_f32_16x16x32_bf16 v[12:15], v[104:107], v[120:123], v[12:15]
  ds_read_b128 v[60:63], v2 offset:7168
  v_mfma_f32_16x16x32_bf16 v[16:19], v[108:111], v[120:123], v[16:19]
  ds_read_b128 v[64:67], v2 offset:8192
  v_mfma_f32_16x16x32_bf16 v[20:23], v[112:115], v[120:123], v[20:23]
  ds_read_b128 v[68:71], v2 offset:9216
  v_mfma_f32_16x16x32_bf16 v[24:27], v[116:119], v[120:123], v[24:27]
  s_waitcnt lgkmcnt(0)
  s_barrier
  ds_read_b128 v[96:99], v3 offset:8192
  ds_read_b128 v[76:79], v2 offset:10240
  ds_read_b128 v[80:83], v2 offset:11264
  v_mfma_f32_16x16x32_bf16 v[8:11], v[28:31], v[48:51], v[8:11]
  ds_read_b128 v[84:87], v2 offset:12288
  v_mfma_f32_16x16x32_bf16 v[12:15], v[32:35], v[48:51], v[12:15]
  ds_read_b128 v[88:91], v2 offset:13312
  v_mfma_f32_16x16x32_bf16 v[16:19], v[36:39], v[48:51], v[16:19]
  ds_read_b128 v[92:95], v2 offset:14336
  v_mfma_f32_16x16x32_bf16 v[20:23], v[40:43], v[48:51], v[20:23]
  ds_read_b128 v[120:123], v3 offset:9216
  v_mfma_f32_16x16x32_bf16 v[24:27], v[44:47], v[48:51], v[24:27]
  ds_read_b128 v[100:103], v2 offset:15360
  v_mfma_f32_16x16x32_bf16 v[8:11], v[52:55], v[72:75], v[8:11]
  ds_read_b128 v[104:107], v2 offset:16384
  v_mfma_f32_16x16x32_bf16 v[12:15], v[56:59], v[72:75], v[12:15]
  ds_read_b128 v[108:111], v2 offset:17408
  v_mfma_f32_16x16x32_bf16 v[16:19], v[60:63], v[72:75], v[16:19]
  ds_read_b128 v[112:115], v2 offset:18432
  v_mfma_f32_16x16x32_bf16 v[20:23], v[64:67], v[72:75], v[20:23]
  ds_read_b128 v[116:119], v2 offset:19456
  v_mfma_f32_16x16x32_bf16 v[24:27], v[68:71], v[72:75], v[24:27]
  s_waitcnt lgkmcnt(0)
  s_barrier
  ds_read_b128 v[48:51], v3 offset:16384
  ds_read_b128 v[28:31], v2 offset:20480
  ds_read_b128 v[32:35], v2 offset:21504
  v_mfma_f32_16x16x32_bf16 v[8:11], v[76:79], v[96:99], v[8:11]
  ds_read_b128 v[36:39], v2 offset:22528
  v_mfma_f32_16x16x32_bf16 v[12:15], v[80:83], v[96:99], v[12:15]
  ds_read_b128 v[40:43], v2 offset:23552
  v_mfma_f32_16x16x32_bf16 v[16:19], v[84:87], v[96:99], v[16:19]
  ds_read_b128 v[44:47], v2 offset:24576
  v_mfma_f32_16x16x32_bf16 v[20:23], v[88:91], v[96:99], v[20:23]
  ds_read_b128 v[72:75], v3 offset:17408
  v_mfma_f32_16x16x32_bf16 v[24:27], v[92:95], v[96:99], v[24:27]
  ds_read_b128 v[52:55], v2 offset:25600
  v_mfma_f32_16x16x32_bf16 v[8:11], v[100:103], v[120:123], v[8:11]
  ds_read_b128 v[56:59], v2 offset:26624
  v_mfma_f32_16x16x32_bf16 v[12:15], v[104:107], v[120:123], v[12:15]
  ds_read_b128 v[60:63], v2 offset:27648
  v_mfma_f32_16x16x32_bf16 v[16:19], v[108:111], v[120:123], v[16:19]
  ds_read_b128 v[64:67], v2 offset:28672
  v_mfma_f32_16x16x32_bf16 v[20:23], v[112:115], v[120:123], v[20:23]
  ds_read_b128 v[68:71], v2 offset:29696
  v_mfma_f32_16x16x32_bf16 v[24:27], v[116:119], v[120:123], v[24:27]
  s_waitcnt lgkmcnt(0)
  s_barrier
  ds_read_b128 v[96:99], v3 offset:24576
  ds_read_b128 v[76:79], v2 offset:30720
  ds_read_b128 v[80:83], v2 offset:31744
  v_mfma_f32_16x16x32_bf16 v[8:11], v[28:31], v[48:51], v[8:11]
  ds_read_b128 v[84:87], v2 offset:32768
  v_mfma_f32_16x16x32_bf16 v[12:15], v[32:35], v[48:51], v[12:15]
  ds_read_b128 v[88:91], v2 offset:33792
  v_mfma_f32_16x16x32_bf16 v[16:19], v[36:39], v[48:51], v[16:19]
  ds_read_b128 v[92:95], v2 offset:34816
  v_mfma_f32_16x16x32_bf16 v[20:23], v[40:43], v[48:51], v[20:23]
  ds_read_b128 v[120:123], v3 offset:25600
  v_mfma_f32_16x16x32_bf16 v[24:27], v[44:47], v[48:51], v[24:27]
  ds_read_b128 v[100:103], v2 offset:35840
  v_mfma_f32_16x16x32_bf16 v[8:11], v[52:55], v[72:75], v[8:11]
  ds_read_b128 v[104:107], v2 offset:36864
  v_mfma_f32_16x16x32_bf16 v[12:15], v[56:59], v[72:75], v[12:15]
  ds_read_b128 v[108:111], v2 offset:37888
  v_mfma_f32_16x16x32_bf16 v[16:19], v[60:63], v[72:75], v[16:19]
  ds_read_b128 v[112:115], v2 offset:38912
  v_mfma_f32_16x16x32_bf16 v[20:23], v[64:67], v[72:75], v[20:23]
  ds_read_b128 v[116:119], v2 offset:39936
  v_mfma_f32_16x16x32_bf16 v[24:27], v[68:71], v[72:75], v[24:27]
  s_waitcnt lgkmcnt(0)
  s_barrier
  ds_read_b128 v[48:51], v3 offset:32768
  ds_read_b128 v[28:31], v2 offset:40960
  ds_read_b128 v[32:35], v2 offset:41984
  v_mfma_f32_16x16x32_bf16 v[8:11], v[76:79], v[96:99], v[8:11]
  ds_read_b128 v[36:39], v2 offset:43008
  v_mfma_f32_16x16x32_bf16 v[12:15], v[80:83], v[96:99], v[12:15]
  ds_read_b128 v[40:43], v2 offset:44032
  v_mfma_f32_16x16x32_bf16 v[16:19], v[84:87], v[96:99], v[16:19]
  ds_read_b128 v[44:47], v2 offset:45056
  v_mfma_f32_16x16x32_bf16 v[20:23], v[88:91], v[96:99], v[20:23]
  ds_read_b128 v[72:75], v3 offset:33792
  v_mfma_f32_16x16x32_bf16 v[24:27], v[92:95], v[96:99], v[24:27]
  ds_read_b128 v[52:55], v2 offset:46080
  v_mfma_f32_16x16x32_bf16 v[8:11], v[100:103], v[120:123], v[8:11]
  ds_read_b128 v[56:59], v2 offset:47104
  v_mfma_f32_16x16x32_bf16 v[12:15], v[104:107], v[120:123], v[12:15]
  ds_read_b128 v[60:63], v2 offset:48128
  v_mfma_f32_16x16x32_bf16 v[16:19], v[108:111], v[120:123], v[16:19]
  ds_read_b128 v[64:67], v2 offset:49152
  v_mfma_f32_16x16x32_bf16 v[20:23], v[112:115], v[120:123], v[20:23]
  ds_read_b128 v[68:71], v2 offset:50176
  v_mfma_f32_16x16x32_bf16 v[24:27], v[116:119], v[120:123], v[24:27]
  s_waitcnt lgkmcnt(0)
  s_barrier
  ds_read_b128 v[96:99], v3 offset:40960
  ds_read_b128 v[76:79], v2 offset:51200
  ds_read_b128 v[80:83], v2 offset:52224
  v_mfma_f32_16x16x32_bf16 v[8:11], v[28:31], v[48:51], v[8:11]
  ds_read_b128 v[84:87], v2 offset:53248
  v_mfma_f32_16x16x32_bf16 v[12:15], v[32:35], v[48:51], v[12:15]
  ds_read_b128 v[88:91], v2 offset:54272
  v_mfma_f32_16x16x32_bf16 v[16:19], v[36:39], v[48:51], v[16:19]
  ds_read_b128 v[92:95], v2 offset:55296
  v_mfma_f32_16x16x32_bf16 v[20:23], v[40:43], v[48:51], v[20:23]
  ds_read_b128 v[120:123], v3 offset:41984
  v_mfma_f32_16x16x32_bf16 v[24:27], v[44:47], v[48:51], v[24:27]
  ds_read_b128 v[100:103], v2 offset:56320
  v_mfma_f32_16x16x32_bf16 v[8:11], v[52:55], v[72:75], v[8:11]
  ds_read_b128 v[104:107], v2 offset:57344
  v_mfma_f32_16x16x32_bf16 v[12:15], v[56:59], v[72:75], v[12:15]
  ds_read_b128 v[108:111], v2 offset:58368
  v_mfma_f32_16x16x32_bf16 v[16:19], v[60:63], v[72:75], v[16:19]
  ds_read_b128 v[112:115], v2 offset:59392
  v_mfma_f32_16x16x32_bf16 v[20:23], v[64:67], v[72:75], v[20:23]
  ds_read_b128 v[116:119], v2 offset:60416
  v_mfma_f32_16x16x32_bf16 v[24:27], v[68:71], v[72:75], v[24:27]
  s_waitcnt lgkmcnt(0)
  s_barrier
  ds_read_b128 v[48:51], v3 offset:49152
  ds_read_b128 v[28:31], v2 offset:61440
  ds_read_b128 v[32:35], v2 offset:62464
  v_mfma_f32_16x16x32_bf16 v[8:11], v[76:79], v[96:99], v[8:11]
  ds_read_b128 v[36:39], v2 offset:63488
  v_mfma_f32_16x16x32_bf16 v[12:15], v[80:83], v[96:99], v[12:15]
  ds_read_b128 v[40:43], v2 offset:64512
  v_mfma_f32_16x16x32_bf16 v[16:19], v[84:87], v[96:99], v[16:19]
  ds_read_b128 v[44:47], v124 offset:0
  v_mfma_f32_16x16x32_bf16 v[20:23], v[88:91], v[96:99], v[20:23]
  ds_read_b128 v[72:75], v3 offset:50176
  v_mfma_f32_16x16x32_bf16 v[24:27], v[92:95], v[96:99], v[24:27]
  ds_read_b128 v[52:55], v124 offset:1024
  v_mfma_f32_16x16x32_bf16 v[8:11], v[100:103], v[120:123], v[8:11]
  ds_read_b128 v[56:59], v124 offset:2048
  v_mfma_f32_16x16x32_bf16 v[12:15], v[104:107], v[120:123], v[12:15]
  ds_read_b128 v[60:63], v124 offset:3072
  v_mfma_f32_16x16x32_bf16 v[16:19], v[108:111], v[120:123], v[16:19]
  ds_read_b128 v[64:67], v124 offset:4096
  v_mfma_f32_16x16x32_bf16 v[20:23], v[112:115], v[120:123], v[20:23]
  ds_read_b128 v[68:71], v124 offset:5120
  v_mfma_f32_16x16x32_bf16 v[24:27], v[116:119], v[120:123], v[24:27]
  s_waitcnt lgkmcnt(0)
  s_barrier
  ds_read_b128 v[96:99], v3 offset:57344
  ds_read_b128 v[76:79], v124 offset:6144
  ds_read_b128 v[80:83], v124 offset:7168
  v_mfma_f32_16x16x32_bf16 v[8:11], v[28:31], v[48:51], v[8:11]
  ds_read_b128 v[84:87], v124 offset:8192
  v_mfma_f32_16x16x32_bf16 v[12:15], v[32:35], v[48:51], v[12:15]
  ds_read_b128 v[88:91], v124 offset:9216
  v_mfma_f32_16x16x32_bf16 v[16:19], v[36:39], v[48:51], v[16:19]
  ds_read_b128 v[92:95], v124 offset:10240
  v_mfma_f32_16x16x32_bf16 v[20:23], v[40:43], v[48:51], v[20:23]
  ds_read_b128 v[120:123], v3 offset:58368
  v_mfma_f32_16x16x32_bf16 v[24:27], v[44:47], v[48:51], v[24:27]
  ds_read_b128 v[100:103], v124 offset:11264
  v_mfma_f32_16x16x32_bf16 v[8:11], v[52:55], v[72:75], v[8:11]
  ds_read_b128 v[104:107], v124 offset:12288
  v_mfma_f32_16x16x32_bf16 v[12:15], v[56:59], v[72:75], v[12:15]
  ds_read_b128 v[108:111], v124 offset:13312
  v_mfma_f32_16x16x32_bf16 v[16:19], v[60:63], v[72:75], v[16:19]
  ds_read_b128 v[112:115], v124 offset:14336
  v_mfma_f32_16x16x32_bf16 v[20:23], v[64:67], v[72:75], v[20:23]
  ds_read_b128 v[116:119], v124 offset:15360
  v_mfma_f32_16x16x32_bf16 v[24:27], v[68:71], v[72:75], v[24:27]
  s_waitcnt lgkmcnt(0)
  ds_read_b64 v[28:29], v5 offset:0
  ds_read_b64 v[30:31], v5 offset:512
  ds_read_b64 v[32:33], v5 offset:1024
  ds_read_b64 v[34:35], v5 offset:1536
  ds_read_b64 v[36:37], v5 offset:2048
  v_mfma_f32_16x16x32_bf16 v[8:11], v[76:79], v[96:99], v[8:11]
  v_mfma_f32_16x16x32_bf16 v[12:15], v[80:83], v[96:99], v[12:15]
  v_mfma_f32_16x16x32_bf16 v[16:19], v[84:87], v[96:99], v[16:19]
  v_mfma_f32_16x16x32_bf16 v[20:23], v[88:91], v[96:99], v[20:23]
  v_mfma_f32_16x16x32_bf16 v[24:27], v[92:95], v[96:99], v[24:27]
  v_add_u32 v6, 0, v0
  v_mul_u32_u24 v7, 205, v6
  v_lshrrev_b32 v7, 11, v7
  v_mul_u32_u24 v60, 10, v7
  v_sub_u32 v6, v6, v60
  v_mul_u32_u24 v60, 176, v7
  v_lshl_add_u32 v60, v6, 4, v60
  v_add_u32 v60, s63, v60
  v_mul_u32_u24 v64, 1280, v7
  v_lshl_add_u32 v64, v6, 4, v64
  v_add_u32 v6, 64, v0
  v_mul_u32_u24 v7, 205, v6
  v_lshrrev_b32 v7, 11, v7
  v_mul_u32_u24 v61, 10, v7
  v_sub_u32 v6, v6, v61
  v_mul_u32_u24 v61, 176, v7
  v_lshl_add_u32 v61, v6, 4, v61
  v_add_u32 v61, s63, v61
  v_mul_u32_u24 v65, 1280, v7
  v_lshl_add_u32 v65, v6, 4, v65
  v_add_u32 v6, 128, v0
  v_mul_u32_u24 v7, 205, v6
  v_lshrrev_b32 v7, 11, v7
  v_mul_u32_u24 v62, 10, v7
  v_sub_u32 v6, v6, v62
  v_mul_u32_u24 v62, 176, v7
  v_lshl_add_u32 v62, v6, 4, v62
  v_add_u32 v62, s63, v62
  v_mul_u32_u24 v66, 1280, v7
  v_lshl_add_u32 v66, v6, 4, v66
  v_mfma_f32_16x16x32_bf16 v[8:11], v[100:103], v[120:123], v[8:11]
  v_mfma_f32_16x16x32_bf16 v[12:15], v[104:107], v[120:123], v[12:15]
  v_mfma_f32_16x16x32_bf16 v[16:19], v[108:111], v[120:123], v[16:19]
  v_mfma_f32_16x16x32_bf16 v[20:23], v[112:115], v[120:123], v[20:23]
  v_mfma_f32_16x16x32_bf16 v[24:27], v[116:119], v[120:123], v[24:27]
  s_nop 7
  s_waitcnt lgkmcnt(0)
  v_cvt_pk_bf16_f32 v8, v8, v9
  v_and_b32 v53, 0xffff0000, v28
  v_and_b32 v9, 0xffff0000, v8
  v_lshlrev_b32 v8, 16, v8
  v_lshlrev_b32 v52, 16, v28
  v_add_f32 v9, v9, v53
  v_add_f32 v8, v8, v52
  v_cvt_pk_bf16_f32 v40, v8, v9
  v_cvt_pk_bf16_f32 v10, v10, v11
  v_and_b32 v55, 0xffff0000, v29
  v_and_b32 v11, 0xffff0000, v10
  v_lshlrev_b32 v10, 16, v10
  v_lshlrev_b32 v54, 16, v29
  v_add_f32 v11, v11, v55
  v_add_f32 v10, v10, v54
  v_cvt_pk_bf16_f32 v41, v10, v11
  ds_write_b64 v4, v[40:41] offset:0
  v_cvt_pk_bf16_f32 v12, v12, v13
  v_and_b32 v53, 0xffff0000, v30
  v_and_b32 v13, 0xffff0000, v12
  v_lshlrev_b32 v12, 16, v12
  v_lshlrev_b32 v52, 16, v30
  v_add_f32 v13, v13, v53
  v_add_f32 v12, v12, v52
  v_cvt_pk_bf16_f32 v42, v12, v13
  v_cvt_pk_bf16_f32 v14, v14, v15
  v_and_b32 v55, 0xffff0000, v31
  v_and_b32 v15, 0xffff0000, v14
  v_lshlrev_b32 v14, 16, v14
  v_lshlrev_b32 v54, 16, v31
  v_add_f32 v15, v15, v55
  v_add_f32 v14, v14, v54
  v_cvt_pk_bf16_f32 v43, v14, v15
  ds_write_b64 v4, v[42:43] offset:32
  v_cvt_pk_bf16_f32 v16, v16, v17
  v_and_b32 v53, 0xffff0000, v32
  v_and_b32 v17, 0xffff0000, v16
  v_lshlrev_b32 v16, 16, v16
  v_lshlrev_b32 v52, 16, v32
  v_add_f32 v17, v17, v53
  v_add_f32 v16, v16, v52
  v_cvt_pk_bf16_f32 v44, v16, v17
  v_cvt_pk_bf16_f32 v18, v18, v19
  v_and_b32 v55, 0xffff0000, v33
  v_and_b32 v19, 0xffff0000, v18
  v_lshlrev_b32 v18, 16, v18
  v_lshlrev_b32 v54, 16, v33
  v_add_f32 v19, v19, v55
  v_add_f32 v18, v18, v54
  v_cvt_pk_bf16_f32 v45, v18, v19
  ds_write_b64 v4, v[44:45] offset:64
  v_cvt_pk_bf16_f32 v20, v20, v21
  v_and_b32 v53, 0xffff0000, v34
  v_and_b32 v21, 0xffff0000, v20
  v_lshlrev_b32 v20, 16, v20
  v_lshlrev_b32 v52, 16, v34
  v_add_f32 v21, v21, v53
  v_add_f32 v20, v20, v52
  v_cvt_pk_bf16_f32 v46, v20, v21
  v_cvt_pk_bf16_f32 v22, v22, v23
  v_and_b32 v55, 0xffff0000, v35
  v_and_b32 v23, 0xffff0000, v22
  v_lshlrev_b32 v22, 16, v22
  v_lshlrev_b32 v54, 16, v35
  v_add_f32 v23, v23, v55
  v_add_f32 v22, v22, v54
  v_cvt_pk_bf16_f32 v47, v22, v23
  ds_write_b64 v4, v[46:47] offset:96
  v_cvt_pk_bf16_f32 v24, v24, v25
  v_and_b32 v53, 0xffff0000, v36
  v_and_b32 v25, 0xffff0000, v24
  v_lshlrev_b32 v24, 16, v24
  v_lshlrev_b32 v52, 16, v36
  v_add_f32 v25, v25, v53
  v_add_f32 v24, v24, v52
  v_cvt_pk_bf16_f32 v48, v24, v25
  v_cvt_pk_bf16_f32 v26, v26, v27
  v_and_b32 v55, 0xffff0000, v37
  v_and_b32 v27, 0xffff0000, v26
  v_lshlrev_b32 v26, 16, v26
  v_lshlrev_b32 v54, 16, v37
  v_add_f32 v27, v27, v55
  v_add_f32 v26, v26, v54
  v_cvt_pk_bf16_f32 v49, v26, v27
  ds_write_b64 v4, v[48:49] offset:128
  ds_read_b128 v[76:79], v60
  ds_read_b128 v[80:83], v61
  ds_read_b128 v[84:87], v62
  s_mul_i32 s96, s61, 20480
  s_add_u32 s96, s96, s62
  s_waitcnt lgkmcnt(2)
  buffer_store_dwordx4 v[76:79], v64, s[72:75], s96 offen
  s_waitcnt lgkmcnt(1)
  buffer_store_dwordx4 v[80:83], v65, s[72:75], s96 offen
  s_waitcnt lgkmcnt(0)
  s_mov_b32 exec_hi, 0
  buffer_store_dwordx4 v[84:87], v66, s[72:75], s96 offen
  s_mov_b64 exec, -1
  s_endpgm
L_k1_p2b:
  s_setprio 0
  s_sub_u32 s60, s3, 6
  v_and_b32 v4, 15, v0
  v_lshrrev_b32 v5, 4, v0
  v_lshlrev_b32 v6, 3, v4
  v_lshlrev_b32 v7, 3, v5
  s_lshl_b32 s61, s80, 2
  s_add_u32 s61, s61, s60
  s_lshl_b32 s96, s61, 7
  s_add_u32 s96, s96, 15810560
  s_mul_i32 s62, s81, 160
  buffer_load_dwordx2 v[38:39], v6, s[20:23], s96 offen sc1
  buffer_load_dwordx2 v[28:29], v7, s[76:79], s62 offen offset:0
  buffer_load_dwordx2 v[30:31], v7, s[76:79], s62 offen offset:32
  buffer_load_dwordx2 v[32:33], v7, s[76:79], s62 offen offset:64
  buffer_load_dwordx2 v[34:35], v7, s[76:79], s62 offen offset:96
  buffer_load_dwordx2 v[36:37], v7, s[76:79], s62 offen offset:128
  v_lshrrev_b32 v2, 2, v0
  v_and_b32 v3, 3, v0
  v_lshlrev_b32 v2, 7, v2
  v_lshl_add_u32 v2, v3, 3, v2
  s_lshl_b32 s96, s60, 5
  s_add_u32 s96, s96, 149504
  v_add_u32 v2, s96, v2
  v_mov_b32 v3, 163776
L_xw_46:
  ds_read_b32 v6, v3 offset:24
  s_sleep 1
  s_waitcnt lgkmcnt(0)
  v_readfirstlane_b32 s96, v6
  s_cmp_ge_u32 s96, 1
  s_cbranch_scc0 L_xw_46
  ds_read_b64_tr_b16 v[8:9], v2 offset:0
  ds_read_b64_tr_b16 v[10:11], v2 offset:2048
  ds_read_b64_tr_b16 v[12:13], v2 offset:4096
  ds_read_b64_tr_b16 v[14:15], v2 offset:6144
  ds_read_b64_tr_b16 v[16:17], v2 offset:8192
  s_waitcnt vmcnt(0)
  v_rcp_f32 v39, v39
  s_waitcnt lgkmcnt(0)
  v_and_b32 v41, 0xffff0000, v8
  v_lshlrev_b32 v40, 16, v8
  v_and_b32 v43, 0xffff0000, v9
  v_lshlrev_b32 v42, 16, v9
  v_and_b32 v45, 0xffff0000, v28
  v_lshlrev_b32 v44, 16, v28
  v_and_b32 v47, 0xffff0000, v29
  v_lshlrev_b32 v46, 16, v29
  v_sub_f32 v40, v40, v38
  v_sub_f32 v41, v41, v38
  v_sub_f32 v42, v42, v38
  v_sub_f32 v43, v43, v38
  v_cvt_pk_bf16_f32 v40, v40, v41
  v_cvt_pk_bf16_f32 v42, v42, v43
  v_and_b32 v41, 0xffff0000, v40
  v_lshlrev_b32 v40, 16, v40
  v_and_b32 v43, 0xffff0000, v42
  v_lshlrev_b32 v42, 16, v42
  v_mul_f32 v40, v40, v39
  v_mul_f32 v41, v41, v39
  v_mul_f32 v42, v42, v39
  v_mul_f32 v43, v43, v39
  v_cvt_pk_bf16_f32 v40, v40, v41
  v_cvt_pk_bf16_f32 v42, v42, v43
  v_and_b32 v41, 0xffff0000, v40
  v_lshlrev_b32 v40, 16, v40
  v_and_b32 v43, 0xffff0000, v42
  v_lshlrev_b32 v42, 16, v42
  v_mul_f32 v40, v40, v44
  v_mul_f32 v41, v41, v45
  v_mul_f32 v42, v42, v46
  v_mul_f32 v43, v43, v47
  v_cvt_pk_bf16_f32 v18, v40, v41
  v_cvt_pk_bf16_f32 v19, v42, v43
  v_and_b32 v41, 0xffff0000, v10
  v_lshlrev_b32 v40, 16, v10
  v_and_b32 v43, 0xffff0000, v11
  v_lshlrev_b32 v42, 16, v11
  v_and_b32 v45, 0xffff0000, v30
  v_lshlrev_b32 v44, 16, v30
  v_and_b32 v47, 0xffff0000, v31
  v_lshlrev_b32 v46, 16, v31
  v_sub_f32 v40, v40, v38
  v_sub_f32 v41, v41, v38
  v_sub_f32 v42, v42, v38
  v_sub_f32 v43, v43, v38
  v_cvt_pk_bf16_f32 v40, v40, v41
  v_cvt_pk_bf16_f32 v42, v42, v43
  v_and_b32 v41, 0xffff0000, v40
  v_lshlrev_b32 v40, 16, v40
  v_and_b32 v43, 0xffff0000, v42
  v_lshlrev_b32 v42, 16, v42
  v_mul_f32 v40, v40, v39
  v_mul_f32 v41, v41, v39
  v_mul_f32 v42, v42, v39
  v_mul_f32 v43, v43, v39
  v_cvt_pk_bf16_f32 v40, v40, v41
  v_cvt_pk_bf16_f32 v42, v42, v43
  v_and_b32 v41, 0xffff0000, v40
  v_lshlrev_b32 v40, 16, v40
  v_and_b32 v43, 0xffff0000, v42
  v_lshlrev_b32 v42, 16, v42
  v_mul_f32 v40, v40, v44
  v_mul_f32 v41, v41, v45
  v_mul_f32 v42, v42, v46
  v_mul_f32 v43, v43, v47
  v_cvt_pk_bf16_f32 v20, v40, v41
  v_cvt_pk_bf16_f32 v21, v42, v43
  v_and_b32 v41, 0xffff0000, v12
  v_lshlrev_b32 v40, 16, v12
  v_and_b32 v43, 0xffff0000, v13
  v_lshlrev_b32 v42, 16, v13
  v_and_b32 v45, 0xffff0000, v32
  v_lshlrev_b32 v44, 16, v32
  v_and_b32 v47, 0xffff0000, v33
  v_lshlrev_b32 v46, 16, v33
  v_sub_f32 v40, v40, v38
  v_sub_f32 v41, v41, v38
  v_sub_f32 v42, v42, v38
  v_sub_f32 v43, v43, v38
  v_cvt_pk_bf16_f32 v40, v40, v41
  v_cvt_pk_bf16_f32 v42, v42, v43
  v_and_b32 v41, 0xffff0000, v40
  v_lshlrev_b32 v40, 16, v40
  v_and_b32 v43, 0xffff0000, v42
  v_lshlrev_b32 v42, 16, v42
  v_mul_f32 v40, v40, v39
  v_mul_f32 v41, v41, v39
  v_mul_f32 v42, v42, v39
  v_mul_f32 v43, v43, v39
  v_cvt_pk_bf16_f32 v40, v40, v41
  v_cvt_pk_bf16_f32 v42, v42, v43
  v_and_b32 v41, 0xffff0000, v40
  v_lshlrev_b32 v40, 16, v40
  v_and_b32 v43, 0xffff0000, v42
  v_lshlrev_b32 v42, 16, v42
  v_mul_f32 v40, v40, v44
  v_mul_f32 v41, v41, v45
  v_mul_f32 v42, v42, v46
  v_mul_f32 v43, v43, v47
  v_cvt_pk_bf16_f32 v22, v40, v41
  v_cvt_pk_bf16_f32 v23, v42, v43
  v_and_b32 v41, 0xffff0000, v14
  v_lshlrev_b32 v40, 16, v14
  v_and_b32 v43, 0xffff0000, v15
  v_lshlrev_b32 v42, 16, v15
  v_and_b32 v45, 0xffff0000, v34
  v_lshlrev_b32 v44, 16, v34
  v_and_b32 v47, 0xffff0000, v35
  v_lshlrev_b32 v46, 16, v35
  v_sub_f32 v40, v40, v38
  v_sub_f32 v41, v41, v38
  v_sub_f32 v42, v42, v38
  v_sub_f32 v43, v43, v38
  v_cvt_pk_bf16_f32 v40, v40, v41
  v_cvt_pk_bf16_f32 v42, v42, v43
  v_and_b32 v41, 0xffff0000, v40
  v_lshlrev_b32 v40, 16, v40
  v_and_b32 v43, 0xffff0000, v42
  v_lshlrev_b32 v42, 16, v42
  v_mul_f32 v40, v40, v39
  v_mul_f32 v41, v41, v39
  v_mul_f32 v42, v42, v39
  v_mul_f32 v43, v43, v39
  v_cvt_pk_bf16_f32 v40, v40, v41
  v_cvt_pk_bf16_f32 v42, v42, v43
  v_and_b32 v41, 0xffff0000, v40
  v_lshlrev_b32 v40, 16, v40
  v_and_b32 v43, 0xffff0000, v42
  v_lshlrev_b32 v42, 16, v42
  v_mul_f32 v40, v40, v44
  v_mul_f32 v41, v41, v45
  v_mul_f32 v42, v42, v46
  v_mul_f32 v43, v43, v47
  v_cvt_pk_bf16_f32 v24, v40, v41
  v_cvt_pk_bf16_f32 v25, v42, v43
  v_and_b32 v41, 0xffff0000, v16
  v_lshlrev_b32 v40, 16, v16
  v_and_b32 v43, 0xffff0000, v17
  v_lshlrev_b32 v42, 16, v17
  v_and_b32 v45, 0xffff0000, v36
  v_lshlrev_b32 v44, 16, v36
  v_and_b32 v47, 0xffff0000, v37
  v_lshlrev_b32 v46, 16, v37
  v_sub_f32 v40, v40, v38
  v_sub_f32 v41, v41, v38
  v_sub_f32 v42, v42, v38
  v_sub_f32 v43, v43, v38
  v_cvt_pk_bf16_f32 v40, v40, v41
  v_cvt_pk_bf16_f32 v42, v42, v43
  v_and_b32 v41, 0xffff0000, v40
  v_lshlrev_b32 v40, 16, v40
  v_and_b32 v43, 0xffff0000, v42
  v_lshlrev_b32 v42, 16, v42
  v_mul_f32 v40, v40, v39
  v_mul_f32 v41, v41, v39
  v_mul_f32 v42, v42, v39
  v_mul_f32 v43, v43, v39
  v_cvt_pk_bf16_f32 v40, v40, v41
  v_cvt_pk_bf16_f32 v42, v42, v43
  v_and_b32 v41, 0xffff0000, v40
  v_lshlrev_b32 v40, 16, v40
  v_and_b32 v43, 0xffff0000, v42
  v_lshlrev_b32 v42, 16, v42
  v_mul_f32 v40, v40, v44
  v_mul_f32 v41, v41, v45
  v_mul_f32 v42, v42, v46
  v_mul_f32 v43, v43, v47
  v_cvt_pk_bf16_f32 v26, v40, v41
  v_cvt_pk_bf16_f32 v27, v42, v43
  v_lshlrev_b32 v48, 4, v0
  v_lshrrev_b32 v49, 3, v0
  v_and_b32 v50, 7, v0
  v_lshlrev_b32 v49, 12, v49
  v_lshl_add_u32 v49, v50, 4, v49
  s_mul_i32 s63, s81, 327680
  s_lshl_b32 s96, s80, 7
  s_add_u32 s63, s63, s96
  s_lshl_b32 s96, s60, 15
  s_add_u32 s63, s63, s96
  s_add_u32 s63, s63, 10878976
  s_lshl_b32 s59, s60, 10
  s_add_u32 s59, s59, 149504
  s_mov_b32 s61, 15890432
  s_barrier
  s_barrier
  s_barrier
  s_barrier
  s_barrier
  s_barrier
  s_barrier
  s_barrier
  s_barrier
  s_barrier
  s_cmp_lg_u32 s60, 0
  s_cbranch_scc1 L_nyp_47
  buffer_load_dwordx4 v[52:55], v48, s[20:23], s61 offen sc1
L_nyp_47:
  s_barrier
  s_barrier
  s_barrier
  s_cmp_lg_u32 s60, 0
  s_cbranch_scc1 L_nyp_48
  s_waitcnt vmcnt(0)
  s_mov_b32 s62, 0
L_yc_49:
  v_and_b32 v52, v52, v53
  v_and_b32 v54, v54, v55
  v_and_b32 v52, v52, v54
  v_cmp_eq_u32 vcc, 1, v52
  s_and_b32 s96, vcc_lo, vcc_hi
  s_cmp_eq_u32 s96, -1
  s_cbranch_scc1 L_nyp_48
  s_sleep 16
  buffer_load_dwordx4 v[52:55], v48, s[20:23], s61 offen sc1
  s_add_u32 s62, s62, 1
  s_waitcnt vmcnt(0)
  s_cmp_lt_u32 s62, 200000
  s_cbranch_scc1 L_yc_49
L_nyp_48:
  s_barrier
  s_add_u32 m0, s59, 0
  s_add_u32 s97, s63, 0
  buffer_load_dwordx4 v49, s[20:23], s97 offen sc1 lds
  s_add_u32 m0, s59, 4096
  s_add_u32 s97, s63, 131072
  buffer_load_dwordx4 v49, s[20:23], s97 offen sc1 lds
  s_cmp_ge_u32 s60, 2
  s_cbranch_scc1 L_ny3_50
  s_add_u32 m0, s59, 8192
  s_add_u32 s97, s63, 262144
  buffer_load_dwordx4 v49, s[20:23], s97 offen sc1 lds
L_ny3_50:
  s_barrier
  s_barrier
  s_barrier
  s_waitcnt vmcnt(0)
  s_barrier
  ds_read_b64_tr_b16 v[28:29], v2 offset:0
  ds_read_b64_tr_b16 v[30:31], v2 offset:2048
  ds_read_b64_tr_b16 v[32:33], v2 offset:4096
  ds_read_b64_tr_b16 v[34:35], v2 offset:6144
  ds_read_b64_tr_b16 v[36:37], v2 offset:8192
  s_barrier
  s_mul_i32 s96, s60, 2560
  s_add_u32 s96, s96, 0
  v_lshlrev_b32 v3, 3, v0
  v_add_u32 v3, s96, v3
  s_waitcnt lgkmcnt(0)
  v_and_b32 v41, 0xffff0000, v28
  v_lshlrev_b32 v40, 16, v28
  v_and_b32 v45, 0xffff0000, v18
  v_lshlrev_b32 v44, 16, v18
  v_and_b32 v43, 0xffff0000, v29
  v_lshlrev_b32 v42, 16, v29
  v_and_b32 v47, 0xffff0000, v19
  v_lshlrev_b32 v46, 16, v19
  v_add_f32 v40, v40, v44
  v_add_f32 v41, v41, v45
  v_add_f32 v42, v42, v46
  v_add_f32 v43, v43, v47
  v_cvt_pk_bf16_f32 v40, v40, v41
  v_and_b32 v45, 0xffff0000, v8
  v_lshlrev_b32 v44, 16, v8
  v_cvt_pk_bf16_f32 v42, v42, v43
  v_and_b32 v47, 0xffff0000, v9
  v_lshlrev_b32 v46, 16, v9
  v_and_b32 v41, 0xffff0000, v40
  v_lshlrev_b32 v40, 16, v40
  v_and_b32 v43, 0xffff0000, v42
  v_lshlrev_b32 v42, 16, v42
  v_add_f32 v40, v40, v44
  v_add_f32 v41, v41, v45
  s_barrier
  v_add_f32 v42, v42, v46
  v_add_f32 v43, v43, v47
  v_cvt_pk_bf16_f32 v8, v40, v41
  v_cvt_pk_bf16_f32 v9, v42, v43
  v_and_b32 v41, 0xffff0000, v30
  v_lshlrev_b32 v40, 16, v30
  v_and_b32 v45, 0xffff0000, v20
  v_lshlrev_b32 v44, 16, v20
  v_and_b32 v43, 0xffff0000, v31
  v_lshlrev_b32 v42, 16, v31
  v_and_b32 v47, 0xffff0000, v21
  v_lshlrev_b32 v46, 16, v21
  v_add_f32 v40, v40, v44
  v_add_f32 v41, v41, v45
  v_add_f32 v42, v42, v46
  v_add_f32 v43, v43, v47
  v_cvt_pk_bf16_f32 v40, v40, v41
  v_and_b32 v45, 0xffff0000, v10
  v_lshlrev_b32 v44, 16, v10
  v_cvt_pk_bf16_f32 v42, v42, v43
  v_and_b32 v47, 0xffff0000, v11
  v_lshlrev_b32 v46, 16, v11
  v_and_b32 v41, 0xffff0000, v40
  v_lshlrev_b32 v40, 16, v40
  v_and_b32 v43, 0xffff0000, v42
  v_lshlrev_b32 v42, 16, v42
  v_add_f32 v40, v40, v44
  v_add_f32 v41, v41, v45
  v_add_f32 v42, v42, v46
  s_barrier
  v_add_f32 v43, v43, v47
  v_cvt_pk_bf16_f32 v10, v40, v41
  v_cvt_pk_bf16_f32 v11, v42, v43
  v_and_b32 v41, 0xffff0000, v32
  v_lshlrev_b32 v40, 16, v32
  v_and_b32 v45, 0xffff0000, v22
  v_lshlrev_b32 v44, 16, v22
  v_and_b32 v43, 0xffff0000, v33
  v_lshlrev_b32 v42, 16, v33
  v_and_b32 v47, 0xffff0000, v23
  v_lshlrev_b32 v46, 16, v23
  v_add_f32 v40, v40, v44
  v_add_f32 v41, v41, v45
  v_add_f32 v42, v42, v46
  v_add_f32 v43, v43, v47
  v_cvt_pk_bf16_f32 v40, v40, v41
  v_and_b32 v45, 0xffff0000, v12
  v_lshlrev_b32 v44, 16, v12
  v_cvt_pk_bf16_f32 v42, v42, v43
  v_and_b32 v47, 0xffff0000, v13
  v_lshlrev_b32 v46, 16, v13
  v_and_b32 v41, 0xffff0000, v40
  v_lshlrev_b32 v40, 16, v40
  v_and_b32 v43, 0xffff0000, v42
  v_lshlrev_b32 v42, 16, v42
  v_add_f32 v40, v40, v44
  v_add_f32 v41, v41, v45
  v_add_f32 v42, v42, v46
  v_add_f32 v43, v43, v47
  s_barrier
  v_cvt_pk_bf16_f32 v12, v40, v41
  v_cvt_pk_bf16_f32 v13, v42, v43
  v_and_b32 v41, 0xffff0000, v34
  v_lshlrev_b32 v40, 16, v34
  v_and_b32 v45, 0xffff0000, v24
  v_lshlrev_b32 v44, 16, v24
  v_and_b32 v43, 0xffff0000, v35
  v_lshlrev_b32 v42, 16, v35
  v_and_b32 v47, 0xffff0000, v25
  v_lshlrev_b32 v46, 16, v25
  v_add_f32 v40, v40, v44
  v_add_f32 v41, v41, v45
  v_add_f32 v42, v42, v46
  v_add_f32 v43, v43, v47
  v_cvt_pk_bf16_f32 v40, v40, v41
  v_and_b32 v45, 0xffff0000, v14
  v_lshlrev_b32 v44, 16, v14
  v_cvt_pk_bf16_f32 v42, v42, v43
  v_and_b32 v47, 0xffff0000, v15
  v_lshlrev_b32 v46, 16, v15
  v_and_b32 v41, 0xffff0000, v40
  v_lshlrev_b32 v40, 16, v40
  v_and_b32 v43, 0xffff0000, v42
  v_lshlrev_b32 v42, 16, v42
  v_add_f32 v40, v40, v44
  v_add_f32 v41, v41, v45
  v_add_f32 v42, v42, v46
  v_add_f32 v43, v43, v47
  v_cvt_pk_bf16_f32 v14, v40, v41
  s_barrier
  v_cvt_pk_bf16_f32 v15, v42, v43
  v_and_b32 v41, 0xffff0000, v36
  v_lshlrev_b32 v40, 16, v36
  v_and_b32 v45, 0xffff0000, v26
  v_lshlrev_b32 v44, 16, v26
  v_and_b32 v43, 0xffff0000, v37
  v_lshlrev_b32 v42, 16, v37
  v_and_b32 v47, 0xffff0000, v27
  v_lshlrev_b32 v46, 16, v27
  v_add_f32 v40, v40, v44
  v_add_f32 v41, v41, v45
  v_add_f32 v42, v42, v46
  v_add_f32 v43, v43, v47
  v_cvt_pk_bf16_f32 v40, v40, v41
  v_and_b32 v45, 0xffff0000, v16
  v_lshlrev_b32 v44, 16, v16
  v_cvt_pk_bf16_f32 v42, v42, v43
  v_and_b32 v47, 0xffff0000, v17
  v_lshlrev_b32 v46, 16, v17
  v_and_b32 v41, 0xffff0000, v40
  v_lshlrev_b32 v40, 16, v40
  v_and_b32 v43, 0xffff0000, v42
  v_lshlrev_b32 v42, 16, v42
  v_add_f32 v40, v40, v44
  v_add_f32 v41, v41, v45
  v_add_f32 v42, v42, v46
  v_add_f32 v43, v43, v47
  v_cvt_pk_bf16_f32 v16, v40, v41
  v_cvt_pk_bf16_f32 v17, v42, v43
  s_barrier
  ds_write_b64 v3, v[8:9] offset:0
  ds_write_b64 v3, v[10:11] offset:512
  ds_write_b64 v3, v[12:13] offset:1024
  ds_write_b64 v3, v[14:15] offset:1536
  ds_write_b64 v3, v[16:17] offset:2048
  s_waitcnt lgkmcnt(0)
  s_barrier
  s_endpgm
L_k1_x0:
  s_waitcnt lgkmcnt(0)
  s_barrier
L_k1_x:
  s_setprio 0
  s_waitcnt lgkmcnt(0)
  s_barrier
L_k1_x1:
  s_setprio 0
  s_barrier
  s_waitcnt vmcnt(0)
  s_barrier
  s_cmp_lg_u32 s3, 15
  s_cbranch_scc1 L_k1_x2
  s_and_b32 s96, s2, 63
  s_lshl_b32 s96, s96, 2
  v_mov_b32 v5, s96
  v_mov_b32 v6, 1
  s_mov_b64 exec, 1
  buffer_atomic_add v6, v5, s[24:27], 0 offen sc1
  s_endpgm
L_k1_x2:
  s_sub_u32 s68, s3, 11
  s_min_u32 s68, s68, 4
  s_cmp_ge_u32 s68, 3
  s_cselect_b32 s59, 1, 0
  s_cselect_b32 s96, 3, 0
  s_mov_b32 s70, s59
  s_sub_u32 s68, s68, s96
  s_and_b32 s97, s69, 1
  s_mul_i32 s61, s68, 19600
  s_add_u32 s61, s61, 86016
  s_cmp_eq_u32 s68, 2
  s_cselect_b32 s59, s97, s59
  s_cselect_b32 s61, 66416, s61
  s_mul_i32 s60, s68, 3328
  s_add_u32 s60, s60, 131584
  s_mov_b32 s62, 141568
  s_lshl_b32 s58, s69, 1
  s_add_u32 s58, s58, s68
  s_lshr_b32 s96, s69, 1
  s_add_u32 s96, s96, 512
  s_cmp_eq_u32 s68, 2
  s_cselect_b32 s58, s96, s58
  v_and_b32 v96, 15, v0
  v_lshrrev_b32 v97, 4, v0
  v_and_b32 v98, 1, v97
  v_lshrrev_b32 v99, 1, v97
  v_bfe_u32 v100, v0, 2, 2
  v_and_b32 v101, 3, v0
  v_sub_u32 v102, v96, v99
  v_lshlrev_b32 v102, 5, v102
  v_lshl_add_u32 v102, v98, 4, v102
  s_add_u32 s96, s61, 128
  v_add_u32 v116, s96, v102
  v_lshlrev_b32 v102, 3, v98
  v_sub_u32 v102, v102, v96
  v_lshlrev_b32 v103, 4, v99
  v_sub_u32 v102, v102, v103
  v_add_u32 v102, 32, v102
  v_lshlrev_b32 v102, 1, v102
  v_and_b32 v104, 1, v96
  v_mul_u32_u24 v103, 638, v104
  v_add3_u32 v117, v102, v103, s60
  v_lshl_add_u32 v102, v99, 3, v100
  v_mul_u32_u24 v102, 8, v102
  v_lshlrev_b32 v103, 3, v101
  v_sub_u32 v102, v103, v102
  v_mul_i32_i24 v103, -3648, v98
  s_barrier
  v_add3_u32 v102, v102, v103, s61
  v_add_u32 v118, 8440, v102
  v_mul_u32_u24 v102, 8, v96
  v_lshl_add_u32 v102, v99, 4, v102
  v_mul_u32_u24 v103, 384, v98
  v_add3_u32 v102, v102, v103, s60
  v_add_u32 v121, 1280, v102
  v_lshl_add_u32 v102, v99, 3, v100
  v_mul_u32_u24 v102, 16, v102
  v_lshlrev_b32 v103, 3, v101
  v_sub_u32 v102, v103, v102
  v_mul_i32_i24 v103, -3704, v98
  v_add3_u32 v102, v102, v103, s61
  v_add_u32 v119, 11600, v102
  v_mul_u32_u24 v102, 4, v96
  v_lshl_add_u32 v102, v99, 4, v102
  v_mul_u32_u24 v103, 256, v98
  v_add3_u32 v102, v102, v103, s60
  v_add_u32 v122, 2048, v102
  v_lshl_add_u32 v102, v99, 3, v100
  v_mul_u32_u24 v102, 32, v102
  v_lshlrev_b32 v103, 3, v101
  v_sub_u32 v102, v103, v102
  v_mul_i32_i24 v103, -2176, v98
  v_add3_u32 v102, v102, v103, s61
  v_add_u32 v120, 15824, v102
  s_barrier
  v_mul_u32_u24 v102, 2, v96
  v_lshl_add_u32 v102, v99, 4, v102
  v_mul_u32_u24 v103, 320, v98
  v_add3_u32 v102, v102, v103, s60
  v_add_u32 v123, 2560, v102
  v_mul_u32_u24 v103, 158, v104
  v_add_u32 v123, v123, v103
  v_lshlrev_b32 v102, 4, v99
  v_lshlrev_b32 v103, 3, v98
  v_sub_u32 v102, v102, v103
  v_add3_u32 v102, v102, v96, -6
  v_mov_b32 v105, 0xffff
  v_mov_b32 v101, 0xffff0000
  v_subrev_u32 v103, 0, v102
  v_subrev_u32 v104, 1, v102
  v_cmp_gt_u32 vcc, 7, v103
  v_cmp_gt_u32 s[96:97], 7, v104
  s_nop 1
  v_cndmask_b32 v103, 0, v105, vcc
  v_cndmask_b32 v104, 0, v101, s[96:97]
  v_or_b32 v112, v103, v104
  v_subrev_u32 v103, 2, v102
  v_subrev_u32 v104, 3, v102
  v_cmp_gt_u32 vcc, 7, v103
  v_cmp_gt_u32 s[96:97], 7, v104
  s_barrier
  s_nop 1
  v_cndmask_b32 v103, 0, v105, vcc
  v_cndmask_b32 v104, 0, v101, s[96:97]
  v_or_b32 v113, v103, v104
  v_subrev_u32 v103, 4, v102
  v_subrev_u32 v104, 5, v102
  v_cmp_gt_u32 vcc, 7, v103
  v_cmp_gt_u32 s[96:97], 7, v104
  s_nop 1
  v_cndmask_b32 v103, 0, v105, vcc
  v_cndmask_b32 v104, 0, v101, s[96:97]
  v_or_b32 v114, v103, v104
  v_subrev_u32 v103, 6, v102
  v_subrev_u32 v104, 7, v102
  v_cmp_gt_u32 vcc, 7, v103
  v_cmp_gt_u32 s[96:97], 7, v104
  s_nop 1
  v_cndmask_b32 v103, 0, v105, vcc
  v_cndmask_b32 v104, 0, v101, s[96:97]
  v_or_b32 v115, v103, v104
  v_lshlrev_b32 v126, 5, v96
  v_lshl_add_u32 v126, v97, 3, v126
  s_add_u32 s96, s60, 3200
  v_mov_b32 v124, s96
  s_lshl_b32 s93, s58, 12
  s_add_u32 s93, s93, 10878976
  s_barrier
  s_barrier
  s_lshl_b32 s96, s68, 2
  s_add_u32 s96, s96, 163776
  v_mov_b32 v3, s96
  v_mov_b32 v4, 1
  s_cmp_lg_u32 s70, 0
  s_cbranch_scc1 L_noprep_2051
  v_lshlrev_b32 v2, 4, v0
  s_lshl_b32 s96, s58, 12
  s_add_u32 s96, s96, 8257536
  buffer_load_dwordx4 v[8:11], v2, s[20:23], s96 offen offset:0 sc1
  buffer_load_dwordx4 v[12:15], v2, s[20:23], s96 offen offset:1024 sc1
  buffer_load_dwordx4 v[16:19], v2, s[20:23], s96 offen offset:2048 sc1
  buffer_load_dwordx4 v[20:23], v2, s[20:23], s96 offen offset:3072 sc1
  s_and_b32 s96, s69, 1
  s_lshl_b32 s96, s96, 1
  s_and_b32 s96, s96, s68
  s_cmp_eq_u32 s96, 0
  s_cbranch_scc1 L_notab_2052
  s_mov_b32 m0, s60
  s_mul_i32 s96, s58, 3584
  s_add_u32 s96, s96, 13500416
  buffer_load_dwordx4 v2, s[20:23], s96 offen offset:0 sc1 lds
  buffer_load_dwordx4 v2, s[20:23], s96 offen offset:1024 sc1 lds
  buffer_load_dwordx4 v2, s[20:23], s96 offen offset:2048 sc1 lds
  s_mov_b64 exec, 0xffff
  buffer_load_dwordx4 v2, s[20:23], s96 offen offset:3072 sc1 lds
  s_mov_b64 exec, -1
L_notab_2052:
  s_barrier
  s_barrier
  s_setprio 3
  v_mov_b32 v5, 163776
L_pl_2053:
  ds_read_b32 v7, v5 offset:12
  s_sleep 1
  s_waitcnt vmcnt(0) lgkmcnt(0)
  v_readfirstlane_b32 s96, v7
  s_cmp_ge_u32 s96, 1
  s_cbranch_scc0 L_pl_2053
  v_lshlrev_b32 v2, 4, v0
  v_add_u32 v6, s62, v2
  ds_read_b128 v[50:53], v6 offset:0
  ds_read_b128 v[54:57], v6 offset:4096
  ds_read_b128 v[58:61], v6 offset:8192
  ds_read_b128 v[62:65], v6 offset:12288
  ds_read_b128 v[66:69], v6 offset:1024
  ds_read_b128 v[70:73], v6 offset:5120
  ds_read_b128 v[74:77], v6 offset:9216
  ds_read_b128 v[78:81], v6 offset:13312
  v_lshlrev_b32 v94, 16, v8
  v_and_b32 v95, 0xffff0000, v8
  v_lshlrev_b32 v96, 16, v9
  v_and_b32 v97, 0xffff0000, v9
  v_lshlrev_b32 v98, 16, v10
  v_and_b32 v99, 0xffff0000, v10
  v_lshlrev_b32 v100, 16, v11
  v_and_b32 v101, 0xffff0000, v11
  s_waitcnt lgkmcnt(4)
  v_fma_f32 v94, v94, v50, v51
  v_fma_f32 v95, v95, v52, v53
  v_fma_f32 v96, v96, v54, v55
  v_fma_f32 v97, v97, v56, v57
  v_fma_f32 v98, v98, v58, v59
  v_fma_f32 v99, v99, v60, v61
  v_fma_f32 v100, v100, v62, v63
  v_fma_f32 v101, v101, v64, v65
  v_cvt_pk_f16_f32 v8, v94, v95
  v_cvt_pk_f16_f32 v9, v96, v97
  v_cvt_pk_f16_f32 v10, v98, v99
  v_cvt_pk_f16_f32 v11, v100, v101
  ds_read_b128 v[50:53], v6 offset:2048
  ds_read_b128 v[54:57], v6 offset:6144
  ds_read_b128 v[58:61], v6 offset:10240
  ds_read_b128 v[62:65], v6 offset:14336
  v_lshlrev_b32 v94, 16, v12
  v_and_b32 v95, 0xffff0000, v12
  v_lshlrev_b32 v96, 16, v13
  v_and_b32 v97, 0xffff0000, v13
  v_lshlrev_b32 v98, 16, v14
  v_and_b32 v99, 0xffff0000, v14
  v_lshlrev_b32 v100, 16, v15
  v_and_b32 v101, 0xffff0000, v15
  s_waitcnt lgkmcnt(4)
  v_fma_f32 v94, v94, v66, v67
  v_fma_f32 v95, v95, v68, v69
  v_fma_f32 v96, v96, v70, v71
  v_fma_f32 v97, v97, v72, v73
  v_fma_f32 v98, v98, v74, v75
  v_fma_f32 v99, v99, v76, v77
  v_fma_f32 v100, v100, v78, v79
  v_fma_f32 v101, v101, v80, v81
  v_cvt_pk_f16_f32 v12, v94, v95
  v_cvt_pk_f16_f32 v13, v96, v97
  v_cvt_pk_f16_f32 v14, v98, v99
  v_cvt_pk_f16_f32 v15, v100, v101
  ds_read_b128 v[66:69], v6 offset:3072
  ds_read_b128 v[70:73], v6 offset:7168
  ds_read_b128 v[74:77], v6 offset:11264
  ds_read_b128 v[78:81], v6 offset:15360
  v_lshlrev_b32 v94, 16, v16
  v_and_b32 v95, 0xffff0000, v16
  v_lshlrev_b32 v96, 16, v17
  v_and_b32 v97, 0xffff0000, v17
  v_lshlrev_b32 v98, 16, v18
  v_and_b32 v99, 0xffff0000, v18
  v_lshlrev_b32 v100, 16, v19
  v_and_b32 v101, 0xffff0000, v19
  s_waitcnt lgkmcnt(4)
  v_fma_f32 v94, v94, v50, v51
  v_fma_f32 v95, v95, v52, v53
  v_fma_f32 v96, v96, v54, v55
  v_fma_f32 v97, v97, v56, v57
  v_fma_f32 v98, v98, v58, v59
  v_fma_f32 v99, v99, v60, v61
  v_fma_f32 v100, v100, v62, v63
  v_fma_f32 v101, v101, v64, v65
  v_cvt_pk_f16_f32 v16, v94, v95
  v_cvt_pk_f16_f32 v17, v96, v97
  v_cvt_pk_f16_f32 v18, v98, v99
  v_cvt_pk_f16_f32 v19, v100, v101
  v_lshlrev_b32 v94, 16, v20
  v_and_b32 v95, 0xffff0000, v20
  v_lshlrev_b32 v96, 16, v21
  v_and_b32 v97, 0xffff0000, v21
  v_lshlrev_b32 v98, 16, v22
  v_and_b32 v99, 0xffff0000, v22
  v_lshlrev_b32 v100, 16, v23
  v_and_b32 v101, 0xffff0000, v23
  s_waitcnt lgkmcnt(0)
  v_fma_f32 v94, v94, v66, v67
  v_fma_f32 v95, v95, v68, v69
  v_fma_f32 v96, v96, v70, v71
  v_fma_f32 v97, v97, v72, v73
  v_fma_f32 v98, v98, v74, v75
  v_fma_f32 v99, v99, v76, v77
  v_fma_f32 v100, v100, v78, v79
  v_fma_f32 v101, v101, v80, v81
  v_cvt_pk_f16_f32 v20, v94, v95
  v_cvt_pk_f16_f32 v21, v96, v97
  v_mov_b32 v5, 163776
  s_cmp_ge_u32 s56, 30
  s_cselect_b32 s97, 0, 8
L_g28_2054:
  ds_read_b32 v7, v5 offset:28
  s_sleep 1
  s_waitcnt lgkmcnt(0)
  v_readfirstlane_b32 s96, v7
  s_cmp_ge_u32 s96, s97
  s_cbranch_scc0 L_g28_2054
  v_add_u32 v5, s61, v2
  v_mov_b64 v[104:105], 0
  v_mov_b64 v[106:107], 0
  s_mov_b32 exec_hi, 0xff
  ds_write_b128 v5, v[104:107]
  s_mov_b64 exec, 7
  ds_write_b128 v5, v[104:107] offset:4800
  ds_write_b128 v5, v[104:107] offset:8448
  ds_write_b128 v5, v[104:107] offset:12160
  ds_write_b128 v5, v[104:107] offset:15296
  ds_write_b128 v5, v[104:107] offset:17488
  s_mov_b64 exec, -1
  v_cvt_pk_f16_f32 v22, v98, v99
  v_cvt_pk_f16_f32 v23, v100, v101
  ds_write_b128 v5, v[8:11] offset:640
  v_mov_b32 v27, 0
  ds_write_b128 v5, v[12:15] offset:1664
  v_mov_b32 v28, 0
  ds_write_b128 v5, v[16:19] offset:2688
  v_mov_b32 v29, 0
  ds_write_b128 v5, v[20:23] offset:3712
  v_mov_b32 v30, 0
  v_mov_b32 v25, 0
  v_mov_b32 v26, 0
  v_mov_b32_dpp v29, v10 wave_shr:1 row_mask:0xf bank_mask:0xf
  v_mov_b32_dpp v30, v11 wave_shr:1 row_mask:0xf bank_mask:0xf
  v_mov_b32_dpp v27, v8 wave_shr:1 row_mask:0xf bank_mask:0xf
  v_mov_b32_dpp v28, v9 wave_shr:1 row_mask:0xf bank_mask:0xf
  v_mov_b32_dpp v25, v29 wave_shr:1 row_mask:0xf bank_mask:0xf
  v_mov_b32_dpp v26, v30 wave_shr:1 row_mask:0xf bank_mask:0xf
  v_alignbit_b32 v94, v26, v25, 16
  v_alignbit_b32 v95, v27, v26, 16
  v_alignbit_b32 v96, v28, v27, 16
  v_alignbit_b32 v97, v29, v28, 16
  v_alignbit_b32 v98, v30, v29, 16
  v_alignbit_b32 v99, v8, v30, 16
  v_alignbit_b32 v100, v9, v8, 16
  ds_write_b128 v5, v[26:29] offset:4848
  v_pk_add_f16 v50, v95, v96
  v_pk_add_f16 v51, v96, v97
  v_pk_add_f16 v52, v97, v98
  v_pk_add_f16 v53, v98, v99
  v_pk_add_f16 v50, v50, v27
  v_pk_add_f16 v51, v51, v28
  v_pk_add_f16 v52, v52, v29
  v_pk_add_f16 v53, v53, v30
  ds_write_b128 v5, v[50:53] offset:8496
  v_pk_add_f16 v66, v26, v28
  v_pk_add_f16 v67, v27, v29
  v_pk_add_f16 v68, v28, v30
  v_pk_add_f16 v69, v29, v8
  v_pk_add_f16 v66, v66, v50
  v_pk_add_f16 v67, v67, v51
  v_pk_add_f16 v68, v68, v52
  v_pk_add_f16 v69, v69, v53
  ds_write_b128 v5, v[66:69] offset:12208
  v_pk_add_f16 v78, v94, v97
  v_pk_add_f16 v79, v95, v98
  v_pk_add_f16 v80, v96, v99
  v_pk_add_f16 v81, v97, v100
  v_pk_add_f16 v78, v78, v66
  v_pk_add_f16 v79, v79, v67
  v_pk_add_f16 v80, v80, v68
  v_pk_add_f16 v81, v81, v69
  ds_write_b128 v5, v[78:81] offset:15344
  v_pk_add_f16 v86, v25, v29
  v_pk_add_f16 v87, v26, v30
  v_pk_add_f16 v88, v27, v8
  v_pk_add_f16 v89, v28, v9
  v_pk_add_f16 v86, v86, v78
  v_pk_add_f16 v87, v87, v79
  v_pk_add_f16 v88, v88, v80
  v_pk_add_f16 v89, v89, v81
  ds_write_b128 v5, v[86:89] offset:17536
  v_mov_b32_dpp v33, v8 wave_ror:1 row_mask:0xf bank_mask:0xf
  v_mov_b32_dpp v34, v9 wave_ror:1 row_mask:0xf bank_mask:0xf
  v_mov_b32_dpp v35, v10 wave_ror:1 row_mask:0xf bank_mask:0xf
  v_mov_b32_dpp v36, v11 wave_ror:1 row_mask:0xf bank_mask:0xf
  v_mov_b32_dpp v31, v29 wave_ror:1 row_mask:0xf bank_mask:0xf
  v_mov_b32_dpp v32, v30 wave_ror:1 row_mask:0xf bank_mask:0xf
  v_mov_b32_dpp v35, v14 wave_shr:1 row_mask:0xf bank_mask:0xf
  v_mov_b32_dpp v36, v15 wave_shr:1 row_mask:0xf bank_mask:0xf
  v_mov_b32_dpp v33, v12 wave_shr:1 row_mask:0xf bank_mask:0xf
  v_mov_b32_dpp v34, v13 wave_shr:1 row_mask:0xf bank_mask:0xf
  v_mov_b32_dpp v31, v35 wave_shr:1 row_mask:0xf bank_mask:0xf
  v_mov_b32_dpp v32, v36 wave_shr:1 row_mask:0xf bank_mask:0xf
  v_alignbit_b32 v94, v32, v31, 16
  v_alignbit_b32 v95, v33, v32, 16
  v_alignbit_b32 v96, v34, v33, 16
  v_alignbit_b32 v97, v35, v34, 16
  v_alignbit_b32 v98, v36, v35, 16
  v_alignbit_b32 v99, v12, v36, 16
  v_alignbit_b32 v100, v13, v12, 16
  ds_write_b128 v5, v[32:35] offset:5872
  v_pk_add_f16 v54, v95, v96
  v_pk_add_f16 v55, v96, v97
  v_pk_add_f16 v56, v97, v98
  v_pk_add_f16 v57, v98, v99
  v_pk_add_f16 v54, v54, v33
  v_pk_add_f16 v55, v55, v34
  v_pk_add_f16 v56, v56, v35
  v_pk_add_f16 v57, v57, v36
  ds_write_b128 v5, v[54:57] offset:9520
  v_pk_add_f16 v70, v32, v34
  v_pk_add_f16 v71, v33, v35
  v_pk_add_f16 v72, v34, v36
  v_pk_add_f16 v73, v35, v12
  v_pk_add_f16 v70, v70, v54
  v_pk_add_f16 v71, v71, v55
  v_pk_add_f16 v72, v72, v56
  v_pk_add_f16 v73, v73, v57
  ds_write_b128 v5, v[70:73] offset:13232
  v_pk_add_f16 v82, v94, v97
  v_pk_add_f16 v83, v95, v98
  v_pk_add_f16 v84, v96, v99
  v_pk_add_f16 v85, v97, v100
  v_pk_add_f16 v82, v82, v70
  v_pk_add_f16 v83, v83, v71
  v_pk_add_f16 v84, v84, v72
  v_pk_add_f16 v85, v85, v73
  ds_write_b128 v5, v[82:85] offset:16368
  v_pk_add_f16 v90, v31, v35
  v_pk_add_f16 v91, v32, v36
  v_pk_add_f16 v92, v33, v12
  v_pk_add_f16 v93, v34, v13
  v_pk_add_f16 v90, v90, v82
  v_pk_add_f16 v91, v91, v83
  v_pk_add_f16 v92, v92, v84
  v_pk_add_f16 v93, v93, v85
  ds_write_b128 v5, v[90:93] offset:18560
  v_mov_b32_dpp v39, v12 wave_ror:1 row_mask:0xf bank_mask:0xf
  v_mov_b32_dpp v40, v13 wave_ror:1 row_mask:0xf bank_mask:0xf
  v_mov_b32_dpp v41, v14 wave_ror:1 row_mask:0xf bank_mask:0xf
  v_mov_b32_dpp v42, v15 wave_ror:1 row_mask:0xf bank_mask:0xf
  v_mov_b32_dpp v37, v35 wave_ror:1 row_mask:0xf bank_mask:0xf
  v_mov_b32_dpp v38, v36 wave_ror:1 row_mask:0xf bank_mask:0xf
  v_mov_b32_dpp v41, v18 wave_shr:1 row_mask:0xf bank_mask:0xf
  v_mov_b32_dpp v42, v19 wave_shr:1 row_mask:0xf bank_mask:0xf
  v_mov_b32_dpp v39, v16 wave_shr:1 row_mask:0xf bank_mask:0xf
  v_mov_b32_dpp v40, v17 wave_shr:1 row_mask:0xf bank_mask:0xf
  v_mov_b32_dpp v37, v41 wave_shr:1 row_mask:0xf bank_mask:0xf
  v_mov_b32_dpp v38, v42 wave_shr:1 row_mask:0xf bank_mask:0xf
  v_alignbit_b32 v95, v39, v38, 16
  v_alignbit_b32 v96, v40, v39, 16
  v_alignbit_b32 v97, v41, v40, 16
  v_alignbit_b32 v98, v42, v41, 16
  v_alignbit_b32 v99, v16, v42, 16
  ds_write_b128 v5, v[38:41] offset:6896
  v_pk_add_f16 v58, v95, v96
  v_pk_add_f16 v59, v96, v97
  v_pk_add_f16 v60, v97, v98
  v_pk_add_f16 v61, v98, v99
  v_pk_add_f16 v58, v58, v39
  v_pk_add_f16 v59, v59, v40
  v_pk_add_f16 v60, v60, v41
  v_pk_add_f16 v61, v61, v42
  ds_write_b128 v5, v[58:61] offset:10544
  v_pk_add_f16 v74, v38, v40
  v_pk_add_f16 v75, v39, v41
  v_pk_add_f16 v76, v40, v42
  v_pk_add_f16 v77, v41, v16
  v_pk_add_f16 v74, v74, v58
  v_pk_add_f16 v75, v75, v59
  v_pk_add_f16 v76, v76, v60
  v_pk_add_f16 v77, v77, v61
  ds_write_b128 v5, v[74:77] offset:14256
  v_mov_b32_dpp v45, v16 wave_ror:1 row_mask:0xf bank_mask:0xf
  v_mov_b32_dpp v46, v17 wave_ror:1 row_mask:0xf bank_mask:0xf
  v_mov_b32_dpp v47, v18 wave_ror:1 row_mask:0xf bank_mask:0xf
  v_mov_b32_dpp v48, v19 wave_ror:1 row_mask:0xf bank_mask:0xf
  v_mov_b32_dpp v43, v41 wave_ror:1 row_mask:0xf bank_mask:0xf
  v_mov_b32_dpp v44, v42 wave_ror:1 row_mask:0xf bank_mask:0xf
  v_mov_b32_dpp v47, v22 wave_shr:1 row_mask:0xf bank_mask:0xf
  v_mov_b32_dpp v48, v23 wave_shr:1 row_mask:0xf bank_mask:0xf
  v_mov_b32_dpp v45, v20 wave_shr:1 row_mask:0xf bank_mask:0xf
  v_mov_b32_dpp v46, v21 wave_shr:1 row_mask:0xf bank_mask:0xf
  v_mov_b32_dpp v43, v47 wave_shr:1 row_mask:0xf bank_mask:0xf
  v_mov_b32_dpp v44, v48 wave_shr:1 row_mask:0xf bank_mask:0xf
  v_alignbit_b32 v95, v45, v44, 16
  v_alignbit_b32 v96, v46, v45, 16
  v_alignbit_b32 v97, v47, v46, 16
  v_alignbit_b32 v98, v48, v47, 16
  v_alignbit_b32 v99, v20, v48, 16
  s_mov_b32 exec_hi, 1
  ds_write_b128 v5, v[44:47] offset:7920
  s_mov_b32 exec_hi, -1
  v_pk_add_f16 v62, v95, v96
  v_pk_add_f16 v63, v96, v97
  v_pk_add_f16 v64, v97, v98
  v_pk_add_f16 v65, v98, v99
  v_pk_add_f16 v62, v62, v45
  v_pk_add_f16 v63, v63, v46
  v_pk_add_f16 v64, v64, v47
  v_pk_add_f16 v65, v65, v48
  s_mov_b32 exec_hi, 1
  ds_write_b128 v5, v[62:65] offset:11568
  s_mov_b32 exec_hi, -1
  s_waitcnt lgkmcnt(0)
  ds_write_b32 v3, v4
  s_setprio 0
  s_branch L_k1_cgo
L_noprep_2051:
  s_barrier
  v_lshlrev_b32 v8, 7, v0
  s_lshl_b32 s96, s56, 1
  s_add_u32 s96, s96, s68
  s_mul_i32 s96, s96, 30720
  s_add_u32 s96, s96, 6291456
  s_barrier
L_wprep_2055:
  ds_read_b32 v7, v3
  s_sleep 1
  s_waitcnt lgkmcnt(0)
  v_readfirstlane_b32 s96, v7
  s_cmp_ge_u32 s96, 1
  s_cbranch_scc0 L_wprep_2055
L_k1_cgo:
  s_setprio 1
  ds_read_b64 v[124:125], v124
  v_mov_b64 v[8:9], 0
  v_mov_b64 v[10:11], 0
  v_mov_b64 v[12:13], 0
  v_mov_b64 v[14:15], 0
  v_mov_b64 v[16:17], 0
  v_mov_b64 v[18:19], 0
  v_mov_b64 v[20:21], 0
  v_mov_b64 v[22:23], 0
  v_mov_b64 v[24:25], 0
  v_mov_b64 v[26:27], 0
  s_waitcnt lgkmcnt(0)
  v_and_b32 v124, 0xffff, v124
  v_lshl_or_b32 v124, v124, 16, v124
  v_and_b32 v112, v112, v124
  v_and_b32 v113, v113, v124
  v_and_b32 v114, v114, v124
  v_and_b32 v115, v115, v124
  s_cmp_eq_u32 s59, 1
  s_cbranch_scc1 L_halfB_2056
  ds_read2_b32 v[28:29], v117 offset0:128 offset1:129
  ds_read2_b32 v[30:31], v117 offset0:130 offset1:131
  ds_read_b128 v[96:99], v116 offset:512
  ds_read2_b32 v[32:33], v117 offset0:112 offset1:113
  ds_read2_b32 v[34:35], v117 offset0:114 offset1:115
  ds_read2_b32 v[36:37], v117 offset0:96 offset1:97
  ds_read2_b32 v[38:39], v117 offset0:98 offset1:99
  ds_read_b128 v[100:103], v116 offset:448
  ds_read_b128 v[104:107], v116 offset:384
  ds_read_b64 v[64:65], v121 offset:0
  ds_read_b64 v[66:67], v121 offset:8
  ds_read2_b32 v[40:41], v117 offset0:80 offset1:81
  ds_read2_b32 v[42:43], v117 offset0:82 offset1:83
  ds_read_b128 v[108:111], v116 offset:320
  s_waitcnt lgkmcnt(11)
  v_mfma_f32_16x16x32_f16 v[8:11], v[28:31], v[96:99], v[8:11]
  ds_read2_b32 v[44:45], v117 offset0:64 offset1:65
  ds_read2_b32 v[46:47], v117 offset0:66 offset1:67
  ds_read_b128 v[96:99], v116 offset:256
  s_waitcnt lgkmcnt(9)
  v_mfma_f32_16x16x32_f16 v[8:11], v[32:35], v[100:103], v[8:11]
  ds_read2_b32 v[48:49], v117 offset0:48 offset1:49
  ds_read2_b32 v[50:51], v117 offset0:50 offset1:51
  ds_read_b128 v[100:103], v116 offset:192
  s_waitcnt lgkmcnt(11)
  v_mfma_f32_16x16x32_f16 v[8:11], v[36:39], v[104:107], v[8:11]
  ds_read2_b32 v[52:53], v117 offset0:32 offset1:33
  ds_read2_b32 v[54:55], v117 offset0:34 offset1:35
  ds_read_b128 v[104:107], v116 offset:128
  s_waitcnt lgkmcnt(9)
  v_mfma_f32_16x16x32_f16 v[8:11], v[40:43], v[108:111], v[8:11]
  ds_read2_b32 v[56:57], v117 offset0:16 offset1:17
  ds_read2_b32 v[58:59], v117 offset0:18 offset1:19
  ds_read_b128 v[108:111], v116 offset:64
  s_waitcnt lgkmcnt(9)
  v_mfma_f32_16x16x32_f16 v[8:11], v[44:47], v[96:99], v[8:11]
  ds_read_b64 v[68:69], v121 offset:32
  ds_read_b64 v[70:71], v121 offset:40
  ds_read2_b32 v[60:61], v117 offset0:0 offset1:1
  ds_read2_b32 v[62:63], v117 offset0:2 offset1:3
  ds_read_b128 v[96:99], v116 offset:1024
  s_waitcnt lgkmcnt(11)
  v_mfma_f32_16x16x32_f16 v[8:11], v[48:51], v[100:103], v[8:11]
  ds_read_b128 v[100:103], v116 offset:960
  s_waitcnt lgkmcnt(9)
  v_mfma_f32_16x16x32_f16 v[8:11], v[52:55], v[104:107], v[8:11]
  ds_read_b128 v[104:107], v116 offset:896
  s_waitcnt lgkmcnt(7)
  v_mfma_f32_16x16x32_f16 v[8:11], v[56:59], v[108:111], v[8:11]
  ds_read_b128 v[108:111], v116 offset:832
  s_waitcnt lgkmcnt(3)
  v_mfma_f32_16x16x32_f16 v[12:15], v[28:31], v[96:99], v[12:15]
  ds_read_b128 v[96:99], v116 offset:768
  s_waitcnt lgkmcnt(3)
  v_mfma_f32_16x16x32_f16 v[12:15], v[32:35], v[100:103], v[12:15]
  ds_read_b64 v[72:73], v121 offset:64
  ds_read_b64 v[74:75], v121 offset:72
  ds_read_b128 v[100:103], v116 offset:704
  s_waitcnt lgkmcnt(5)
  v_mfma_f32_16x16x32_f16 v[12:15], v[36:39], v[104:107], v[12:15]
  ds_read_b128 v[104:107], v116 offset:640
  s_waitcnt lgkmcnt(5)
  v_mfma_f32_16x16x32_f16 v[12:15], v[40:43], v[108:111], v[12:15]
  ds_read_b128 v[108:111], v116 offset:576
  s_waitcnt lgkmcnt(5)
  v_mfma_f32_16x16x32_f16 v[12:15], v[44:47], v[96:99], v[12:15]
  ds_read_b128 v[96:99], v116 offset:512
  s_waitcnt lgkmcnt(3)
  v_mfma_f32_16x16x32_f16 v[12:15], v[48:51], v[100:103], v[12:15]
  ds_read_b128 v[100:103], v116 offset:1536
  s_waitcnt lgkmcnt(3)
  v_mfma_f32_16x16x32_f16 v[12:15], v[52:55], v[104:107], v[12:15]
  ds_read_b64 v[76:77], v121 offset:96
  ds_read_b64 v[78:79], v121 offset:104
  ds_read_b128 v[104:107], v116 offset:1472
  s_waitcnt lgkmcnt(5)
  v_mfma_f32_16x16x32_f16 v[12:15], v[56:59], v[108:111], v[12:15]
  ds_read_b128 v[108:111], v116 offset:1408
  s_waitcnt lgkmcnt(5)
  v_mfma_f32_16x16x32_f16 v[12:15], v[60:63], v[96:99], v[12:15]
  ds_read_b128 v[96:99], v116 offset:1344
  s_waitcnt lgkmcnt(5)
  v_mfma_f32_16x16x32_f16 v[16:19], v[28:31], v[100:103], v[16:19]
  ds_read_b128 v[100:103], v116 offset:1280
  s_waitcnt lgkmcnt(3)
  v_mfma_f32_16x16x32_f16 v[16:19], v[32:35], v[104:107], v[16:19]
  ds_read_b128 v[104:107], v116 offset:1216
  s_waitcnt lgkmcnt(3)
  v_mfma_f32_16x16x32_f16 v[16:19], v[36:39], v[108:111], v[16:19]
  ds_read_b128 v[108:111], v116 offset:1152
  s_waitcnt lgkmcnt(3)
  v_mfma_f32_16x16x32_f16 v[16:19], v[40:43], v[96:99], v[16:19]
  ds_read_b64 v[80:81], v121 offset:128
  ds_read_b64 v[82:83], v121 offset:136
  ds_read_b128 v[96:99], v116 offset:1088
  s_waitcnt lgkmcnt(5)
  v_mfma_f32_16x16x32_f16 v[16:19], v[44:47], v[100:103], v[16:19]
  ds_read_b128 v[100:103], v116 offset:1024
  s_waitcnt lgkmcnt(5)
  v_mfma_f32_16x16x32_f16 v[16:19], v[48:51], v[104:107], v[16:19]
  ds_read_b128 v[104:107], v116 offset:2048
  s_waitcnt lgkmcnt(5)
  v_mfma_f32_16x16x32_f16 v[16:19], v[52:55], v[108:111], v[16:19]
  ds_read_b128 v[108:111], v116 offset:1984
  s_waitcnt lgkmcnt(3)
  v_mfma_f32_16x16x32_f16 v[16:19], v[56:59], v[96:99], v[16:19]
  ds_read_b128 v[96:99], v116 offset:1920
  s_waitcnt lgkmcnt(3)
  v_mfma_f32_16x16x32_f16 v[16:19], v[60:63], v[100:103], v[16:19]
  ds_read_b64 v[84:85], v121 offset:160
  ds_read_b64 v[86:87], v121 offset:168
  ds_read_b128 v[100:103], v116 offset:1856
  s_waitcnt lgkmcnt(5)
  v_mfma_f32_16x16x32_f16 v[20:23], v[28:31], v[104:107], v[20:23]
  ds_read_b128 v[104:107], v116 offset:1792
  s_waitcnt lgkmcnt(5)
  v_mfma_f32_16x16x32_f16 v[20:23], v[32:35], v[108:111], v[20:23]
  ds_read_b128 v[108:111], v116 offset:1728
  s_waitcnt lgkmcnt(5)
  v_mfma_f32_16x16x32_f16 v[20:23], v[36:39], v[96:99], v[20:23]
  ds_read_b128 v[96:99], v116 offset:1664
  s_waitcnt lgkmcnt(3)
  v_mfma_f32_16x16x32_f16 v[20:23], v[40:43], v[100:103], v[20:23]
  ds_read_b128 v[100:103], v116 offset:1600
  s_waitcnt lgkmcnt(3)
  v_mfma_f32_16x16x32_f16 v[20:23], v[44:47], v[104:107], v[20:23]
  ds_read_b64 v[88:89], v121 offset:192
  ds_read_b64 v[90:91], v121 offset:200
  ds_read_b128 v[104:107], v116 offset:1536
  s_waitcnt lgkmcnt(5)
  v_mfma_f32_16x16x32_f16 v[20:23], v[48:51], v[108:111], v[20:23]
  ds_read_b128 v[108:111], v116 offset:2560
  s_waitcnt lgkmcnt(5)
  v_mfma_f32_16x16x32_f16 v[20:23], v[52:55], v[96:99], v[20:23]
  ds_read_b128 v[96:99], v116 offset:2496
  s_waitcnt lgkmcnt(5)
  v_mfma_f32_16x16x32_f16 v[20:23], v[56:59], v[100:103], v[20:23]
  ds_read_b128 v[100:103], v116 offset:2432
  s_waitcnt lgkmcnt(3)
  v_mfma_f32_16x16x32_f16 v[20:23], v[60:63], v[104:107], v[20:23]
  ds_read_b128 v[104:107], v116 offset:2368
  s_waitcnt lgkmcnt(3)
  v_mfma_f32_16x16x32_f16 v[24:27], v[28:31], v[108:111], v[24:27]
  ds_read_b64 v[92:93], v121 offset:224
  ds_read_b64 v[94:95], v121 offset:232
  ds_read_b128 v[108:111], v116 offset:2304
  s_waitcnt lgkmcnt(5)
  v_mfma_f32_16x16x32_f16 v[24:27], v[32:35], v[96:99], v[24:27]
  ds_read_b128 v[96:99], v116 offset:2240
  s_waitcnt lgkmcnt(5)
  v_mfma_f32_16x16x32_f16 v[24:27], v[36:39], v[100:103], v[24:27]
  ds_read_b128 v[100:103], v116 offset:2176
  s_waitcnt lgkmcnt(5)
  v_mfma_f32_16x16x32_f16 v[24:27], v[40:43], v[104:107], v[24:27]
  ds_read_b128 v[104:107], v116 offset:2112
  s_waitcnt lgkmcnt(3)
  v_mfma_f32_16x16x32_f16 v[24:27], v[44:47], v[108:111], v[24:27]
  ds_read_b128 v[108:111], v116 offset:2048
  s_waitcnt lgkmcnt(3)
  v_mfma_f32_16x16x32_f16 v[24:27], v[48:51], v[96:99], v[24:27]
  ds_read_b64_tr_b16 v[96:97], v118 offset:160
  ds_read_b64_tr_b16 v[98:99], v118 offset:128
  s_waitcnt lgkmcnt(4)
  v_mfma_f32_16x16x32_f16 v[24:27], v[52:55], v[100:103], v[24:27]
  ds_read_b64_tr_b16 v[100:101], v118 offset:288
  ds_read_b64_tr_b16 v[102:103], v118 offset:256
  s_waitcnt lgkmcnt(5)
  v_mfma_f32_16x16x32_f16 v[24:27], v[56:59], v[104:107], v[24:27]
  ds_read_b64_tr_b16 v[104:105], v118 offset:416
  ds_read_b64_tr_b16 v[106:107], v118 offset:384
  s_waitcnt lgkmcnt(6)
  v_mfma_f32_16x16x32_f16 v[24:27], v[60:63], v[108:111], v[24:27]
  ds_read2_b32 v[28:29], v122 offset0:0 offset1:1
  ds_read2_b32 v[30:31], v122 offset0:2 offset1:3
  ds_read_b64_tr_b16 v[108:109], v118 offset:544
  ds_read_b64_tr_b16 v[110:111], v118 offset:512
  s_waitcnt lgkmcnt(8)
  v_mfma_f32_16x16x32_f16 v[12:15], v[96:99], v[76:79], v[12:15]
  v_mfma_f32_16x16x32_f16 v[16:19], v[96:99], v[92:95], v[16:19]
  ds_read_b64_tr_b16 v[96:97], v118 offset:672
  ds_read_b64_tr_b16 v[98:99], v118 offset:640
  s_waitcnt lgkmcnt(8)
  v_mfma_f32_16x16x32_f16 v[12:15], v[100:103], v[72:75], v[12:15]
  v_mfma_f32_16x16x32_f16 v[16:19], v[100:103], v[88:91], v[16:19]
  ds_read2_b32 v[32:33], v122 offset0:8 offset1:9
  ds_read2_b32 v[34:35], v122 offset0:10 offset1:11
  ds_read_b64_tr_b16 v[100:101], v118 offset:800
  ds_read_b64_tr_b16 v[102:103], v118 offset:768
  s_waitcnt lgkmcnt(10)
  v_mfma_f32_16x16x32_f16 v[12:15], v[104:107], v[68:71], v[12:15]
  v_mfma_f32_16x16x32_f16 v[16:19], v[104:107], v[84:87], v[16:19]
  ds_read_b64_tr_b16 v[104:105], v118 offset:928
  ds_read_b64_tr_b16 v[106:107], v118 offset:896
  s_waitcnt lgkmcnt(8)
  v_mfma_f32_16x16x32_f16 v[12:15], v[108:111], v[64:67], v[12:15]
  v_mfma_f32_16x16x32_f16 v[16:19], v[108:111], v[80:83], v[16:19]
  ds_read2_b32 v[36:37], v122 offset0:16 offset1:17
  ds_read2_b32 v[38:39], v122 offset0:18 offset1:19
  ds_read_b64_tr_b16 v[108:109], v118 offset:1056
  ds_read_b64_tr_b16 v[110:111], v118 offset:1024
  s_waitcnt lgkmcnt(10)
  v_mfma_f32_16x16x32_f16 v[16:19], v[96:99], v[76:79], v[16:19]
  v_mfma_f32_16x16x32_f16 v[20:23], v[96:99], v[92:95], v[20:23]
  ds_read_b64_tr_b16 v[96:97], v118 offset:1184
  ds_read_b64_tr_b16 v[98:99], v118 offset:1152
  s_waitcnt lgkmcnt(8)
  v_mfma_f32_16x16x32_f16 v[16:19], v[100:103], v[72:75], v[16:19]
  v_mfma_f32_16x16x32_f16 v[20:23], v[100:103], v[88:91], v[20:23]
  ds_read_b64_tr_b16 v[100:101], v118 offset:1312
  ds_read_b64_tr_b16 v[102:103], v118 offset:1280
  s_waitcnt lgkmcnt(8)
  v_mfma_f32_16x16x32_f16 v[16:19], v[104:107], v[68:71], v[16:19]
  v_mfma_f32_16x16x32_f16 v[20:23], v[104:107], v[84:87], v[20:23]
  ds_read2_b32 v[40:41], v122 offset0:24 offset1:25
  ds_read2_b32 v[42:43], v122 offset0:26 offset1:27
  ds_read_b64_tr_b16 v[104:105], v118 offset:1440
  ds_read_b64_tr_b16 v[106:107], v118 offset:1408
  s_waitcnt lgkmcnt(8)
  v_mfma_f32_16x16x32_f16 v[16:19], v[108:111], v[64:67], v[16:19]
  v_mfma_f32_16x16x32_f16 v[20:23], v[108:111], v[80:83], v[20:23]
  ds_read_b64_tr_b16 v[108:109], v118 offset:1568
  ds_read_b64_tr_b16 v[110:111], v118 offset:1536
  s_waitcnt lgkmcnt(8)
  v_mfma_f32_16x16x32_f16 v[20:23], v[96:99], v[76:79], v[20:23]
  v_mfma_f32_16x16x32_f16 v[24:27], v[96:99], v[92:95], v[24:27]
  ds_read2_b32 v[44:45], v122 offset0:32 offset1:33
  ds_read2_b32 v[46:47], v122 offset0:34 offset1:35
  ds_read_b64_tr_b16 v[96:97], v118 offset:1696
  ds_read_b64_tr_b16 v[98:99], v118 offset:1664
  s_waitcnt lgkmcnt(10)
  v_mfma_f32_16x16x32_f16 v[20:23], v[100:103], v[72:75], v[20:23]
  v_mfma_f32_16x16x32_f16 v[24:27], v[100:103], v[88:91], v[24:27]
  ds_read_b64_tr_b16 v[100:101], v118 offset:1824
  ds_read_b64_tr_b16 v[102:103], v118 offset:1792
  s_waitcnt lgkmcnt(8)
  v_mfma_f32_16x16x32_f16 v[20:23], v[104:107], v[68:71], v[20:23]
  v_mfma_f32_16x16x32_f16 v[24:27], v[104:107], v[84:87], v[24:27]
  ds_read2_b32 v[48:49], v122 offset0:40 offset1:41
  ds_read2_b32 v[50:51], v122 offset0:42 offset1:43
  ds_read_b64_tr_b16 v[104:105], v118 offset:1952
  ds_read_b64_tr_b16 v[106:107], v118 offset:1920
  s_waitcnt lgkmcnt(10)
  v_mfma_f32_16x16x32_f16 v[20:23], v[108:111], v[64:67], v[20:23]
  v_mfma_f32_16x16x32_f16 v[24:27], v[108:111], v[80:83], v[24:27]
  ds_read_b64_tr_b16 v[108:109], v118 offset:2080
  ds_read_b64_tr_b16 v[110:111], v118 offset:2048
  s_waitcnt lgkmcnt(8)
  v_mfma_f32_16x16x32_f16 v[24:27], v[96:99], v[76:79], v[24:27]
  ds_read_b64_tr_b16 v[96:97], v119 offset:832
  ds_read_b64_tr_b16 v[98:99], v119 offset:768
  s_waitcnt lgkmcnt(8)
  v_mfma_f32_16x16x32_f16 v[24:27], v[100:103], v[72:75], v[24:27]
  ds_read_b64_tr_b16 v[100:101], v119 offset:1088
  ds_read_b64_tr_b16 v[102:103], v119 offset:1024
  s_waitcnt lgkmcnt(6)
  v_mfma_f32_16x16x32_f16 v[24:27], v[104:107], v[68:71], v[24:27]
  ds_read_b64_tr_b16 v[104:105], v119 offset:1344
  ds_read_b64_tr_b16 v[106:107], v119 offset:1280
  s_waitcnt lgkmcnt(6)
  v_mfma_f32_16x16x32_f16 v[24:27], v[108:111], v[64:67], v[24:27]
  ds_read2_b32 v[64:65], v123 offset0:0 offset1:1
  ds_read2_b32 v[66:67], v123 offset0:2 offset1:3
  ds_read_b64_tr_b16 v[108:109], v119 offset:1600
  ds_read_b64_tr_b16 v[110:111], v119 offset:1536
  s_waitcnt lgkmcnt(8)
  v_mfma_f32_16x16x32_f16 v[16:19], v[96:99], v[32:35], v[16:19]
  v_mfma_f32_16x16x32_f16 v[20:23], v[96:99], v[40:43], v[20:23]
  v_mfma_f32_16x16x32_f16 v[24:27], v[96:99], v[48:51], v[24:27]
  ds_read_b64_tr_b16 v[96:97], v119 offset:1856
  ds_read_b64_tr_b16 v[98:99], v119 offset:1792
  s_waitcnt lgkmcnt(8)
  v_mfma_f32_16x16x32_f16 v[16:19], v[100:103], v[28:31], v[16:19]
  v_mfma_f32_16x16x32_f16 v[20:23], v[100:103], v[36:39], v[20:23]
  v_mfma_f32_16x16x32_f16 v[24:27], v[100:103], v[44:47], v[24:27]
  ds_read_b64_tr_b16 v[100:101], v119 offset:2112
  ds_read_b64_tr_b16 v[102:103], v119 offset:2048
  s_waitcnt lgkmcnt(8)
  v_mfma_f32_16x16x32_f16 v[20:23], v[104:107], v[32:35], v[20:23]
  v_mfma_f32_16x16x32_f16 v[24:27], v[104:107], v[40:43], v[24:27]
  ds_read_b64_tr_b16 v[104:105], v120 offset:2176
  ds_read_b64_tr_b16 v[106:107], v120 offset:2048
  s_waitcnt lgkmcnt(6)
  v_mfma_f32_16x16x32_f16 v[20:23], v[108:111], v[28:31], v[20:23]
  v_mfma_f32_16x16x32_f16 v[24:27], v[108:111], v[36:39], v[24:27]
  ds_read_b128 v[108:111], v116 offset:16
  s_waitcnt lgkmcnt(5)
  v_mfma_f32_16x16x32_f16 v[24:27], v[96:99], v[32:35], v[24:27]
  ds_read_b128 v[96:99], v116 offset:528
  s_waitcnt lgkmcnt(4)
  v_mfma_f32_16x16x32_f16 v[24:27], v[100:103], v[28:31], v[24:27]
  s_waitcnt lgkmcnt(2)
  v_mfma_f32_16x16x32_f16 v[24:27], v[104:107], v[64:67], v[24:27]
  s_waitcnt lgkmcnt(1)
  v_mfma_f32_16x16x32_f16 v[20:23], v[112:115], v[108:111], v[20:23]
  s_waitcnt lgkmcnt(0)
  v_mfma_f32_16x16x32_f16 v[24:27], v[112:115], v[96:99], v[24:27]
  s_nop 7
  v_mul_f32 v8, v8, v125
  v_mul_f32 v9, v9, v125
  v_mul_f32 v10, v10, v125
  v_mul_f32 v11, v11, v125
  v_cvt_pk_bf16_f32 v8, v8, v9
  v_cvt_pk_bf16_f32 v9, v10, v11
  buffer_store_dwordx2 v[8:9], v126, s[20:23], s93 offen offset:0 sc1
  v_mul_f32 v12, v12, v125
  v_mul_f32 v13, v13, v125
  v_mul_f32 v14, v14, v125
  v_mul_f32 v15, v15, v125
  v_cvt_pk_bf16_f32 v12, v12, v13
  v_cvt_pk_bf16_f32 v13, v14, v15
  buffer_store_dwordx2 v[12:13], v126, s[20:23], s93 offen offset:512 sc1
  v_mul_f32 v16, v16, v125
  v_mul_f32 v17, v17, v125
  v_mul_f32 v18, v18, v125
  v_mul_f32 v19, v19, v125
  v_cvt_pk_bf16_f32 v16, v16, v17
  v_cvt_pk_bf16_f32 v17, v18, v19
  buffer_store_dwordx2 v[16:17], v126, s[20:23], s93 offen offset:1024 sc1
  v_mul_f32 v20, v20, v125
  v_mul_f32 v21, v21, v125
  v_mul_f32 v22, v22, v125
  v_mul_f32 v23, v23, v125
  v_cvt_pk_bf16_f32 v20, v20, v21
  v_cvt_pk_bf16_f32 v21, v22, v23
  buffer_store_dwordx2 v[20:21], v126, s[20:23], s93 offen offset:1536 sc1
  v_mul_f32 v24, v24, v125
  v_mul_f32 v25, v25, v125
  v_mul_f32 v26, v26, v125
  v_mul_f32 v27, v27, v125
  v_cvt_pk_bf16_f32 v24, v24, v25
  v_cvt_pk_bf16_f32 v25, v26, v27
  buffer_store_dwordx2 v[24:25], v126, s[20:23], s93 offen offset:2048 sc1
  s_branch L_cjoin_2057
L_halfB_2056:
  ds_read2_b32 v[28:29], v117 offset0:128 offset1:129
  ds_read2_b32 v[30:31], v117 offset0:130 offset1:131
  ds_read_b128 v[96:99], v116 offset:3072
  ds_read2_b32 v[32:33], v117 offset0:112 offset1:113
  ds_read2_b32 v[34:35], v117 offset0:114 offset1:115
  ds_read2_b32 v[36:37], v117 offset0:96 offset1:97
  ds_read2_b32 v[38:39], v117 offset0:98 offset1:99
  ds_read_b128 v[100:103], v116 offset:3008
  ds_read_b128 v[104:107], v116 offset:2944
  ds_read_b64 v[64:65], v121 offset:0
  ds_read_b64 v[66:67], v121 offset:8
  ds_read2_b32 v[40:41], v117 offset0:80 offset1:81
  ds_read2_b32 v[42:43], v117 offset0:82 offset1:83
  ds_read_b128 v[108:111], v116 offset:2880
  s_waitcnt lgkmcnt(11)
  v_mfma_f32_16x16x32_f16 v[8:11], v[28:31], v[96:99], v[8:11]
  ds_read2_b32 v[44:45], v117 offset0:64 offset1:65
  ds_read2_b32 v[46:47], v117 offset0:66 offset1:67
  ds_read_b128 v[96:99], v116 offset:2816
  s_waitcnt lgkmcnt(9)
  v_mfma_f32_16x16x32_f16 v[8:11], v[32:35], v[100:103], v[8:11]
  ds_read2_b32 v[48:49], v117 offset0:48 offset1:49
  ds_read2_b32 v[50:51], v117 offset0:50 offset1:51
  ds_read_b128 v[100:103], v116 offset:2752
  s_waitcnt lgkmcnt(11)
  v_mfma_f32_16x16x32_f16 v[8:11], v[36:39], v[104:107], v[8:11]
  ds_read_b64 v[68:69], v121 offset:32
  ds_read_b64 v[70:71], v121 offset:40
  ds_read2_b32 v[52:53], v117 offset0:32 offset1:33
  ds_read2_b32 v[54:55], v117 offset0:34 offset1:35
  ds_read_b128 v[104:107], v116 offset:2688
  s_waitcnt lgkmcnt(11)
  v_mfma_f32_16x16x32_f16 v[8:11], v[40:43], v[108:111], v[8:11]
  ds_read2_b32 v[56:57], v117 offset0:16 offset1:17
  ds_read2_b32 v[58:59], v117 offset0:18 offset1:19
  ds_read_b128 v[108:111], v116 offset:2624
  s_waitcnt lgkmcnt(11)
  v_mfma_f32_16x16x32_f16 v[8:11], v[44:47], v[96:99], v[8:11]
  ds_read2_b32 v[60:61], v117 offset0:0 offset1:1
  ds_read2_b32 v[62:63], v117 offset0:2 offset1:3
  ds_read_b128 v[96:99], v116 offset:2560
  s_waitcnt lgkmcnt(11)
  v_mfma_f32_16x16x32_f16 v[8:11], v[48:51], v[100:103], v[8:11]
  ds_read_b64 v[72:73], v121 offset:64
  ds_read_b64 v[74:75], v121 offset:72
  ds_read_b128 v[100:103], v116 offset:3584
  s_waitcnt lgkmcnt(9)
  v_mfma_f32_16x16x32_f16 v[8:11], v[52:55], v[104:107], v[8:11]
  ds_read_b128 v[104:107], v116 offset:3520
  s_waitcnt lgkmcnt(7)
  v_mfma_f32_16x16x32_f16 v[8:11], v[56:59], v[108:111], v[8:11]
  ds_read_b128 v[108:111], v116 offset:3456
  s_waitcnt lgkmcnt(5)
  v_mfma_f32_16x16x32_f16 v[8:11], v[60:63], v[96:99], v[8:11]
  ds_read_b64 v[76:77], v121 offset:96
  ds_read_b64 v[78:79], v121 offset:104
  ds_read_b128 v[96:99], v116 offset:3392
  s_waitcnt lgkmcnt(5)
  v_mfma_f32_16x16x32_f16 v[12:15], v[28:31], v[100:103], v[12:15]
  ds_read_b128 v[100:103], v116 offset:3328
  s_waitcnt lgkmcnt(5)
  v_mfma_f32_16x16x32_f16 v[12:15], v[32:35], v[104:107], v[12:15]
  ds_read_b128 v[104:107], v116 offset:3264
  s_waitcnt lgkmcnt(5)
  v_mfma_f32_16x16x32_f16 v[12:15], v[36:39], v[108:111], v[12:15]
  ds_read_b64 v[80:81], v121 offset:128
  ds_read_b64 v[82:83], v121 offset:136
  ds_read_b128 v[108:111], v116 offset:3200
  s_waitcnt lgkmcnt(5)
  v_mfma_f32_16x16x32_f16 v[12:15], v[40:43], v[96:99], v[12:15]
  ds_read_b128 v[96:99], v116 offset:3136
  s_waitcnt lgkmcnt(5)
  v_mfma_f32_16x16x32_f16 v[12:15], v[44:47], v[100:103], v[12:15]
  ds_read_b128 v[100:103], v116 offset:3072
  s_waitcnt lgkmcnt(5)
  v_mfma_f32_16x16x32_f16 v[12:15], v[48:51], v[104:107], v[12:15]
  ds_read_b64 v[84:85], v121 offset:160
  ds_read_b64 v[86:87], v121 offset:168
  ds_read_b128 v[104:107], v116 offset:4096
  s_waitcnt lgkmcnt(5)
  v_mfma_f32_16x16x32_f16 v[12:15], v[52:55], v[108:111], v[12:15]
  ds_read_b128 v[108:111], v116 offset:4032
  s_waitcnt lgkmcnt(5)
  v_mfma_f32_16x16x32_f16 v[12:15], v[56:59], v[96:99], v[12:15]
  ds_read_b128 v[96:99], v116 offset:3968
  s_waitcnt lgkmcnt(5)
  v_mfma_f32_16x16x32_f16 v[12:15], v[60:63], v[100:103], v[12:15]
  ds_read_b64 v[88:89], v121 offset:192
  ds_read_b64 v[90:91], v121 offset:200
  ds_read_b128 v[100:103], v116 offset:3904
  s_waitcnt lgkmcnt(5)
  v_mfma_f32_16x16x32_f16 v[16:19], v[28:31], v[104:107], v[16:19]
  ds_read_b128 v[104:107], v116 offset:3840
  s_waitcnt lgkmcnt(5)
  v_mfma_f32_16x16x32_f16 v[16:19], v[32:35], v[108:111], v[16:19]
  ds_read_b128 v[108:111], v116 offset:3776
  s_waitcnt lgkmcnt(5)
  v_mfma_f32_16x16x32_f16 v[16:19], v[36:39], v[96:99], v[16:19]
  ds_read_b64 v[92:93], v121 offset:224
  ds_read_b64 v[94:95], v121 offset:232
  ds_read_b128 v[96:99], v116 offset:3712
  s_waitcnt lgkmcnt(5)
  v_mfma_f32_16x16x32_f16 v[16:19], v[40:43], v[100:103], v[16:19]
  ds_read_b128 v[100:103], v116 offset:3648
  s_waitcnt lgkmcnt(5)
  v_mfma_f32_16x16x32_f16 v[16:19], v[44:47], v[104:107], v[16:19]
  ds_read_b128 v[104:107], v116 offset:3584
  s_waitcnt lgkmcnt(5)
  v_mfma_f32_16x16x32_f16 v[16:19], v[48:51], v[108:111], v[16:19]
  ds_read_b64_tr_b16 v[108:109], v118 offset:1696
  ds_read_b64_tr_b16 v[110:111], v118 offset:1664
  s_waitcnt lgkmcnt(4)
  v_mfma_f32_16x16x32_f16 v[16:19], v[52:55], v[96:99], v[16:19]
  ds_read_b64_tr_b16 v[96:97], v118 offset:1824
  ds_read_b64_tr_b16 v[98:99], v118 offset:1792
  s_waitcnt lgkmcnt(5)
  v_mfma_f32_16x16x32_f16 v[16:19], v[56:59], v[100:103], v[16:19]
  ds_read_b64_tr_b16 v[100:101], v118 offset:1952
  ds_read_b64_tr_b16 v[102:103], v118 offset:1920
  s_waitcnt lgkmcnt(6)
  v_mfma_f32_16x16x32_f16 v[16:19], v[60:63], v[104:107], v[16:19]
  ds_read2_b32 v[28:29], v122 offset0:0 offset1:1
  ds_read2_b32 v[30:31], v122 offset0:2 offset1:3
  ds_read_b64_tr_b16 v[104:105], v118 offset:2080
  ds_read_b64_tr_b16 v[106:107], v118 offset:2048
  s_waitcnt lgkmcnt(8)
  v_mfma_f32_16x16x32_f16 v[8:11], v[108:111], v[92:95], v[8:11]
  ds_read_b64_tr_b16 v[108:109], v118 offset:2208
  ds_read_b64_tr_b16 v[110:111], v118 offset:2176
  s_waitcnt lgkmcnt(8)
  v_mfma_f32_16x16x32_f16 v[8:11], v[96:99], v[88:91], v[8:11]
  ds_read2_b32 v[32:33], v122 offset0:8 offset1:9
  ds_read2_b32 v[34:35], v122 offset0:10 offset1:11
  ds_read_b64_tr_b16 v[96:97], v118 offset:2336
  ds_read_b64_tr_b16 v[98:99], v118 offset:2304
  s_waitcnt lgkmcnt(10)
  v_mfma_f32_16x16x32_f16 v[8:11], v[100:103], v[84:87], v[8:11]
  ds_read_b64_tr_b16 v[100:101], v118 offset:2464
  ds_read_b64_tr_b16 v[102:103], v118 offset:2432
  s_waitcnt lgkmcnt(8)
  v_mfma_f32_16x16x32_f16 v[8:11], v[104:107], v[80:83], v[8:11]
  ds_read2_b32 v[36:37], v122 offset0:16 offset1:17
  ds_read2_b32 v[38:39], v122 offset0:18 offset1:19
  ds_read_b64_tr_b16 v[104:105], v118 offset:2592
  ds_read_b64_tr_b16 v[106:107], v118 offset:2560
  s_waitcnt lgkmcnt(10)
  v_mfma_f32_16x16x32_f16 v[8:11], v[108:111], v[76:79], v[8:11]
  v_mfma_f32_16x16x32_f16 v[12:15], v[108:111], v[92:95], v[12:15]
  ds_read_b64_tr_b16 v[108:109], v118 offset:2720
  ds_read_b64_tr_b16 v[110:111], v118 offset:2688
  s_waitcnt lgkmcnt(8)
  v_mfma_f32_16x16x32_f16 v[8:11], v[96:99], v[72:75], v[8:11]
  v_mfma_f32_16x16x32_f16 v[12:15], v[96:99], v[88:91], v[12:15]
  ds_read_b64_tr_b16 v[96:97], v118 offset:2848
  ds_read_b64_tr_b16 v[98:99], v118 offset:2816
  s_waitcnt lgkmcnt(8)
  v_mfma_f32_16x16x32_f16 v[8:11], v[100:103], v[68:71], v[8:11]
  v_mfma_f32_16x16x32_f16 v[12:15], v[100:103], v[84:87], v[12:15]
  ds_read2_b32 v[40:41], v122 offset0:24 offset1:25
  ds_read2_b32 v[42:43], v122 offset0:26 offset1:27
  ds_read_b64_tr_b16 v[100:101], v118 offset:2976
  ds_read_b64_tr_b16 v[102:103], v118 offset:2944
  s_waitcnt lgkmcnt(8)
  v_mfma_f32_16x16x32_f16 v[8:11], v[104:107], v[64:67], v[8:11]
  v_mfma_f32_16x16x32_f16 v[12:15], v[104:107], v[80:83], v[12:15]
  ds_read_b64_tr_b16 v[104:105], v118 offset:3104
  ds_read_b64_tr_b16 v[106:107], v118 offset:3072
  s_waitcnt lgkmcnt(8)
  v_mfma_f32_16x16x32_f16 v[12:15], v[108:111], v[76:79], v[12:15]
  v_mfma_f32_16x16x32_f16 v[16:19], v[108:111], v[92:95], v[16:19]
  ds_read2_b32 v[44:45], v122 offset0:32 offset1:33
  ds_read2_b32 v[46:47], v122 offset0:34 offset1:35
  ds_read_b64_tr_b16 v[108:109], v118 offset:3232
  ds_read_b64_tr_b16 v[110:111], v118 offset:3200
  s_waitcnt lgkmcnt(10)
  v_mfma_f32_16x16x32_f16 v[12:15], v[96:99], v[72:75], v[12:15]
  v_mfma_f32_16x16x32_f16 v[16:19], v[96:99], v[88:91], v[16:19]
  ds_read_b64_tr_b16 v[96:97], v118 offset:3360
  ds_read_b64_tr_b16 v[98:99], v118 offset:3328
  s_waitcnt lgkmcnt(8)
  v_mfma_f32_16x16x32_f16 v[12:15], v[100:103], v[68:71], v[12:15]
  v_mfma_f32_16x16x32_f16 v[16:19], v[100:103], v[84:87], v[16:19]
  ds_read2_b32 v[48:49], v122 offset0:40 offset1:41
  ds_read2_b32 v[50:51], v122 offset0:42 offset1:43
  ds_read_b64_tr_b16 v[100:101], v118 offset:3488
  ds_read_b64_tr_b16 v[102:103], v118 offset:3456
  s_waitcnt lgkmcnt(10)
  v_mfma_f32_16x16x32_f16 v[12:15], v[104:107], v[64:67], v[12:15]
  v_mfma_f32_16x16x32_f16 v[16:19], v[104:107], v[80:83], v[16:19]
  ds_read_b64_tr_b16 v[104:105], v118 offset:3616
  ds_read_b64_tr_b16 v[106:107], v118 offset:3584
  s_waitcnt lgkmcnt(8)
  v_mfma_f32_16x16x32_f16 v[16:19], v[108:111], v[76:79], v[16:19]
  ds_read_b64_tr_b16 v[108:109], v119 offset:1344
  ds_read_b64_tr_b16 v[110:111], v119 offset:1280
  s_waitcnt lgkmcnt(8)
  v_mfma_f32_16x16x32_f16 v[16:19], v[96:99], v[72:75], v[16:19]
  ds_read_b64_tr_b16 v[96:97], v119 offset:1600
  ds_read_b64_tr_b16 v[98:99], v119 offset:1536
  s_waitcnt lgkmcnt(6)
  v_mfma_f32_16x16x32_f16 v[16:19], v[100:103], v[68:71], v[16:19]
  ds_read_b64_tr_b16 v[100:101], v119 offset:1856
  ds_read_b64_tr_b16 v[102:103], v119 offset:1792
  s_waitcnt lgkmcnt(6)
  v_mfma_f32_16x16x32_f16 v[16:19], v[104:107], v[64:67], v[16:19]
  ds_read2_b32 v[64:65], v123 offset0:0 offset1:1
  ds_read2_b32 v[66:67], v123 offset0:2 offset1:3
  ds_read_b64_tr_b16 v[104:105], v119 offset:2112
  ds_read_b64_tr_b16 v[106:107], v119 offset:2048
  s_waitcnt lgkmcnt(8)
  v_mfma_f32_16x16x32_f16 v[8:11], v[108:111], v[48:51], v[8:11]
  ds_read_b64_tr_b16 v[108:109], v119 offset:2368
  ds_read_b64_tr_b16 v[110:111], v119 offset:2304
  s_waitcnt lgkmcnt(8)
  v_mfma_f32_16x16x32_f16 v[8:11], v[96:99], v[44:47], v[8:11]
  ds_read2_b32 v[68:69], v123 offset0:8 offset1:9
  ds_read2_b32 v[70:71], v123 offset0:10 offset1:11
  ds_read_b64_tr_b16 v[96:97], v119 offset:2624
  ds_read_b64_tr_b16 v[98:99], v119 offset:2560
  s_waitcnt lgkmcnt(10)
  v_mfma_f32_16x16x32_f16 v[8:11], v[100:103], v[40:43], v[8:11]
  v_mfma_f32_16x16x32_f16 v[12:15], v[100:103], v[48:51], v[12:15]
  ds_read_b64_tr_b16 v[100:101], v119 offset:2880
  ds_read_b64_tr_b16 v[102:103], v119 offset:2816
  s_waitcnt lgkmcnt(8)
  v_mfma_f32_16x16x32_f16 v[8:11], v[104:107], v[36:39], v[8:11]
  v_mfma_f32_16x16x32_f16 v[12:15], v[104:107], v[44:47], v[12:15]
  ds_read2_b32 v[72:73], v123 offset0:16 offset1:17
  ds_read2_b32 v[74:75], v123 offset0:18 offset1:19
  ds_read_b64_tr_b16 v[104:105], v119 offset:3136
  ds_read_b64_tr_b16 v[106:107], v119 offset:3072
  s_waitcnt lgkmcnt(10)
  v_mfma_f32_16x16x32_f16 v[8:11], v[108:111], v[32:35], v[8:11]
  v_mfma_f32_16x16x32_f16 v[12:15], v[108:111], v[40:43], v[12:15]
  v_mfma_f32_16x16x32_f16 v[16:19], v[108:111], v[48:51], v[16:19]
  ds_read_b64_tr_b16 v[108:109], v119 offset:3392
  ds_read_b64_tr_b16 v[110:111], v119 offset:3328
  s_waitcnt lgkmcnt(8)
  v_mfma_f32_16x16x32_f16 v[8:11], v[96:99], v[28:31], v[8:11]
  v_mfma_f32_16x16x32_f16 v[12:15], v[96:99], v[36:39], v[12:15]
  v_mfma_f32_16x16x32_f16 v[16:19], v[96:99], v[44:47], v[16:19]
  ds_read2_b32 v[76:77], v123 offset0:24 offset1:25
  ds_read2_b32 v[78:79], v123 offset0:26 offset1:27
  ds_read_b64_tr_b16 v[96:97], v119 offset:3648
  ds_read_b64_tr_b16 v[98:99], v119 offset:3584
  s_waitcnt lgkmcnt(10)
  v_mfma_f32_16x16x32_f16 v[12:15], v[100:103], v[32:35], v[12:15]
  v_mfma_f32_16x16x32_f16 v[16:19], v[100:103], v[40:43], v[16:19]
  ds_read_b64_tr_b16 v[100:101], v120 offset:2176
  ds_read_b64_tr_b16 v[102:103], v120 offset:2048
  s_waitcnt lgkmcnt(8)
  v_mfma_f32_16x16x32_f16 v[12:15], v[104:107], v[28:31], v[12:15]
  v_mfma_f32_16x16x32_f16 v[16:19], v[104:107], v[36:39], v[16:19]
  ds_read_b64_tr_b16 v[104:105], v120 offset:2688
  ds_read_b64_tr_b16 v[106:107], v120 offset:2560
  s_waitcnt lgkmcnt(8)
  v_mfma_f32_16x16x32_f16 v[16:19], v[108:111], v[32:35], v[16:19]
  ds_read_b64_tr_b16 v[108:109], v120 offset:3200
  ds_read_b64_tr_b16 v[110:111], v120 offset:3072
  s_waitcnt lgkmcnt(6)
  v_mfma_f32_16x16x32_f16 v[16:19], v[96:99], v[28:31], v[16:19]
  ds_read_b64_tr_b16 v[96:97], v120 offset:3712
  ds_read_b64_tr_b16 v[98:99], v120 offset:3584
  s_waitcnt lgkmcnt(6)
  v_mfma_f32_16x16x32_f16 v[8:11], v[100:103], v[68:71], v[8:11]
  v_mfma_f32_16x16x32_f16 v[12:15], v[100:103], v[72:75], v[12:15]
  v_mfma_f32_16x16x32_f16 v[16:19], v[100:103], v[76:79], v[16:19]
  ds_read_b128 v[100:103], v116 offset:1040
  s_waitcnt lgkmcnt(5)
  v_mfma_f32_16x16x32_f16 v[8:11], v[104:107], v[64:67], v[8:11]
  v_mfma_f32_16x16x32_f16 v[12:15], v[104:107], v[68:71], v[12:15]
  v_mfma_f32_16x16x32_f16 v[16:19], v[104:107], v[72:75], v[16:19]
  ds_read_b128 v[104:107], v116 offset:1552
  s_waitcnt lgkmcnt(4)
  v_mfma_f32_16x16x32_f16 v[12:15], v[108:111], v[64:67], v[12:15]
  v_mfma_f32_16x16x32_f16 v[16:19], v[108:111], v[68:71], v[16:19]
  ds_read_b128 v[108:111], v116 offset:2064
  s_waitcnt lgkmcnt(3)
  v_mfma_f32_16x16x32_f16 v[16:19], v[96:99], v[64:67], v[16:19]
  s_waitcnt lgkmcnt(2)
  v_mfma_f32_16x16x32_f16 v[8:11], v[112:115], v[100:103], v[8:11]
  s_waitcnt lgkmcnt(1)
  v_mfma_f32_16x16x32_f16 v[12:15], v[112:115], v[104:107], v[12:15]
  s_waitcnt lgkmcnt(0)
  v_mfma_f32_16x16x32_f16 v[16:19], v[112:115], v[108:111], v[16:19]
  s_nop 7
  v_mul_f32 v8, v8, v125
  v_mul_f32 v9, v9, v125
  v_mul_f32 v10, v10, v125
  v_mul_f32 v11, v11, v125
  v_cvt_pk_bf16_f32 v8, v8, v9
  v_cvt_pk_bf16_f32 v9, v10, v11
  buffer_store_dwordx2 v[8:9], v126, s[20:23], s93 offen offset:2560 sc1
  v_mul_f32 v12, v12, v125
  v_mul_f32 v13, v13, v125
  v_mul_f32 v14, v14, v125
  v_mul_f32 v15, v15, v125
  v_cvt_pk_bf16_f32 v12, v12, v13
  v_cvt_pk_bf16_f32 v13, v14, v15
  buffer_store_dwordx2 v[12:13], v126, s[20:23], s93 offen offset:3072 sc1
  v_mul_f32 v16, v16, v125
  v_mul_f32 v17, v17, v125
  v_mul_f32 v18, v18, v125
  v_mul_f32 v19, v19, v125
  v_cvt_pk_bf16_f32 v16, v16, v17
  v_cvt_pk_bf16_f32 v17, v18, v19
  buffer_store_dwordx2 v[16:17], v126, s[20:23], s93 offen offset:3584 sc1
L_cjoin_2057:
  v_mov_b32 v3, 163776
  s_mov_b64 exec, 1
  ds_add_u32 v3, v4 offset:32
  s_mov_b64 exec, -1
  s_barrier
  s_waitcnt vmcnt(0)
  v_mov_b32 v3, 163776
  v_mov_b32 v5, 0
  s_mov_b64 exec, 1
  ds_add_rtn_u32 v6, v3, v4 offset:20
  s_waitcnt lgkmcnt(0)
  v_readfirstlane_b32 s96, v6
  s_cmp_lg_u32 s96, 4
  s_cbranch_scc1 L_ys_2058
  s_lshl_b32 s97, s69, 2
  s_add_u32 s97, s97, 15890432
  buffer_store_dword v4, v5, s[20:23], s97 offen sc1
L_ys_2058:
  s_mov_b64 exec, -1
  s_endpgm
L_k1_end:
  s_endpgm
.section .rodata,"a"
.p2align 6
.amdhsa_kernel parallel_sum__ssm_conv_s4d__glu_gated_glu__prompt_kernel
  .amdhsa_next_free_vgpr 128
  .amdhsa_next_free_sgpr 102
  .amdhsa_accum_offset 128
  .amdhsa_group_segment_fixed_size 0
  .amdhsa_kernarg_size 112
  .amdhsa_user_sgpr_count 2
  .amdhsa_user_sgpr_kernarg_segment_ptr 1
  .amdhsa_system_sgpr_workgroup_id_x 1
.end_amdhsa_kernel
```
